```python
import torch

def _softmax(x, axis=-1):
    return torch.softmax(x, dim=axis)
def _gelu(x):
    return torch.nn.functional.gelu(x, approximate="tanh")
def _silu(x):
    return torch.nn.functional.silu(x)
def _sigmoid(x):
    return torch.sigmoid(x)
def _layernorm(x, axis=-1, eps=1e-5):
    m = x.mean(dim=axis, keepdim=True)
    v = x.var(dim=axis, keepdim=True, unbiased=False)
    return (x - m) / torch.sqrt(v + eps)
def _scatter_add(tgt, idx, src, axis=0):
    return tgt.clone().index_add_(axis, idx, src)
def _segment_sum(src, seg, n):
    out = torch.zeros((n,) + src.shape[1:], dtype=src.dtype)
    return out.index_add_(0, seg, src)
def _pad(x, pw):
    flat = tuple(v for pair in reversed(pw) for v in pair)
    return torch.nn.functional.pad(x, flat)

kernel_name = 'standalone__gqa_softmax__near_ridge'

def setup_inputs():

    _w = (lambda a: (lambda t: t.to(torch.bfloat16) if t.is_floating_point() else t)(torch.as_tensor(a)))
    B, Hq, Hkv, Sq, Sk, D = 16, 32, 32, 512, 512, 192
    return {
        "q": _w((lambda *s: torch.randn(*s, dtype=torch.bfloat16) * 0.8)(B, Hq, Sq, D)),
        "k": _w((lambda *s: torch.randn(*s, dtype=torch.bfloat16) * 0.8)(B, Hkv, Sk, D)),
        "v": _w((lambda *s: torch.randn(*s, dtype=torch.bfloat16) * 0.05)(B, Hkv, Sk, D)),
    }

def reference(q, k, v):
    B, Hq, Sq, D = q.shape
    Hkv = k.shape[1]
    rep = Hq // Hkv
    k = (lambda x, n, axis: torch.repeat_interleave(x, n, dim=axis))(k, rep, axis=1)
    v = (lambda x, n, axis: torch.repeat_interleave(x, n, dim=axis))(v, rep, axis=1)
    scale = D ** -0.5
    scores = torch.einsum("bhqd,bhkd->bhqk", q, k) * scale
    p = _softmax(scores, axis=-1)
    return torch.einsum("bhqk,bhkd->bhqd", p, v)
```

```asm
; @launch grid=(256,1,1) block=(256,1,1) lds=163840
.amdgcn_target "amdgcn-amd-amdhsa--gfx950"
.text
.globl standalone__gqa_softmax__near_ridge_kernel
.p2align 8
.type standalone__gqa_softmax__near_ridge_kernel,@function
standalone__gqa_softmax__near_ridge_kernel:
s_cmp_ge_u32 s2, 256
s_cbranch_scc1 L_end
s_load_dwordx4 s[4:7], s[0:1], 0
s_load_dwordx4 s[8:11], s[0:1], 16
v_lshrrev_b32 v24, 6, v0
v_and_b32 v25, 63, v0
v_readfirstlane_b32 s3, v24
s_and_b32 s39, s2, 7
s_lshr_b32 s48, s2, 4
s_lshl_b32 s48, s48, 3
s_add_u32 s39, s39, s48
s_mul_i32 s31, s39, 196608
s_lshr_b32 s48, s2, 3
s_and_b32 s48, s48, 1
s_mul_i32 s49, s48, 98304
s_lshl_b32 s39, s3, 3
v_add_u32 v26, 0, v25
v_mul_u32_u24 v27, 2731, v26
v_lshrrev_b32 v27, 16, v27
v_mul_u32_u24 v28, 24, v27
v_sub_u32 v28, v26, v28
v_add_u32 v27, s39, v27
v_lshrrev_b32 v29, 1, v27
v_and_b32 v30, 7, v29
v_xor_b32_e64 v30, v30, v28
v_mul_u32_u24 v31, 384, v27
v_lshl_add_u32 v7, v30, 4, v31
v_subrev_u32 v7, 0, v7
v_and_b32 v30, 3, v29
v_lshlrev_b32 v30, 1, v30
v_xor_b32 v30, v30, v28
v_lshl_add_u32 v10, v30, 4, v31
v_subrev_u32 v10, 0, v10
v_add_u32 v26, 64, v25
v_mul_u32_u24 v27, 2731, v26
v_lshrrev_b32_e64 v27, 16, v27
v_mul_u32_u24 v28, 24, v27
v_sub_u32 v28, v26, v28
v_add_u32 v27, s39, v27
v_lshrrev_b32 v29, 1, v27
v_and_b32 v30, 7, v29
v_xor_b32 v30, v30, v28
v_mul_u32_u24 v31, 384, v27
v_lshl_add_u32 v8, v30, 4, v31
v_subrev_u32 v8, 1024, v8
v_and_b32 v30, 3, v29
v_lshlrev_b32 v30, 1, v30
v_xor_b32_e64 v30, v30, v28
v_lshl_add_u32 v11, v30, 4, v31
v_subrev_u32 v11, 1024, v11
v_add_u32 v26, 128, v25
v_mul_u32_u24 v27, 2731, v26
v_lshrrev_b32_e64 v27, 16, v27
v_mul_u32_u24 v28, 24, v27
v_sub_u32 v28, v26, v28
v_add_u32 v27, s39, v27
v_lshrrev_b32 v29, 1, v27
v_and_b32 v30, 7, v29
v_xor_b32 v30, v30, v28
v_mul_u32_u24 v31, 384, v27
v_lshl_add_u32 v9, v30, 4, v31
v_subrev_u32 v9, 2048, v9
v_and_b32 v30, 3, v29
v_lshlrev_b32 v30, 1, v30
v_xor_b32_e64 v30, v30, v28
v_lshl_add_u32 v12, v30, 4, v31
v_subrev_u32 v12, 2048, v12
s_waitcnt lgkmcnt(0)
s_add_u32 s4, s4, s49
s_addc_u32 s5, s5, 0
s_add_u32 s10, s10, s49
s_addc_u32 s11, s11, 0
s_add_u32 s12, s4, s31
s_addc_u32 s13, s5, 0
s_mov_b32 s14, 98304
s_mov_b32 s15, 0x20000
s_add_u32 s16, s6, s31
s_addc_u32 s17, s7, 0
s_mov_b32 s18, 196608
s_mov_b32 s19, 0x20000
s_add_u32 s20, s8, s31
s_addc_u32 s21, s9, 0
s_mov_b32 s22, 196608
s_mov_b32 s23, 0x20000
s_add_u32 s24, s10, s31
s_addc_u32 s25, s11, 0
s_mov_b32 s26, 98304
s_mov_b32 s27, 0x20000
s_mov_b32 s26, 0
s_mul_i32 s39, s3, 3072
s_mov_b32 s32, 0
s_add_u32 s35, s39, 0
s_mov_b32 s33, 49152
s_add_u32 s36, s39, 49152
s_mov_b32 s34, 98304
s_add_u32 s37, s39, 98304
s_add_u32 m0, s35, 36864
s_mov_b32 s38, 0
buffer_load_dwordx4 v7, s[12:15], s38 offen sc1 nt lds
buffer_load_dwordx4 v8, s[12:15], s38 offen offset:1024 sc1 nt lds
buffer_load_dwordx4 v9, s[12:15], s38 offen offset:2048 sc1 nt lds
s_add_u32 m0, s36, 0
s_mov_b32 s38, 12288
buffer_load_dwordx4 v7, s[12:15], s38 offen sc1 nt lds
buffer_load_dwordx4 v8, s[12:15], s38 offen offset:1024 sc1 nt lds
buffer_load_dwordx4 v9, s[12:15], s38 offen offset:2048 sc1 nt lds
s_add_u32 m0, s36, 12288
s_mov_b32 s38, 24576
buffer_load_dwordx4 v7, s[12:15], s38 offen sc1 nt lds
buffer_load_dwordx4 v8, s[12:15], s38 offen offset:1024 sc1 nt lds
buffer_load_dwordx4 v9, s[12:15], s38 offen offset:2048 sc1 nt lds
s_add_u32 m0, s36, 24576
s_mov_b32 s38, 36864
buffer_load_dwordx4 v7, s[12:15], s38 offen sc1 nt lds
buffer_load_dwordx4 v8, s[12:15], s38 offen offset:1024 sc1 nt lds
buffer_load_dwordx4 v9, s[12:15], s38 offen offset:2048 sc1 nt lds
s_add_u32 m0, s36, 36864
s_mov_b32 s38, 49152
buffer_load_dwordx4 v7, s[12:15], s38 offen sc1 nt lds
buffer_load_dwordx4 v8, s[12:15], s38 offen offset:1024 sc1 nt lds
buffer_load_dwordx4 v9, s[12:15], s38 offen offset:2048 sc1 nt lds
s_add_u32 m0, s37, 0
s_mov_b32 s38, 61440
buffer_load_dwordx4 v7, s[12:15], s38 offen sc1 nt lds
buffer_load_dwordx4 v8, s[12:15], s38 offen offset:1024 sc1 nt lds
buffer_load_dwordx4 v9, s[12:15], s38 offen offset:2048 sc1 nt lds
s_add_u32 m0, s37, 12288
s_mov_b32 s38, 73728
buffer_load_dwordx4 v7, s[12:15], s38 offen sc1 nt lds
buffer_load_dwordx4 v8, s[12:15], s38 offen offset:1024 sc1 nt lds
buffer_load_dwordx4 v9, s[12:15], s38 offen offset:2048 sc1 nt lds
s_add_u32 m0, s37, 24576
s_mov_b32 s38, 86016
buffer_load_dwordx4 v7, s[12:15], s38 offen sc1 nt lds
buffer_load_dwordx4 v8, s[12:15], s38 offen offset:1024 sc1 nt lds
buffer_load_dwordx4 v9, s[12:15], s38 offen offset:2048 sc1 nt lds
s_lshr_b32 s91, s2, 3
s_and_b32 s91, s91, 3
s_mul_i32 s91, s91, 4
s_add_u32 s91, s91, s3
s_mov_b32 s90, 4
s_mov_b64 exec, 0
L_warm_go:
s_cmp_eq_u32 s91, 0
s_cbranch_scc1 L_pad0
s_cmp_eq_u32 s91, 1
s_cbranch_scc1 L_pad1
s_cmp_eq_u32 s91, 2
s_cbranch_scc1 L_pad2
s_cmp_eq_u32 s91, 3
s_cbranch_scc1 L_pad3
s_cmp_eq_u32 s91, 4
s_cbranch_scc1 L_pad4
s_cmp_eq_u32 s91, 5
s_cbranch_scc1 L_pad5
s_cmp_eq_u32 s91, 6
s_cbranch_scc1 L_pad6
s_cmp_eq_u32 s91, 7
s_cbranch_scc1 L_pad7
s_cmp_eq_u32 s91, 8
s_cbranch_scc1 L_pad8
s_cmp_eq_u32 s91, 9
s_cbranch_scc1 L_pad9
L_warm_next:
s_add_u32 s91, s91, 4
s_and_b32 s91, s91, 15
s_sub_u32 s90, s90, 1
s_cmp_lg_u32 s90, 0
s_cbranch_scc1 L_warm_go
s_mov_b64 exec, -1
s_add_u32 m0, s37, 36864
s_mov_b32 s38, 0
buffer_load_dwordx4 v7, s[16:19], s38 offen  lds
buffer_load_dwordx4 v8, s[16:19], s38 offen offset:1024  lds
buffer_load_dwordx4 v9, s[16:19], s38 offen offset:2048  lds
s_add_u32 m0, s35, 0
s_mov_b32 s38, 12288
buffer_load_dwordx4 v7, s[16:19], s38 offen  lds
buffer_load_dwordx4 v8, s[16:19], s38 offen offset:1024  lds
buffer_load_dwordx4 v9, s[16:19], s38 offen offset:2048  lds
s_add_u32 m0, s35, 12288
s_mov_b32 s38, 0
buffer_load_dwordx4 v10, s[20:23], s38 offen  lds
buffer_load_dwordx4 v11, s[20:23], s38 offen offset:1024  lds
buffer_load_dwordx4 v12, s[20:23], s38 offen offset:2048  lds
s_add_u32 m0, s35, 24576
s_mov_b32 s38, 24576
buffer_load_dwordx4 v7, s[16:19], s38 offen  lds
buffer_load_dwordx4 v8, s[16:19], s38 offen offset:1024  lds
buffer_load_dwordx4 v9, s[16:19], s38 offen offset:2048  lds
s_mov_b32 s28, 0x3dd53b95
s_mov_b32 s42, 0xbdd53b95
s_mov_b32 s29, 0x40004000
s_mov_b32 s30, 0
v_and_b32 v26, 15, v25
v_mov_b32 v27, 0x3f803f80
v_cmp_eq_u32 vcc, 0, v26
s_nop 1
v_cndmask_b32 v180, 0, v27, vcc
v_cndmask_b32 v181, 0, v27, vcc
v_cndmask_b32 v182, 0, v27, vcc
v_cndmask_b32 v183, 0, v27, vcc
s_mov_b32 s67, 0xc1800000
v_and_b32 v26, 15, v25
v_lshrrev_b32 v27, 4, v25
v_mul_u32_u24 v28, 384, v26
v_bfe_u32 v29, v26, 1, 3
v_add_u32 v30, 0, v27
v_xor_b32 v30, v30, v29
v_lshl_add_u32 v1, v30, 4, v28
v_add_u32 v30, 4, v27
v_xor_b32 v30, v30, v29
v_lshl_add_u32 v2, v30, 4, v28
v_lshrrev_b32_e64 v28, 2, v26
v_lshl_add_u32 v28, v27, 2, v28
v_bfe_u32 v29, v28, 1, 2
v_lshlrev_b32_e64 v29, 1, v29
v_mul_u32_u24 v28, 384, v28
v_bfe_u32 v30, v26, 1, 1
v_lshl_add_u32 v28, v30, 4, v28
v_and_b32_e64 v30, 1, v26
v_lshl_add_u32 v28, v30, 3, v28
v_xor_b32_e64 v30, 0, v29
v_lshl_add_u32 v3, v30, 4, v28
v_xor_b32_e64 v30, 2, v29
v_lshl_add_u32 v4, v30, 4, v28
v_xor_b32_e64 v30, 4, v29
v_lshl_add_u32 v5, v30, 4, v28
v_xor_b32 v30, 6, v29
v_lshl_add_u32 v6, v30, 4, v28
s_lshl_b32 s39, s3, 12
s_add_u32 s39, s39, 147456
v_lshlrev_b32 v28, 7, v26
v_and_b32 v30, 1, v27
v_lshl_add_u32 v28, v30, 3, v28
v_add_u32 v28, s39, v28
v_and_b32 v29, 7, v26
v_lshrrev_b32 v30, 1, v27
v_xor_b32 v29, v29, v30
v_lshl_add_u32 v15, v29, 4, v28
v_lshrrev_b32 v26, 3, v25
v_and_b32 v28, 7, v25
v_xor_b32 v29, v28, v26
v_lshlrev_b32 v30, 7, v26
v_lshl_add_u32 v30, v29, 4, v30
v_add_u32_e64 v13, s39, v30
s_lshl_b32 s48, s3, 6
v_add_u32 v26, s48, v26
v_mul_u32_u24 v26, 384, v26
v_lshl_add_u32 v14, v28, 4, v26
s_lshl_b32 s39, s3, 1
s_add_u32 s39, s39, 7
s_cmp_ge_u32 s39, 12
s_cselect_b32 s48, 12, 0
s_sub_u32 s39, s39, s48
s_mul_i32 s46, s39, 12288
s_lshl_b32 s39, s3, 1
s_add_u32 s39, s39, 8
s_cmp_ge_u32 s39, 12
s_cselect_b32 s48, 12, 0
s_sub_u32 s39, s39, s48
s_mul_i32 s47, s39, 12288
s_waitcnt vmcnt(12)
s_barrier
s_add_u32 s39, s46, 98304
s_cmp_ge_u32 s39, 147456
s_cselect_b32 s48, 147456, 0
s_sub_u32 s39, s39, s48
s_sub_u32 s39, s39, s32
v_add_u32 v24, s39, v1
v_add_u32 v25, s39, v2
s_add_u32 s39, s47, 98304
s_cmp_ge_u32 s39, 147456
s_cselect_b32 s48, 147456, 0
s_sub_u32 s39, s39, s48
s_sub_u32 s39, s39, s32
v_add_u32 v26, s39, v1
v_add_u32 v27, s39, v2
ds_read_b128 a[160:163], v24 offset:0
ds_read_b128 a[164:167], v25 offset:0
ds_read_b128 a[168:171], v24 offset:128
ds_read_b128 a[172:175], v25 offset:128
ds_read_b128 a[176:179], v24 offset:256
ds_read_b128 a[180:183], v25 offset:256
ds_read_b128 a[184:187], v24 offset:6144
ds_read_b128 a[188:191], v25 offset:6144
ds_read_b128 a[192:195], v24 offset:6272
ds_read_b128 a[196:199], v25 offset:6272
ds_read_b128 a[200:203], v24 offset:6400
ds_read_b128 a[204:207], v25 offset:6400
ds_read_b128 a[208:211], v26 offset:0
ds_read_b128 a[212:215], v27 offset:0
ds_read_b128 a[216:219], v26 offset:128
ds_read_b128 a[220:223], v27 offset:128
ds_read_b128 a[224:227], v26 offset:256
ds_read_b128 a[228:231], v27 offset:256
ds_read_b128 a[232:235], v26 offset:6144
ds_read_b128 a[236:239], v27 offset:6144
ds_read_b128 a[240:243], v26 offset:6272
ds_read_b128 a[244:247], v27 offset:6272
ds_read_b128 a[248:251], v26 offset:6400
ds_read_b128 a[252:255], v27 offset:6400
s_waitcnt lgkmcnt(0)
s_barrier
s_add_u32 m0, s35, 36864
s_mov_b32 s38, 12288
buffer_load_dwordx4 v10, s[20:23], s38 offen  lds
buffer_load_dwordx4 v11, s[20:23], s38 offen offset:1024  lds
buffer_load_dwordx4 v12, s[20:23], s38 offen offset:2048  lds
s_branch L_item
.p2align 12
L_item:
L_pad0:
s_cbranch_execz L_warm_next
s_waitcnt vmcnt(9)
s_barrier
s_sub_u32 s51, s34, s32
v_add_u32 v1, s51, v1
v_add_u32 v2, s51, v2
ds_read_b128 v[160:163], v1 offset:36864
ds_read_b128 v[164:167], v1 offset:43008
ds_read_b128 v[168:171], v2 offset:36864
s_waitcnt lgkmcnt(2)
v_mfma_f32_16x16x32_bf16 v[64:67], v[160:163], a[160:163], 0
s_add_u32 m0, s36, 0
ds_read_b128 v[172:175], v2 offset:43008
v_mfma_f32_16x16x32_bf16 v[72:75], v[160:163], a[184:187], 0
s_mov_b32 s38, 36864
v_mfma_f32_16x16x32_bf16 v[80:83], v[160:163], a[208:211], 0
buffer_load_dwordx4 v7, s[16:19], s38 offen  lds
v_mfma_f32_16x16x32_bf16 v[88:91], v[160:163], a[232:235], 0
s_waitcnt lgkmcnt(2)
ds_read_b128 v[128:131], v13 offset:0
v_mfma_f32_16x16x32_bf16 v[68:71], v[164:167], a[160:163], 0
ds_read_b128 v[160:163], v1 offset:36992
ds_read_b128 v[132:135], v13 offset:1024
v_mfma_f32_16x16x32_bf16 v[76:79], v[164:167], a[184:187], 0
v_mfma_f32_16x16x32_bf16 v[84:87], v[164:167], a[208:211], 0
buffer_load_dwordx4 v8, s[16:19], s38 offen offset:1024  lds
v_mfma_f32_16x16x32_bf16 v[92:95], v[164:167], a[232:235], 0
s_waitcnt lgkmcnt(4)
ds_read_b128 v[136:139], v13 offset:2048
v_mfma_f32_16x16x32_bf16 v[64:67], v[168:171], a[164:167], v[64:67]
ds_read_b128 v[164:167], v1 offset:43136
ds_read_b128 v[140:143], v13 offset:3072
v_mfma_f32_16x16x32_bf16 v[72:75], v[168:171], a[188:191], v[72:75]
ds_write_b64 v15, v[144:145] offset:0
v_mfma_f32_16x16x32_bf16 v[80:83], v[168:171], a[212:215], v[80:83]
buffer_load_dwordx4 v9, s[16:19], s38 offen offset:2048  lds
v_mfma_f32_16x16x32_bf16 v[88:91], v[168:171], a[236:239], v[88:91]
s_waitcnt lgkmcnt(7)
v_mfma_f32_16x16x32_bf16 v[68:71], v[172:175], a[164:167], v[68:71]
ds_read_b128 v[168:171], v2 offset:36992
v_xor_b32 v31, 32, v15
v_mfma_f32_16x16x32_bf16 v[76:79], v[172:175], a[188:191], v[76:79]
s_mov_b32 s50, 0
ds_write_b64 v31, v[146:147] offset:0
v_mfma_f32_16x16x32_bf16 v[84:87], v[172:175], a[212:215], v[84:87]
s_waitcnt lgkmcnt(8)
buffer_store_dwordx4 v[128:131], v14, s[24:27], s50 offen sc1 nt
v_mfma_f32_16x16x32_bf16 v[92:95], v[172:175], a[236:239], v[92:95]
s_waitcnt lgkmcnt(7)
v_mfma_f32_16x16x32_bf16 v[64:67], v[160:163], a[168:171], v[64:67]
ds_read_b128 v[172:175], v2 offset:43136
v_xor_b32 v31, 64, v15
v_mfma_f32_16x16x32_bf16 v[72:75], v[160:163], a[192:195], v[72:75]
ds_write_b64 v31, v[148:149] offset:0
v_mfma_f32_16x16x32_bf16 v[80:83], v[160:163], a[216:219], v[80:83]
v_mfma_f32_16x16x32_bf16 v[88:91], v[160:163], a[240:243], v[88:91]
s_waitcnt lgkmcnt(6)
v_mfma_f32_16x16x32_bf16 v[68:71], v[164:167], a[168:171], v[68:71]
ds_read_b128 v[160:163], v1 offset:37120
v_xor_b32 v31, 96, v15
v_mfma_f32_16x16x32_bf16 v[76:79], v[164:167], a[192:195], v[76:79]
ds_write_b64 v31, v[150:151] offset:0
v_mfma_f32_16x16x32_bf16 v[84:87], v[164:167], a[216:219], v[84:87]
v_mfma_f32_16x16x32_bf16 v[92:95], v[164:167], a[240:243], v[92:95]
s_waitcnt lgkmcnt(5)
v_mfma_f32_16x16x32_bf16 v[64:67], v[168:171], a[172:175], v[64:67]
ds_read_b128 v[164:167], v1 offset:43264
v_mfma_f32_16x16x32_bf16 v[72:75], v[168:171], a[196:199], v[72:75]
ds_write_b64 v15, v[152:153] offset:2048
v_mfma_f32_16x16x32_bf16 v[80:83], v[168:171], a[220:223], v[80:83]
v_mfma_f32_16x16x32_bf16 v[88:91], v[168:171], a[244:247], v[88:91]
s_waitcnt lgkmcnt(5)
v_mfma_f32_16x16x32_bf16 v[68:71], v[172:175], a[172:175], v[68:71]
ds_read_b128 v[168:171], v2 offset:37120
v_xor_b32 v31, 32, v15
v_mfma_f32_16x16x32_bf16 v[76:79], v[172:175], a[196:199], v[76:79]
s_mov_b32 s50, 3072
ds_write_b64 v31, v[154:155] offset:2048
v_mfma_f32_16x16x32_bf16 v[84:87], v[172:175], a[220:223], v[84:87]
buffer_store_dwordx4 v[132:135], v14, s[24:27], s50 offen sc1 nt
v_mfma_f32_16x16x32_bf16 v[92:95], v[172:175], a[244:247], v[92:95]
s_waitcnt lgkmcnt(5)
v_mfma_f32_16x16x32_bf16 v[64:67], v[160:163], a[176:179], v[64:67]
ds_read_b128 v[172:175], v2 offset:43264
v_xor_b32 v31, 64, v15
v_mfma_f32_16x16x32_bf16 v[72:75], v[160:163], a[200:203], v[72:75]
s_sub_u32 s51, s32, s34
ds_write_b64 v31, v[156:157] offset:2048
v_add_u32 v1, s51, v1
v_add_u32 v2, s51, v2
v_mfma_f32_16x16x32_bf16 v[80:83], v[160:163], a[224:227], v[80:83]
v_mfma_f32_16x16x32_bf16 v[88:91], v[160:163], a[248:251], v[88:91]
s_waitcnt lgkmcnt(5)
v_mfma_f32_16x16x32_bf16 v[68:71], v[164:167], a[176:179], v[68:71]
ds_read_b128 v[160:163], v1 offset:0
v_xor_b32 v31, 96, v15
v_mfma_f32_16x16x32_bf16 v[76:79], v[164:167], a[200:203], v[76:79]
ds_write_b64 v31, v[158:159] offset:2048
v_mfma_f32_16x16x32_bf16 v[84:87], v[164:167], a[224:227], v[84:87]
v_mfma_f32_16x16x32_bf16 v[92:95], v[164:167], a[248:251], v[92:95]
s_waitcnt lgkmcnt(5)
ds_read_b128 v[144:147], v13 offset:0
v_mfma_f32_16x16x32_bf16 v[64:67], v[168:171], a[180:183], v[64:67]
ds_read_b128 v[164:167], v1 offset:6144
ds_read_b128 v[148:151], v13 offset:1024
v_mfma_f32_16x16x32_bf16 v[72:75], v[168:171], a[204:207], v[72:75]
v_mfma_f32_16x16x32_bf16 v[80:83], v[168:171], a[228:231], v[80:83]
v_mfma_f32_16x16x32_bf16 v[88:91], v[168:171], a[252:255], v[88:91]
s_waitcnt lgkmcnt(6)
ds_read_b128 v[152:155], v13 offset:2048
v_mfma_f32_16x16x32_bf16 v[68:71], v[172:175], a[180:183], v[68:71]
ds_read_b128 v[168:171], v2 offset:0
ds_read_b128 v[156:159], v13 offset:3072
v_mfma_f32_16x16x32_bf16 v[76:79], v[172:175], a[204:207], v[76:79]
v_mfma_f32_16x16x32_bf16 v[84:87], v[172:175], a[228:231], v[84:87]
v_mfma_f32_16x16x32_bf16 v[92:95], v[172:175], a[252:255], v[92:95]
s_waitcnt lgkmcnt(7)
v_mfma_f32_16x16x32_bf16 v[96:99], v[160:163], a[160:163], 0
ds_read_b128 v[172:175], v2 offset:6144
v_mfma_f32_16x16x32_bf16 v[104:107], v[160:163], a[184:187], 0
v_mfma_f32_16x16x32_bf16 v[112:115], v[160:163], a[208:211], 0
s_waitcnt vmcnt(11)
s_barrier
v_mfma_f32_16x16x32_bf16 v[120:123], v[160:163], a[232:235], 0
s_waitcnt lgkmcnt(5)
v_max3_f32 v16, v64, v65, v66
v_max3_f32 v17, v72, v73, v74
v_mfma_f32_16x16x32_bf16 v[100:103], v[164:167], a[160:163], 0
ds_read_b128 v[160:163], v1 offset:128
v_max3_f32 v18, v80, v81, v82
v_mfma_f32_16x16x32_bf16 v[108:111], v[164:167], a[184:187], 0
s_mov_b32 s50, 6144
v_max3_f32 v19, v88, v89, v90
v_max3_f32 v16, v16, v67, v68
v_mfma_f32_16x16x32_bf16 v[116:119], v[164:167], a[208:211], 0
s_add_u32 m0, s36, 12288
buffer_store_dwordx4 v[136:139], v14, s[24:27], s50 offen sc1 nt
v_mfma_f32_16x16x32_bf16 v[124:127], v[164:167], a[232:235], 0
s_waitcnt lgkmcnt(3)
v_max3_f32 v17, v17, v75, v76
v_max3_f32 v18, v18, v83, v84
v_mfma_f32_16x16x32_bf16 v[96:99], v[168:171], a[164:167], v[96:99]
s_mov_b32 s38, 24576
ds_read_b128 v[164:167], v1 offset:6272
v_max3_f32 v19, v19, v91, v92
v_mfma_f32_16x16x32_bf16 v[104:107], v[168:171], a[188:191], v[104:107]
buffer_load_dwordx4 v10, s[20:23], s38 offen  lds
v_mfma_f32_16x16x32_bf16 v[112:115], v[168:171], a[212:215], v[112:115]
v_max3_f32 v16, v16, v69, v70
v_max3_f32 v17, v17, v77, v78
v_mfma_f32_16x16x32_bf16 v[120:123], v[168:171], a[236:239], v[120:123]
s_waitcnt lgkmcnt(2)
v_max3_f32 v18, v18, v85, v86
v_max3_f32 v19, v19, v93, v94
v_mfma_f32_16x16x32_bf16 v[100:103], v[172:175], a[164:167], v[100:103]
ds_read_b128 v[168:171], v2 offset:128
v_max_f32_e64 v16, v16, v71
v_mfma_f32_16x16x32_bf16 v[108:111], v[172:175], a[188:191], v[108:111]
v_max_f32 v17, v17, v79
v_max_f32 v18, v18, v87
v_mfma_f32_16x16x32_bf16 v[116:119], v[172:175], a[212:215], v[116:119]
v_max_f32_e64 v19, v19, v95
v_mfma_f32_16x16x32_bf16 v[124:127], v[172:175], a[236:239], v[124:127]
s_waitcnt lgkmcnt(2)
v_permlane16_swap_b32 v16, v17
v_max_f32 v16, v16, v17
v_mfma_f32_16x16x32_bf16 v[96:99], v[160:163], a[168:171], v[96:99]
ds_read_b128 v[172:175], v2 offset:6272
v_permlane16_swap_b32 v18, v19
v_mfma_f32_16x16x32_bf16 v[104:107], v[160:163], a[192:195], v[104:107]
s_mov_b32 s50, 9216
v_max_f32_e64 v18, v18, v19
v_mfma_f32_16x16x32_bf16 v[112:115], v[160:163], a[216:219], v[112:115]
buffer_store_dwordx4 v[140:143], v14, s[24:27], s50 offen sc1 nt
v_mfma_f32_16x16x32_bf16 v[120:123], v[160:163], a[240:243], v[120:123]
s_waitcnt lgkmcnt(2)
v_permlane32_swap_b32 v16, v18
v_max_f32_e64 v16, v16, v18
v_mfma_f32_16x16x32_bf16 v[100:103], v[164:167], a[168:171], v[100:103]
ds_read_b128 v[160:163], v1 offset:256
v_mul_f32_e64 v16, s42, v16
v_mfma_f32_16x16x32_bf16 v[108:111], v[164:167], a[192:195], v[108:111]
buffer_load_dwordx4 v11, s[20:23], s38 offen offset:1024  lds
v_mfma_f32_16x16x32_bf16 v[116:119], v[164:167], a[216:219], v[116:119]
v_add_f32_e64 v16, s67, v16
v_mov_b32 v18, v16
v_mfma_f32_16x16x32_bf16 v[124:127], v[164:167], a[240:243], v[124:127]
s_waitcnt lgkmcnt(2)
v_mfma_f32_16x16x32_bf16 v[96:99], v[168:171], a[172:175], v[96:99]
ds_read_b128 v[164:167], v1 offset:6400
v_permlane32_swap_b32 v16, v18
v_mfma_f32_16x16x32_bf16 v[104:107], v[168:171], a[196:199], v[104:107]
v_mov_b32 v17, v16
v_mov_b32 v19, v18
v_mfma_f32_16x16x32_bf16 v[112:115], v[168:171], a[220:223], v[112:115]
v_mfma_f32_16x16x32_bf16 v[120:123], v[168:171], a[244:247], v[120:123]
s_waitcnt lgkmcnt(2)
v_permlane16_swap_b32 v16, v17
v_permlane16_swap_b32 v18, v19
v_mfma_f32_16x16x32_bf16 v[100:103], v[172:175], a[172:175], v[100:103]
ds_read_b128 v[168:171], v2 offset:256
v_fma_f32 v24, v64, s28, v16
v_mfma_f32_16x16x32_bf16 v[108:111], v[172:175], a[196:199], v[108:111]
v_exp_f32_e64 v24, v24
v_mfma_f32_16x16x32_bf16 v[116:119], v[172:175], a[220:223], v[116:119]
v_fma_f32 v25, v65, s28, v16
v_fma_f32 v26, v66, s28, v16
v_mfma_f32_16x16x32_bf16 v[124:127], v[172:175], a[244:247], v[124:127]
s_waitcnt lgkmcnt(2)
v_exp_f32 v25, v25
v_mfma_f32_16x16x32_bf16 v[96:99], v[160:163], a[176:179], v[96:99]
ds_read_b128 v[172:175], v2 offset:6400
v_cvt_pk_bf16_f32 v128, v24, v25
v_mfma_f32_16x16x32_bf16 v[104:107], v[160:163], a[200:203], v[104:107]
buffer_load_dwordx4 v12, s[20:23], s38 offen offset:2048  lds
v_mfma_f32_16x16x32_bf16 v[112:115], v[160:163], a[224:227], v[112:115]
v_exp_f32 v26, v26
v_mfma_f32_16x16x32_bf16 v[120:123], v[160:163], a[248:251], v[120:123]
s_waitcnt lgkmcnt(2)
v_fma_f32 v27, v67, s28, v16
v_fma_f32 v28, v68, s28, v16
v_mfma_f32_16x16x32_bf16 v[100:103], v[164:167], a[176:179], v[100:103]
ds_read_b64_tr_b16 v[160:161], v3 offset:12288
ds_read_b64_tr_b16 v[162:163], v3 offset:18432
v_mfma_f32_16x16x32_bf16 v[108:111], v[164:167], a[200:203], v[108:111]
v_exp_f32_e64 v27, v27
v_mfma_f32_16x16x32_bf16 v[116:119], v[164:167], a[224:227], v[116:119]
v_cvt_pk_bf16_f32 v129, v26, v27
v_fma_f32 v29, v69, s28, v16
v_mfma_f32_16x16x32_bf16 v[124:127], v[164:167], a[248:251], v[124:127]
s_waitcnt lgkmcnt(3)
v_exp_f32 v28, v28
v_mfma_f32_16x16x32_bf16 v[96:99], v[168:171], a[180:183], v[96:99]
ds_read_b64_tr_b16 v[164:165], v4 offset:12288
ds_read_b64_tr_b16 v[166:167], v4 offset:18432
v_mfma_f32_16x16x32_bf16 v[104:107], v[168:171], a[204:207], v[104:107]
v_exp_f32_e64 v29, v29
v_mfma_f32_16x16x32_bf16 v[112:115], v[168:171], a[228:231], v[112:115]
v_cvt_pk_bf16_f32 v130, v28, v29
v_fma_f32 v24, v70, s28, v16
v_mfma_f32_16x16x32_bf16 v[120:123], v[168:171], a[252:255], v[120:123]
s_waitcnt lgkmcnt(4)
v_exp_f32 v24, v24
v_mfma_f32_16x16x32_bf16 v[100:103], v[172:175], a[180:183], v[100:103]
ds_read_b64_tr_b16 v[168:169], v5 offset:12288
ds_read_b64_tr_b16 v[170:171], v5 offset:18432
v_mfma_f32_16x16x32_bf16 v[108:111], v[172:175], a[204:207], v[108:111]
v_fma_f32 v25, v71, s28, v16
v_fma_f32 v26, v72, s28, v17
v_mfma_f32_16x16x32_bf16 v[116:119], v[172:175], a[228:231], v[116:119]
v_exp_f32_e64 v25, v25
v_mfma_f32_16x16x32_bf16 v[124:127], v[172:175], a[252:255], v[124:127]
v_cvt_pk_bf16_f32 v131, v24, v25
v_fma_f32 v27, v73, s28, v17
v_exp_f32_e64 v26, v26
v_exp_f32 v27, v27
s_nop 0
v_cvt_pk_bf16_f32 v132, v26, v27
v_fma_f32 v28, v74, s28, v17
v_exp_f32_e64 v28, v28
v_fma_f32 v29, v75, s28, v17
v_exp_f32 v29, v29
s_nop 0
v_cvt_pk_bf16_f32 v133, v28, v29
v_fma_f32 v24, v76, s28, v17
v_exp_f32_e64 v24, v24
v_fma_f32 v25, v77, s28, v17
v_exp_f32 v25, v25
s_nop 0
v_cvt_pk_bf16_f32 v134, v24, v25
v_fma_f32 v26, v78, s28, v17
v_exp_f32_e64 v26, v26
v_fma_f32 v27, v79, s28, v17
v_exp_f32 v27, v27
s_nop 0
v_cvt_pk_bf16_f32 v135, v26, v27
v_fma_f32 v28, v80, s28, v18
v_exp_f32_e64 v28, v28
v_fma_f32 v29, v81, s28, v18
v_exp_f32 v29, v29
s_nop 0
v_cvt_pk_bf16_f32 v136, v28, v29
v_fma_f32 v24, v82, s28, v18
v_exp_f32_e64 v24, v24
v_fma_f32 v25, v83, s28, v18
v_exp_f32 v25, v25
s_nop 0
v_cvt_pk_bf16_f32 v137, v24, v25
v_fma_f32 v26, v84, s28, v18
v_exp_f32_e64 v26, v26
v_fma_f32 v27, v85, s28, v18
v_exp_f32 v27, v27
s_nop 0
v_cvt_pk_bf16_f32 v138, v26, v27
v_fma_f32 v28, v86, s28, v18
v_exp_f32_e64 v28, v28
v_fma_f32 v29, v87, s28, v18
v_exp_f32 v29, v29
s_nop 0
v_cvt_pk_bf16_f32 v139, v28, v29
v_fma_f32 v24, v88, s28, v19
v_exp_f32_e64 v24, v24
v_fma_f32 v25, v89, s28, v19
v_exp_f32 v25, v25
s_nop 0
v_cvt_pk_bf16_f32 v140, v24, v25
v_fma_f32 v26, v90, s28, v19
v_exp_f32_e64 v26, v26
v_fma_f32 v27, v91, s28, v19
v_exp_f32 v27, v27
s_nop 0
v_cvt_pk_bf16_f32 v141, v26, v27
v_fma_f32 v28, v92, s28, v19
v_exp_f32_e64 v28, v28
v_fma_f32 v29, v93, s28, v19
v_exp_f32 v29, v29
s_nop 0
v_cvt_pk_bf16_f32 v142, v28, v29
v_fma_f32 v24, v94, s28, v19
v_exp_f32_e64 v24, v24
v_fma_f32 v25, v95, s28, v19
v_exp_f32 v25, v25
s_nop 0
v_cvt_pk_bf16_f32 v143, v24, v25
v_mfma_f32_16x16x32_bf16 v[20:23], v[180:183], v[128:131], 0
v_mfma_f32_16x16x32_bf16 v[176:179], v[180:183], v[132:135], 0
s_mov_b32 s94, 128
v_fma_f32 v24, v96, s28, v16
v_fma_f32 v25, v97, s28, v16
v_mfma_f32_16x16x32_bf16 v[184:187], v[180:183], v[136:139], 0
buffer_store_dwordx4 v[144:147], v14, s[24:27], s94 offen sc1 nt
v_mfma_f32_16x16x32_bf16 v[188:191], v[180:183], v[140:143], 0
s_waitcnt lgkmcnt(4)
v_exp_f32 v24, v24
v_mfma_f32_16x16x32_bf16 a[0:3], v[160:163], v[128:131], 0
ds_read_b64_tr_b16 v[172:173], v6 offset:12288
ds_read_b64_tr_b16 v[174:175], v6 offset:18432
v_mfma_f32_16x16x32_bf16 a[40:43], v[160:163], v[132:135], 0
v_exp_f32_e64 v25, v25
v_mfma_f32_16x16x32_bf16 a[80:83], v[160:163], v[136:139], 0
v_cvt_pk_bf16_f32 v144, v24, v25
v_fma_f32 v26, v98, s28, v16
v_mfma_f32_16x16x32_bf16 a[120:123], v[160:163], v[140:143], 0
s_waitcnt lgkmcnt(4)
v_exp_f32 v26, v26
v_mfma_f32_16x16x32_bf16 a[4:7], v[164:167], v[128:131], 0
ds_read_b64_tr_b16 v[160:161], v3 offset:12416
ds_read_b64_tr_b16 v[162:163], v3 offset:18560
v_mfma_f32_16x16x32_bf16 a[44:47], v[164:167], v[132:135], 0
v_fma_f32 v27, v99, s28, v16
v_fma_f32 v28, v100, s28, v16
v_mfma_f32_16x16x32_bf16 a[84:87], v[164:167], v[136:139], 0
v_exp_f32 v27, v27
v_mfma_f32_16x16x32_bf16 a[124:127], v[164:167], v[140:143], 0
s_waitcnt lgkmcnt(4)
v_cvt_pk_bf16_f32 v145, v26, v27
v_fma_f32 v29, v101, s28, v16
v_mfma_f32_16x16x32_bf16 a[8:11], v[168:171], v[128:131], 0
ds_read_b64_tr_b16 v[164:165], v4 offset:12416
ds_read_b64_tr_b16 v[166:167], v4 offset:18560
v_mfma_f32_16x16x32_bf16 a[48:51], v[168:171], v[132:135], 0
s_waitcnt vmcnt(11)
s_barrier
v_mfma_f32_16x16x32_bf16 a[88:91], v[168:171], v[136:139], 0
s_add_u32 m0, s36, 24576
v_exp_f32_e64 v28, v28
v_mfma_f32_16x16x32_bf16 a[128:131], v[168:171], v[140:143], 0
s_waitcnt lgkmcnt(4)
v_exp_f32 v29, v29
v_mfma_f32_16x16x32_bf16 a[12:15], v[172:175], v[128:131], 0
s_mov_b32 s38, 49152
ds_read_b64_tr_b16 v[168:169], v5 offset:12416
ds_read_b64_tr_b16 v[170:171], v5 offset:18560
v_mfma_f32_16x16x32_bf16 a[52:55], v[172:175], v[132:135], 0
buffer_load_dwordx4 v7, s[16:19], s38 offen  lds
v_mfma_f32_16x16x32_bf16 a[92:95], v[172:175], v[136:139], 0
v_cvt_pk_bf16_f32 v146, v28, v29
v_or3_b32 v30, v144, v145, v146
v_mfma_f32_16x16x32_bf16 a[132:135], v[172:175], v[140:143], 0
s_waitcnt lgkmcnt(4)
v_fma_f32 v24, v102, s28, v16
v_fma_f32 v25, v103, s28, v16
v_mfma_f32_16x16x32_bf16 a[16:19], v[160:163], v[128:131], 0
ds_read_b64_tr_b16 v[172:173], v6 offset:12416
ds_read_b64_tr_b16 v[174:175], v6 offset:18560
v_mfma_f32_16x16x32_bf16 a[56:59], v[160:163], v[132:135], 0
s_mov_b32 s94, 3200
v_exp_f32 v24, v24
v_mfma_f32_16x16x32_bf16 a[96:99], v[160:163], v[136:139], 0
buffer_store_dwordx4 v[148:151], v14, s[24:27], s94 offen sc1 nt
v_mfma_f32_16x16x32_bf16 a[136:139], v[160:163], v[140:143], 0
s_waitcnt lgkmcnt(4)
v_exp_f32 v25, v25
v_mfma_f32_16x16x32_bf16 a[20:23], v[164:167], v[128:131], 0
ds_read_b64_tr_b16 v[160:161], v3 offset:12544
ds_read_b64_tr_b16 v[162:163], v3 offset:18688
v_mfma_f32_16x16x32_bf16 a[60:63], v[164:167], v[132:135], 0
buffer_load_dwordx4 v8, s[16:19], s38 offen offset:1024  lds
v_mfma_f32_16x16x32_bf16 a[100:103], v[164:167], v[136:139], 0
v_cvt_pk_bf16_f32 v147, v24, v25
v_fma_f32 v26, v104, s28, v17
v_mfma_f32_16x16x32_bf16 a[140:143], v[164:167], v[140:143], 0
s_waitcnt lgkmcnt(4)
v_exp_f32 v26, v26
v_mfma_f32_16x16x32_bf16 a[24:27], v[168:171], v[128:131], 0
ds_read_b64_tr_b16 v[164:165], v4 offset:12544
ds_read_b64_tr_b16 v[166:167], v4 offset:18688
v_mfma_f32_16x16x32_bf16 a[64:67], v[168:171], v[132:135], 0
v_fma_f32 v27, v105, s28, v17
v_fma_f32 v28, v106, s28, v17
v_mfma_f32_16x16x32_bf16 a[104:107], v[168:171], v[136:139], 0
v_exp_f32 v27, v27
v_mfma_f32_16x16x32_bf16 a[144:147], v[168:171], v[140:143], 0
s_waitcnt lgkmcnt(4)
v_cvt_pk_bf16_f32 v148, v26, v27
v_or3_b32 v30, v30, v147, v148
v_mfma_f32_16x16x32_bf16 a[28:31], v[172:175], v[128:131], 0
ds_read_b64_tr_b16 v[168:169], v5 offset:12544
ds_read_b64_tr_b16 v[170:171], v5 offset:18688
v_mfma_f32_16x16x32_bf16 a[68:71], v[172:175], v[132:135], 0
v_exp_f32 v28, v28
v_mfma_f32_16x16x32_bf16 a[108:111], v[172:175], v[136:139], 0
buffer_load_dwordx4 v9, s[16:19], s38 offen offset:2048  lds
v_mfma_f32_16x16x32_bf16 a[148:151], v[172:175], v[140:143], 0
s_waitcnt lgkmcnt(4)
v_fma_f32 v29, v107, s28, v17
v_fma_f32 v24, v108, s28, v17
v_mfma_f32_16x16x32_bf16 a[32:35], v[160:163], v[128:131], 0
ds_read_b64_tr_b16 v[172:173], v6 offset:12544
ds_read_b64_tr_b16 v[174:175], v6 offset:18688
v_mfma_f32_16x16x32_bf16 a[72:75], v[160:163], v[132:135], 0
v_exp_f32_e64 v29, v29
v_mfma_f32_16x16x32_bf16 a[112:115], v[160:163], v[136:139], 0
v_cvt_pk_bf16_f32 v149, v28, v29
v_fma_f32 v25, v109, s28, v17
v_mfma_f32_16x16x32_bf16 a[152:155], v[160:163], v[140:143], 0
s_waitcnt lgkmcnt(4)
v_exp_f32 v24, v24
v_mfma_f32_16x16x32_bf16 a[36:39], v[164:167], v[128:131], 0
ds_read_b128 v[160:163], v1 offset:24576
v_fma_f32 v26, v110, s28, v17
v_mfma_f32_16x16x32_bf16 a[76:79], v[164:167], v[132:135], 0
v_exp_f32_e64 v25, v25
v_mfma_f32_16x16x32_bf16 a[116:119], v[164:167], v[136:139], 0
s_add_u32 m0, s36, 36864
v_cvt_pk_bf16_f32 v150, v24, v25
v_or3_b32 v30, v30, v149, v150
v_mfma_f32_16x16x32_bf16 a[156:159], v[164:167], v[140:143], 0
s_waitcnt lgkmcnt(3)
v_exp_f32 v26, v26
v_mfma_f32_16x16x32_bf16 v[32:35], v[168:171], v[128:131], 0
s_mov_b32 s38, 36864
ds_read_b128 v[164:167], v1 offset:30720
v_fma_f32 v27, v111, s28, v17
v_mfma_f32_16x16x32_bf16 v[40:43], v[168:171], v[132:135], 0
buffer_load_dwordx4 v10, s[20:23], s38 offen  lds
v_mfma_f32_16x16x32_bf16 v[48:51], v[168:171], v[136:139], 0
v_exp_f32 v27, v27
v_mfma_f32_16x16x32_bf16 v[56:59], v[168:171], v[140:143], 0
s_waitcnt lgkmcnt(2)
v_cvt_pk_bf16_f32 v151, v26, v27
v_fma_f32 v28, v112, s28, v18
v_mfma_f32_16x16x32_bf16 v[36:39], v[172:175], v[128:131], 0
ds_read_b128 v[168:171], v2 offset:24576
v_fma_f32 v29, v113, s28, v18
v_mfma_f32_16x16x32_bf16 v[44:47], v[172:175], v[132:135], 0
v_exp_f32_e64 v28, v28
v_mfma_f32_16x16x32_bf16 v[52:55], v[172:175], v[136:139], 0
v_exp_f32 v29, v29
v_mfma_f32_16x16x32_bf16 v[60:63], v[172:175], v[140:143], 0
s_waitcnt lgkmcnt(2)
v_fma_f32 v24, v114, s28, v18
v_fma_f32 v25, v115, s28, v18
v_mfma_f32_16x16x32_bf16 v[64:67], v[160:163], a[160:163], 0
s_mov_b32 s94, 6272
ds_read_b128 v[172:175], v2 offset:30720
v_fma_f32 v26, v116, s28, v18
v_mfma_f32_16x16x32_bf16 v[72:75], v[160:163], a[184:187], 0
buffer_store_dwordx4 v[152:155], v14, s[24:27], s94 offen sc1 nt
v_mfma_f32_16x16x32_bf16 v[80:83], v[160:163], a[208:211], 0
buffer_load_dwordx4 v11, s[20:23], s38 offen offset:1024  lds
v_mfma_f32_16x16x32_bf16 v[88:91], v[160:163], a[232:235], 0
s_waitcnt lgkmcnt(2)
v_cvt_pk_bf16_f32 v152, v28, v29
v_or3_b32 v30, v30, v151, v152
v_mfma_f32_16x16x32_bf16 v[68:71], v[164:167], a[160:163], 0
ds_read_b128 v[160:163], v1 offset:24704
v_fma_f32 v27, v117, s28, v18
v_mfma_f32_16x16x32_bf16 v[76:79], v[164:167], a[184:187], 0
ds_write_b64 v15, v[192:193] offset:0
v_mfma_f32_16x16x32_bf16 v[84:87], v[164:167], a[208:211], 0
v_exp_f32 v24, v24
v_mfma_f32_16x16x32_bf16 v[92:95], v[164:167], a[232:235], 0
s_waitcnt lgkmcnt(3)
v_exp_f32 v25, v25
v_mfma_f32_16x16x32_bf16 v[64:67], v[168:171], a[164:167], v[64:67]
ds_read_b128 v[164:167], v1 offset:30848
v_cvt_pk_bf16_f32 v153, v24, v25
v_mfma_f32_16x16x32_bf16 v[72:75], v[168:171], a[188:191], v[72:75]
v_exp_f32_e64 v26, v26
v_mfma_f32_16x16x32_bf16 v[80:83], v[168:171], a[212:215], v[80:83]
v_exp_f32 v27, v27
v_mfma_f32_16x16x32_bf16 v[88:91], v[168:171], a[236:239], v[88:91]
s_waitcnt lgkmcnt(3)
v_cvt_pk_bf16_f32 v154, v26, v27
v_or3_b32 v30, v30, v153, v154
v_mfma_f32_16x16x32_bf16 v[68:71], v[172:175], a[164:167], v[68:71]
ds_read_b128 v[168:171], v2 offset:24704
v_fma_f32 v28, v118, s28, v18
v_mfma_f32_16x16x32_bf16 v[76:79], v[172:175], a[188:191], v[76:79]
buffer_load_dwordx4 v12, s[20:23], s38 offen offset:2048  lds
v_mfma_f32_16x16x32_bf16 v[84:87], v[172:175], a[212:215], v[84:87]
v_exp_f32 v28, v28
v_mfma_f32_16x16x32_bf16 v[92:95], v[172:175], a[236:239], v[92:95]
s_waitcnt lgkmcnt(3)
v_fma_f32 v29, v119, s28, v18
v_fma_f32 v24, v120, s28, v19
v_mfma_f32_16x16x32_bf16 v[64:67], v[160:163], a[168:171], v[64:67]
ds_read_b128 v[172:175], v2 offset:30848
v_xor_b32_e64 v31, 32, v15
v_mfma_f32_16x16x32_bf16 v[72:75], v[160:163], a[192:195], v[72:75]
s_mov_b32 s94, 9344
ds_write_b64 v31, v[194:195] offset:0
v_mfma_f32_16x16x32_bf16 v[80:83], v[160:163], a[216:219], v[80:83]
buffer_store_dwordx4 v[156:159], v14, s[24:27], s94 offen sc1 nt
v_mfma_f32_16x16x32_bf16 v[88:91], v[160:163], a[240:243], v[88:91]
s_waitcnt lgkmcnt(3)
v_exp_f32 v29, v29
v_mfma_f32_16x16x32_bf16 v[68:71], v[164:167], a[168:171], v[68:71]
ds_read_b128 v[160:163], v1 offset:24832
v_cvt_pk_bf16_f32 v155, v28, v29
v_mfma_f32_16x16x32_bf16 v[76:79], v[164:167], a[192:195], v[76:79]
v_exp_f32_e64 v24, v24
v_mfma_f32_16x16x32_bf16 v[84:87], v[164:167], a[216:219], v[84:87]
v_fma_f32 v25, v121, s28, v19
v_fma_f32 v26, v122, s28, v19
v_mfma_f32_16x16x32_bf16 v[92:95], v[164:167], a[240:243], v[92:95]
s_waitcnt lgkmcnt(3)
v_exp_f32 v25, v25
v_mfma_f32_16x16x32_bf16 v[64:67], v[168:171], a[172:175], v[64:67]
s_add_u32 m0, s37, 0
ds_read_b128 v[164:167], v1 offset:30976
v_xor_b32 v31, 64, v15
v_mfma_f32_16x16x32_bf16 v[72:75], v[168:171], a[196:199], v[72:75]
s_mov_b32 s38, 61440
ds_write_b64 v31, v[196:197] offset:0
v_mfma_f32_16x16x32_bf16 v[80:83], v[168:171], a[220:223], v[80:83]
buffer_load_dwordx4 v7, s[16:19], s38 offen  lds
v_mfma_f32_16x16x32_bf16 v[88:91], v[168:171], a[244:247], v[88:91]
s_waitcnt lgkmcnt(4)
v_cvt_pk_bf16_f32 v156, v24, v25
v_or3_b32 v30, v30, v155, v156
v_mfma_f32_16x16x32_bf16 v[68:71], v[172:175], a[172:175], v[68:71]
ds_read_b128 v[168:171], v2 offset:24832
v_fma_f32 v27, v123, s28, v19
v_mfma_f32_16x16x32_bf16 v[76:79], v[172:175], a[196:199], v[76:79]
v_exp_f32 v26, v26
v_mfma_f32_16x16x32_bf16 v[84:87], v[172:175], a[220:223], v[84:87]
v_exp_f32 v27, v27
v_mfma_f32_16x16x32_bf16 v[92:95], v[172:175], a[244:247], v[92:95]
s_waitcnt lgkmcnt(3)
v_cvt_pk_bf16_f32 v157, v26, v27
v_fma_f32 v28, v124, s28, v19
v_mfma_f32_16x16x32_bf16 v[64:67], v[160:163], a[176:179], v[64:67]
ds_read_b128 v[172:175], v2 offset:30976
v_fma_f32 v29, v125, s28, v19
v_mfma_f32_16x16x32_bf16 v[72:75], v[160:163], a[200:203], v[72:75]
buffer_load_dwordx4 v8, s[16:19], s38 offen offset:1024  lds
v_mfma_f32_16x16x32_bf16 v[80:83], v[160:163], a[224:227], v[80:83]
v_exp_f32 v28, v28
v_mfma_f32_16x16x32_bf16 v[88:91], v[160:163], a[248:251], v[88:91]
s_waitcnt lgkmcnt(3)
v_xor_b32 v31, 96, v15
v_fma_f32 v24, v126, s28, v19
v_mfma_f32_16x16x32_bf16 v[68:71], v[164:167], a[176:179], v[68:71]
ds_read_b64_tr_b16 v[160:161], v3 offset:36864
ds_read_b64_tr_b16 v[162:163], v3 offset:43008
v_mfma_f32_16x16x32_bf16 v[76:79], v[164:167], a[200:203], v[76:79]
L_pad1:
s_cbranch_execz L_warm_next
ds_write_b64 v31, v[198:199] offset:0
v_mfma_f32_16x16x32_bf16 v[84:87], v[164:167], a[224:227], v[84:87]
v_exp_f32_e64 v29, v29
v_mfma_f32_16x16x32_bf16 v[92:95], v[164:167], a[248:251], v[92:95]
s_waitcnt lgkmcnt(4)
v_cvt_pk_bf16_f32 v158, v28, v29
v_or3_b32 v30, v30, v157, v158
v_mfma_f32_16x16x32_bf16 v[64:67], v[168:171], a[180:183], v[64:67]
ds_read_b64_tr_b16 v[164:165], v4 offset:36864
ds_read_b64_tr_b16 v[166:167], v4 offset:43008
v_mfma_f32_16x16x32_bf16 v[72:75], v[168:171], a[204:207], v[72:75]
v_exp_f32_e64 v24, v24
v_mfma_f32_16x16x32_bf16 v[80:83], v[168:171], a[228:231], v[80:83]
v_fma_f32 v25, v127, s28, v19
v_mfma_f32_16x16x32_bf16 v[88:91], v[168:171], a[252:255], v[88:91]
s_waitcnt lgkmcnt(5)
v_exp_f32 v25, v25
v_mfma_f32_16x16x32_bf16 v[68:71], v[172:175], a[180:183], v[68:71]
ds_read_b64_tr_b16 v[168:169], v5 offset:36864
ds_read_b64_tr_b16 v[170:171], v5 offset:43008
v_mfma_f32_16x16x32_bf16 v[76:79], v[172:175], a[204:207], v[76:79]
buffer_load_dwordx4 v9, s[16:19], s38 offen offset:2048  lds
v_mfma_f32_16x16x32_bf16 v[84:87], v[172:175], a[228:231], v[84:87]
v_cvt_pk_bf16_f32 v159, v24, v25
v_or_b32_e64 v30, v30, v159
v_mfma_f32_16x16x32_bf16 v[92:95], v[172:175], a[252:255], v[92:95]
v_and_b32_e64 v30, s29, v30
v_cmp_ne_u32 vcc, 0, v30
s_cbranch_vccnz L_tr1
L_bk1:
v_mfma_f32_16x16x32_bf16 v[20:23], v[180:183], v[144:147], v[20:23]
v_mfma_f32_16x16x32_bf16 v[176:179], v[180:183], v[148:151], v[176:179]
v_fma_f32 v24, v64, s28, v16
v_fma_f32 v25, v65, s28, v16
v_mfma_f32_16x16x32_bf16 v[184:187], v[180:183], v[152:155], v[184:187]
v_exp_f32_e64 v24, v24
v_mfma_f32_16x16x32_bf16 v[188:191], v[180:183], v[156:159], v[188:191]
s_waitcnt lgkmcnt(5)
v_exp_f32 v25, v25
v_mfma_f32_16x16x32_bf16 a[0:3], v[160:163], v[144:147], a[0:3]
ds_read_b64_tr_b16 v[172:173], v6 offset:36864
ds_read_b64_tr_b16 v[174:175], v6 offset:43008
v_mfma_f32_16x16x32_bf16 a[40:43], v[160:163], v[148:151], a[40:43]
v_cvt_pk_bf16_f32 v128, v24, v25
v_fma_f32 v26, v66, s28, v16
v_mfma_f32_16x16x32_bf16 a[80:83], v[160:163], v[152:155], a[80:83]
v_exp_f32 v26, v26
v_mfma_f32_16x16x32_bf16 a[120:123], v[160:163], v[156:159], a[120:123]
s_waitcnt lgkmcnt(4)
v_fma_f32 v27, v67, s28, v16
v_fma_f32 v28, v68, s28, v16
v_mfma_f32_16x16x32_bf16 a[4:7], v[164:167], v[144:147], a[4:7]
ds_read_b64_tr_b16 v[160:161], v3 offset:36992
ds_read_b64_tr_b16 v[162:163], v3 offset:43136
v_mfma_f32_16x16x32_bf16 a[44:47], v[164:167], v[148:151], a[44:47]
v_exp_f32_e64 v27, v27
v_mfma_f32_16x16x32_bf16 a[84:87], v[164:167], v[152:155], a[84:87]
v_cvt_pk_bf16_f32 v129, v26, v27
v_fma_f32 v29, v69, s28, v16
v_mfma_f32_16x16x32_bf16 a[124:127], v[164:167], v[156:159], a[124:127]
s_waitcnt lgkmcnt(4)
v_exp_f32 v28, v28
v_mfma_f32_16x16x32_bf16 a[8:11], v[168:171], v[144:147], a[8:11]
ds_read_b64_tr_b16 v[164:165], v4 offset:36992
ds_read_b64_tr_b16 v[166:167], v4 offset:43136
v_mfma_f32_16x16x32_bf16 a[48:51], v[168:171], v[148:151], a[48:51]
s_waitcnt vmcnt(13)
s_barrier
v_mfma_f32_16x16x32_bf16 a[88:91], v[168:171], v[152:155], a[88:91]
s_add_u32 m0, s37, 12288
v_exp_f32 v29, v29
v_mfma_f32_16x16x32_bf16 a[128:131], v[168:171], v[156:159], a[128:131]
s_waitcnt lgkmcnt(4)
v_cvt_pk_bf16_f32 v130, v28, v29
v_or3_b32 v30, v128, v129, v130
v_mfma_f32_16x16x32_bf16 a[12:15], v[172:175], v[144:147], a[12:15]
s_mov_b32 s38, 49152
ds_read_b64_tr_b16 v[168:169], v5 offset:36992
ds_read_b64_tr_b16 v[170:171], v5 offset:43136
v_mfma_f32_16x16x32_bf16 a[52:55], v[172:175], v[148:151], a[52:55]
buffer_load_dwordx4 v10, s[20:23], s38 offen  lds
v_mfma_f32_16x16x32_bf16 a[92:95], v[172:175], v[152:155], a[92:95]
v_fma_f32 v24, v70, s28, v16
v_fma_f32 v25, v71, s28, v16
v_mfma_f32_16x16x32_bf16 a[132:135], v[172:175], v[156:159], a[132:135]
s_waitcnt lgkmcnt(4)
v_exp_f32 v24, v24
v_mfma_f32_16x16x32_bf16 a[16:19], v[160:163], v[144:147], a[16:19]
ds_read_b64_tr_b16 v[172:173], v6 offset:36992
ds_read_b64_tr_b16 v[174:175], v6 offset:43136
v_mfma_f32_16x16x32_bf16 a[56:59], v[160:163], v[148:151], a[56:59]
v_exp_f32_e64 v25, v25
v_mfma_f32_16x16x32_bf16 a[96:99], v[160:163], v[152:155], a[96:99]
v_cvt_pk_bf16_f32 v131, v24, v25
v_fma_f32 v26, v72, s28, v17
v_mfma_f32_16x16x32_bf16 a[136:139], v[160:163], v[156:159], a[136:139]
s_waitcnt lgkmcnt(4)
v_exp_f32 v26, v26
v_mfma_f32_16x16x32_bf16 a[20:23], v[164:167], v[144:147], a[20:23]
ds_read_b64_tr_b16 v[160:161], v3 offset:37120
ds_read_b64_tr_b16 v[162:163], v3 offset:43264
v_mfma_f32_16x16x32_bf16 a[60:63], v[164:167], v[148:151], a[60:63]
buffer_load_dwordx4 v11, s[20:23], s38 offen offset:1024  lds
v_mfma_f32_16x16x32_bf16 a[100:103], v[164:167], v[152:155], a[100:103]
v_fma_f32 v27, v73, s28, v17
v_fma_f32 v28, v74, s28, v17
v_mfma_f32_16x16x32_bf16 a[140:143], v[164:167], v[156:159], a[140:143]
s_waitcnt lgkmcnt(4)
v_exp_f32 v27, v27
v_mfma_f32_16x16x32_bf16 a[24:27], v[168:171], v[144:147], a[24:27]
ds_read_b64_tr_b16 v[164:165], v4 offset:37120
ds_read_b64_tr_b16 v[166:167], v4 offset:43264
v_mfma_f32_16x16x32_bf16 a[64:67], v[168:171], v[148:151], a[64:67]
v_cvt_pk_bf16_f32 v132, v26, v27
v_or3_b32 v30, v30, v131, v132
v_mfma_f32_16x16x32_bf16 a[104:107], v[168:171], v[152:155], a[104:107]
v_exp_f32 v28, v28
v_mfma_f32_16x16x32_bf16 a[144:147], v[168:171], v[156:159], a[144:147]
s_waitcnt lgkmcnt(4)
v_fma_f32 v29, v75, s28, v17
v_fma_f32 v24, v76, s28, v17
v_mfma_f32_16x16x32_bf16 a[28:31], v[172:175], v[144:147], a[28:31]
ds_read_b64_tr_b16 v[168:169], v5 offset:37120
ds_read_b64_tr_b16 v[170:171], v5 offset:43264
v_mfma_f32_16x16x32_bf16 a[68:71], v[172:175], v[148:151], a[68:71]
v_exp_f32_e64 v29, v29
v_mfma_f32_16x16x32_bf16 a[108:111], v[172:175], v[152:155], a[108:111]
buffer_load_dwordx4 v12, s[20:23], s38 offen offset:2048  lds
v_mfma_f32_16x16x32_bf16 a[148:151], v[172:175], v[156:159], a[148:151]
s_waitcnt lgkmcnt(4)
v_cvt_pk_bf16_f32 v133, v28, v29
v_fma_f32 v25, v77, s28, v17
v_mfma_f32_16x16x32_bf16 a[32:35], v[160:163], v[144:147], a[32:35]
s_sub_u32 s51, s33, s32
ds_read_b64_tr_b16 v[172:173], v6 offset:37120
ds_read_b64_tr_b16 v[174:175], v6 offset:43264
v_mfma_f32_16x16x32_bf16 a[72:75], v[160:163], v[148:151], a[72:75]
v_add_u32 v1, s51, v1
v_add_u32 v2, s51, v2
v_mfma_f32_16x16x32_bf16 a[112:115], v[160:163], v[152:155], a[112:115]
v_exp_f32_e64 v24, v24
v_mfma_f32_16x16x32_bf16 a[152:155], v[160:163], v[156:159], a[152:155]
s_waitcnt lgkmcnt(4)
v_exp_f32 v25, v25
v_mfma_f32_16x16x32_bf16 a[36:39], v[164:167], v[144:147], a[36:39]
ds_read_b128 v[160:163], v1 offset:0
v_cvt_pk_bf16_f32 v134, v24, v25
v_mfma_f32_16x16x32_bf16 a[76:79], v[164:167], v[148:151], a[76:79]
v_or3_b32 v30, v30, v133, v134
v_fma_f32 v26, v78, s28, v17
v_mfma_f32_16x16x32_bf16 a[116:119], v[164:167], v[152:155], a[116:119]
s_add_u32 m0, s37, 24576
v_exp_f32 v26, v26
v_mfma_f32_16x16x32_bf16 a[156:159], v[164:167], v[156:159], a[156:159]
s_waitcnt lgkmcnt(3)
v_fma_f32 v27, v79, s28, v17
v_fma_f32 v28, v80, s28, v18
v_mfma_f32_16x16x32_bf16 v[32:35], v[168:171], v[144:147], v[32:35]
s_mov_b32 s38, 73728
ds_read_b128 v[164:167], v1 offset:6144
v_fma_f32 v29, v81, s28, v18
v_mfma_f32_16x16x32_bf16 v[40:43], v[168:171], v[148:151], v[40:43]
buffer_load_dwordx4 v7, s[16:19], s38 offen  lds
v_mfma_f32_16x16x32_bf16 v[48:51], v[168:171], v[152:155], v[48:51]
v_exp_f32 v27, v27
v_mfma_f32_16x16x32_bf16 v[56:59], v[168:171], v[156:159], v[56:59]
s_waitcnt lgkmcnt(2)
v_cvt_pk_bf16_f32 v135, v26, v27
v_fma_f32 v24, v82, s28, v18
v_mfma_f32_16x16x32_bf16 v[36:39], v[172:175], v[144:147], v[36:39]
ds_read_b128 v[168:171], v2 offset:0
v_fma_f32 v25, v83, s28, v18
v_mfma_f32_16x16x32_bf16 v[44:47], v[172:175], v[148:151], v[44:47]
v_exp_f32_e64 v28, v28
v_mfma_f32_16x16x32_bf16 v[52:55], v[172:175], v[152:155], v[52:55]
v_exp_f32 v29, v29
v_mfma_f32_16x16x32_bf16 v[60:63], v[172:175], v[156:159], v[60:63]
s_waitcnt lgkmcnt(2)
v_cvt_pk_bf16_f32 v136, v28, v29
v_or3_b32 v30, v30, v135, v136
v_mfma_f32_16x16x32_bf16 v[96:99], v[160:163], a[160:163], 0
ds_read_b128 v[172:175], v2 offset:6144
v_fma_f32 v26, v84, s28, v18
v_mfma_f32_16x16x32_bf16 v[104:107], v[160:163], a[184:187], 0
v_exp_f32_e64 v24, v24
v_mfma_f32_16x16x32_bf16 v[112:115], v[160:163], a[208:211], 0
buffer_load_dwordx4 v8, s[16:19], s38 offen offset:1024  lds
v_mfma_f32_16x16x32_bf16 v[120:123], v[160:163], a[232:235], 0
s_waitcnt lgkmcnt(2)
v_exp_f32 v25, v25
v_mfma_f32_16x16x32_bf16 v[100:103], v[164:167], a[160:163], 0
ds_read_b128 v[160:163], v1 offset:128
v_cvt_pk_bf16_f32 v137, v24, v25
v_mfma_f32_16x16x32_bf16 v[108:111], v[164:167], a[184:187], 0
ds_write_b64 v15, v[200:201] offset:2048
v_mfma_f32_16x16x32_bf16 v[116:119], v[164:167], a[208:211], 0
v_exp_f32 v26, v26
v_mfma_f32_16x16x32_bf16 v[124:127], v[164:167], a[232:235], 0
s_waitcnt lgkmcnt(3)
v_fma_f32 v27, v85, s28, v18
v_fma_f32 v28, v86, s28, v18
v_mfma_f32_16x16x32_bf16 v[96:99], v[168:171], a[164:167], v[96:99]
ds_read_b128 v[164:167], v1 offset:6272
v_fma_f32 v29, v87, s28, v18
v_mfma_f32_16x16x32_bf16 v[104:107], v[168:171], a[188:191], v[104:107]
v_exp_f32_e64 v27, v27
v_mfma_f32_16x16x32_bf16 v[112:115], v[168:171], a[212:215], v[112:115]
v_cvt_pk_bf16_f32 v138, v26, v27
v_or3_b32 v30, v30, v137, v138
v_mfma_f32_16x16x32_bf16 v[120:123], v[168:171], a[236:239], v[120:123]
s_waitcnt lgkmcnt(3)
v_exp_f32 v28, v28
v_mfma_f32_16x16x32_bf16 v[100:103], v[172:175], a[164:167], v[100:103]
ds_read_b128 v[168:171], v2 offset:128
v_fma_f32 v24, v88, s28, v19
v_mfma_f32_16x16x32_bf16 v[108:111], v[172:175], a[188:191], v[108:111]
buffer_load_dwordx4 v9, s[16:19], s38 offen offset:2048  lds
v_mfma_f32_16x16x32_bf16 v[116:119], v[172:175], a[212:215], v[116:119]
v_exp_f32 v29, v29
v_mfma_f32_16x16x32_bf16 v[124:127], v[172:175], a[236:239], v[124:127]
s_waitcnt lgkmcnt(3)
v_cvt_pk_bf16_f32 v139, v28, v29
v_fma_f32 v25, v89, s28, v19
v_mfma_f32_16x16x32_bf16 v[96:99], v[160:163], a[168:171], v[96:99]
ds_read_b128 v[172:175], v2 offset:6272
v_xor_b32_e64 v31, 32, v15
v_mfma_f32_16x16x32_bf16 v[104:107], v[160:163], a[192:195], v[104:107]
ds_write_b64 v31, v[202:203] offset:2048
v_mfma_f32_16x16x32_bf16 v[112:115], v[160:163], a[216:219], v[112:115]
v_exp_f32_e64 v24, v24
v_mfma_f32_16x16x32_bf16 v[120:123], v[160:163], a[240:243], v[120:123]
s_waitcnt lgkmcnt(3)
v_exp_f32 v25, v25
v_mfma_f32_16x16x32_bf16 v[100:103], v[164:167], a[168:171], v[100:103]
ds_read_b128 v[160:163], v1 offset:256
v_cvt_pk_bf16_f32 v140, v24, v25
v_mfma_f32_16x16x32_bf16 v[108:111], v[164:167], a[192:195], v[108:111]
v_or3_b32 v30, v30, v139, v140
v_fma_f32 v26, v90, s28, v19
v_mfma_f32_16x16x32_bf16 v[116:119], v[164:167], a[216:219], v[116:119]
v_exp_f32 v26, v26
v_mfma_f32_16x16x32_bf16 v[124:127], v[164:167], a[240:243], v[124:127]
s_waitcnt lgkmcnt(3)
v_fma_f32 v27, v91, s28, v19
v_fma_f32 v28, v92, s28, v19
v_mfma_f32_16x16x32_bf16 v[96:99], v[168:171], a[172:175], v[96:99]
s_add_u32 m0, s37, 36864
ds_read_b128 v[164:167], v1 offset:6400
v_xor_b32_e64 v31, 64, v15
v_mfma_f32_16x16x32_bf16 v[104:107], v[168:171], a[196:199], v[104:107]
s_mov_b32 s38, 61440
ds_write_b64 v31, v[204:205] offset:2048
v_mfma_f32_16x16x32_bf16 v[112:115], v[168:171], a[220:223], v[112:115]
buffer_load_dwordx4 v10, s[20:23], s38 offen  lds
v_mfma_f32_16x16x32_bf16 v[120:123], v[168:171], a[244:247], v[120:123]
s_waitcnt lgkmcnt(4)
v_exp_f32 v27, v27
v_mfma_f32_16x16x32_bf16 v[100:103], v[172:175], a[172:175], v[100:103]
s_sub_u32 s51, s33, s32
ds_read_b128 v[168:171], v2 offset:256
v_add_u32 v3, s51, v3
v_mfma_f32_16x16x32_bf16 v[108:111], v[172:175], a[196:199], v[108:111]
v_add_u32 v4, s51, v4
v_add_u32 v5, s51, v5
v_mfma_f32_16x16x32_bf16 v[116:119], v[172:175], a[220:223], v[116:119]
v_add_u32_e64 v6, s51, v6
v_cvt_pk_bf16_f32 v141, v26, v27
v_mfma_f32_16x16x32_bf16 v[124:127], v[172:175], a[244:247], v[124:127]
s_waitcnt lgkmcnt(3)
v_exp_f32 v28, v28
v_mfma_f32_16x16x32_bf16 v[96:99], v[160:163], a[176:179], v[96:99]
ds_read_b128 v[172:175], v2 offset:6400
v_fma_f32 v29, v93, s28, v19
v_mfma_f32_16x16x32_bf16 v[104:107], v[160:163], a[200:203], v[104:107]
buffer_load_dwordx4 v11, s[20:23], s38 offen offset:1024  lds
v_mfma_f32_16x16x32_bf16 v[112:115], v[160:163], a[224:227], v[112:115]
v_exp_f32 v29, v29
v_mfma_f32_16x16x32_bf16 v[120:123], v[160:163], a[248:251], v[120:123]
s_waitcnt lgkmcnt(3)
v_xor_b32 v31, 96, v15
v_cvt_pk_bf16_f32 v142, v28, v29
v_mfma_f32_16x16x32_bf16 v[100:103], v[164:167], a[176:179], v[100:103]
ds_read_b64_tr_b16 v[160:161], v3 offset:12288
ds_read_b64_tr_b16 v[162:163], v3 offset:18432
v_mfma_f32_16x16x32_bf16 v[108:111], v[164:167], a[200:203], v[108:111]
ds_write_b64 v31, v[206:207] offset:2048
v_mfma_f32_16x16x32_bf16 v[116:119], v[164:167], a[224:227], v[116:119]
v_or3_b32 v30, v30, v141, v142
v_fma_f32 v24, v94, s28, v19
v_mfma_f32_16x16x32_bf16 v[124:127], v[164:167], a[248:251], v[124:127]
s_waitcnt lgkmcnt(4)
v_exp_f32 v24, v24
v_mfma_f32_16x16x32_bf16 v[96:99], v[168:171], a[180:183], v[96:99]
ds_read_b64_tr_b16 v[164:165], v4 offset:12288
ds_read_b64_tr_b16 v[166:167], v4 offset:18432
v_mfma_f32_16x16x32_bf16 v[104:107], v[168:171], a[204:207], v[104:107]
ds_read_b128 v[192:195], v13 offset:0
v_fma_f32 v25, v95, s28, v19
v_mfma_f32_16x16x32_bf16 v[112:115], v[168:171], a[228:231], v[112:115]
ds_read_b128 v[196:199], v13 offset:1024
v_mfma_f32_16x16x32_bf16 v[120:123], v[168:171], a[252:255], v[120:123]
s_waitcnt lgkmcnt(7)
ds_read_b128 v[200:203], v13 offset:2048
v_mfma_f32_16x16x32_bf16 v[100:103], v[172:175], a[180:183], v[100:103]
ds_read_b64_tr_b16 v[168:169], v5 offset:12288
ds_read_b64_tr_b16 v[170:171], v5 offset:18432
v_mfma_f32_16x16x32_bf16 v[108:111], v[172:175], a[204:207], v[108:111]
ds_read_b128 v[204:207], v13 offset:3072
v_mfma_f32_16x16x32_bf16 v[116:119], v[172:175], a[228:231], v[116:119]
buffer_load_dwordx4 v12, s[20:23], s38 offen offset:2048  lds
v_mfma_f32_16x16x32_bf16 v[124:127], v[172:175], a[252:255], v[124:127]
v_exp_f32 v25, v25
s_nop 0
v_cvt_pk_bf16_f32 v143, v24, v25
v_or_b32 v30, v30, v143
v_and_b32_e64 v30, s29, v30
v_cmp_ne_u32 vcc, 0, v30
s_cbranch_vccnz L_tr2
L_bk2:
v_mfma_f32_16x16x32_bf16 v[20:23], v[180:183], v[128:131], v[20:23]
v_mfma_f32_16x16x32_bf16 v[176:179], v[180:183], v[132:135], v[176:179]
v_fma_f32 v24, v96, s28, v16
v_fma_f32 v25, v97, s28, v16
v_mfma_f32_16x16x32_bf16 v[184:187], v[180:183], v[136:139], v[184:187]
v_exp_f32_e64 v24, v24
v_mfma_f32_16x16x32_bf16 v[188:191], v[180:183], v[140:143], v[188:191]
s_waitcnt lgkmcnt(9)
v_exp_f32 v25, v25
v_mfma_f32_16x16x32_bf16 a[0:3], v[160:163], v[128:131], a[0:3]
ds_read_b64_tr_b16 v[172:173], v6 offset:12288
ds_read_b64_tr_b16 v[174:175], v6 offset:18432
v_mfma_f32_16x16x32_bf16 a[40:43], v[160:163], v[132:135], a[40:43]
v_cvt_pk_bf16_f32 v144, v24, v25
v_fma_f32 v26, v98, s28, v16
v_mfma_f32_16x16x32_bf16 a[80:83], v[160:163], v[136:139], a[80:83]
v_exp_f32 v26, v26
v_mfma_f32_16x16x32_bf16 a[120:123], v[160:163], v[140:143], a[120:123]
s_waitcnt lgkmcnt(8)
v_fma_f32 v27, v99, s28, v16
v_fma_f32 v28, v100, s28, v16
v_mfma_f32_16x16x32_bf16 a[4:7], v[164:167], v[128:131], a[4:7]
ds_read_b64_tr_b16 v[160:161], v3 offset:12416
ds_read_b64_tr_b16 v[162:163], v3 offset:18560
v_mfma_f32_16x16x32_bf16 a[44:47], v[164:167], v[132:135], a[44:47]
v_exp_f32_e64 v27, v27
v_mfma_f32_16x16x32_bf16 a[84:87], v[164:167], v[136:139], a[84:87]
v_cvt_pk_bf16_f32 v145, v26, v27
v_fma_f32 v29, v101, s28, v16
v_mfma_f32_16x16x32_bf16 a[124:127], v[164:167], v[140:143], a[124:127]
s_waitcnt lgkmcnt(5)
v_exp_f32 v28, v28
v_mfma_f32_16x16x32_bf16 a[8:11], v[168:171], v[128:131], a[8:11]
ds_read_b64_tr_b16 v[164:165], v4 offset:12416
ds_read_b64_tr_b16 v[166:167], v4 offset:18560
v_mfma_f32_16x16x32_bf16 a[48:51], v[168:171], v[132:135], a[48:51]
s_waitcnt vmcnt(13)
s_barrier
v_mfma_f32_16x16x32_bf16 a[88:91], v[168:171], v[136:139], a[88:91]
s_add_u32 m0, s35, 0
v_exp_f32_e64 v29, v29
v_mfma_f32_16x16x32_bf16 a[128:131], v[168:171], v[140:143], a[128:131]
s_waitcnt lgkmcnt(4)
v_cvt_pk_bf16_f32 v146, v28, v29
v_or3_b32 v30, v144, v145, v146
v_mfma_f32_16x16x32_bf16 a[12:15], v[172:175], v[128:131], a[12:15]
s_mov_b32 s38, 86016
ds_read_b64_tr_b16 v[168:169], v5 offset:12416
ds_read_b64_tr_b16 v[170:171], v5 offset:18560
v_mfma_f32_16x16x32_bf16 a[52:55], v[172:175], v[132:135], a[52:55]
buffer_load_dwordx4 v7, s[16:19], s38 offen  lds
v_mfma_f32_16x16x32_bf16 a[92:95], v[172:175], v[136:139], a[92:95]
v_fma_f32 v24, v102, s28, v16
v_fma_f32 v25, v103, s28, v16
v_mfma_f32_16x16x32_bf16 a[132:135], v[172:175], v[140:143], a[132:135]
s_waitcnt lgkmcnt(4)
v_exp_f32 v24, v24
v_mfma_f32_16x16x32_bf16 a[16:19], v[160:163], v[128:131], a[16:19]
ds_read_b64_tr_b16 v[172:173], v6 offset:12416
ds_read_b64_tr_b16 v[174:175], v6 offset:18560
v_mfma_f32_16x16x32_bf16 a[56:59], v[160:163], v[132:135], a[56:59]
v_exp_f32 v25, v25
v_mfma_f32_16x16x32_bf16 a[96:99], v[160:163], v[136:139], a[96:99]
buffer_load_dwordx4 v8, s[16:19], s38 offen offset:1024  lds
v_mfma_f32_16x16x32_bf16 a[136:139], v[160:163], v[140:143], a[136:139]
s_waitcnt lgkmcnt(4)
v_cvt_pk_bf16_f32 v147, v24, v25
v_fma_f32 v26, v104, s28, v17
v_mfma_f32_16x16x32_bf16 a[20:23], v[164:167], v[128:131], a[20:23]
ds_read_b64_tr_b16 v[160:161], v3 offset:12544
ds_read_b64_tr_b16 v[162:163], v3 offset:18688
v_mfma_f32_16x16x32_bf16 a[60:63], v[164:167], v[132:135], a[60:63]
v_exp_f32_e64 v26, v26
v_mfma_f32_16x16x32_bf16 a[100:103], v[164:167], v[136:139], a[100:103]
v_fma_f32 v27, v105, s28, v17
v_fma_f32 v28, v106, s28, v17
v_mfma_f32_16x16x32_bf16 a[140:143], v[164:167], v[140:143], a[140:143]
s_waitcnt lgkmcnt(4)
v_exp_f32 v27, v27
v_mfma_f32_16x16x32_bf16 a[24:27], v[168:171], v[128:131], a[24:27]
ds_read_b64_tr_b16 v[164:165], v4 offset:12544
ds_read_b64_tr_b16 v[166:167], v4 offset:18688
v_mfma_f32_16x16x32_bf16 a[64:67], v[168:171], v[132:135], a[64:67]
v_cvt_pk_bf16_f32 v148, v26, v27
v_or3_b32 v30, v30, v147, v148
v_mfma_f32_16x16x32_bf16 a[104:107], v[168:171], v[136:139], a[104:107]
buffer_load_dwordx4 v9, s[16:19], s38 offen offset:2048  lds
v_mfma_f32_16x16x32_bf16 a[144:147], v[168:171], v[140:143], a[144:147]
s_waitcnt lgkmcnt(4)
v_exp_f32 v28, v28
v_mfma_f32_16x16x32_bf16 a[28:31], v[172:175], v[128:131], a[28:31]
ds_read_b64_tr_b16 v[168:169], v5 offset:12544
ds_read_b64_tr_b16 v[170:171], v5 offset:18688
v_mfma_f32_16x16x32_bf16 a[68:71], v[172:175], v[132:135], a[68:71]
v_fma_f32 v29, v107, s28, v17
v_fma_f32 v24, v108, s28, v17
v_mfma_f32_16x16x32_bf16 a[108:111], v[172:175], v[136:139], a[108:111]
v_exp_f32 v29, v29
v_mfma_f32_16x16x32_bf16 a[148:151], v[172:175], v[140:143], a[148:151]
s_waitcnt lgkmcnt(4)
v_cvt_pk_bf16_f32 v149, v28, v29
v_fma_f32 v25, v109, s28, v17
v_mfma_f32_16x16x32_bf16 a[32:35], v[160:163], v[128:131], a[32:35]
ds_read_b64_tr_b16 v[172:173], v6 offset:12544
ds_read_b64_tr_b16 v[174:175], v6 offset:18688
v_mfma_f32_16x16x32_bf16 a[72:75], v[160:163], v[132:135], a[72:75]
v_exp_f32_e64 v24, v24
v_mfma_f32_16x16x32_bf16 a[112:115], v[160:163], v[136:139], a[112:115]
s_add_u32 m0, s35, 12288
v_exp_f32 v25, v25
v_mfma_f32_16x16x32_bf16 a[152:155], v[160:163], v[140:143], a[152:155]
s_waitcnt lgkmcnt(4)
v_cvt_pk_bf16_f32 v150, v24, v25
v_or3_b32 v30, v30, v149, v150
v_mfma_f32_16x16x32_bf16 a[36:39], v[164:167], v[128:131], a[36:39]
s_mov_b32 s38, 73728
ds_read_b128 v[160:163], v1 offset:24576
v_fma_f32 v26, v110, s28, v17
v_mfma_f32_16x16x32_bf16 a[76:79], v[164:167], v[132:135], a[76:79]
buffer_load_dwordx4 v10, s[20:23], s38 offen  lds
v_mfma_f32_16x16x32_bf16 a[116:119], v[164:167], v[136:139], a[116:119]
v_exp_f32 v26, v26
v_mfma_f32_16x16x32_bf16 a[156:159], v[164:167], v[140:143], a[156:159]
s_waitcnt lgkmcnt(3)
v_fma_f32 v27, v111, s28, v17
v_fma_f32 v28, v112, s28, v18
v_mfma_f32_16x16x32_bf16 v[32:35], v[168:171], v[128:131], v[32:35]
ds_read_b128 v[164:167], v1 offset:30720
v_fma_f32 v29, v113, s28, v18
v_mfma_f32_16x16x32_bf16 v[40:43], v[168:171], v[132:135], v[40:43]
v_exp_f32_e64 v27, v27
v_mfma_f32_16x16x32_bf16 v[48:51], v[168:171], v[136:139], v[48:51]
v_cvt_pk_bf16_f32 v151, v26, v27
v_fma_f32 v24, v114, s28, v18
v_mfma_f32_16x16x32_bf16 v[56:59], v[168:171], v[140:143], v[56:59]
s_waitcnt lgkmcnt(2)
v_exp_f32 v28, v28
v_mfma_f32_16x16x32_bf16 v[36:39], v[172:175], v[128:131], v[36:39]
ds_read_b128 v[168:171], v2 offset:24576
v_fma_f32 v25, v115, s28, v18
v_mfma_f32_16x16x32_bf16 v[44:47], v[172:175], v[132:135], v[44:47]
buffer_load_dwordx4 v11, s[20:23], s38 offen offset:1024  lds
v_mfma_f32_16x16x32_bf16 v[52:55], v[172:175], v[136:139], v[52:55]
v_exp_f32 v29, v29
v_mfma_f32_16x16x32_bf16 v[60:63], v[172:175], v[140:143], v[60:63]
s_waitcnt lgkmcnt(2)
v_cvt_pk_bf16_f32 v152, v28, v29
v_or3_b32 v30, v30, v151, v152
v_mfma_f32_16x16x32_bf16 v[64:67], v[160:163], a[160:163], 0
ds_read_b128 v[172:175], v2 offset:30720
v_fma_f32 v26, v116, s28, v18
v_mfma_f32_16x16x32_bf16 v[72:75], v[160:163], a[184:187], 0
v_exp_f32_e64 v24, v24
v_mfma_f32_16x16x32_bf16 v[80:83], v[160:163], a[208:211], 0
v_exp_f32 v25, v25
v_mfma_f32_16x16x32_bf16 v[88:91], v[160:163], a[232:235], 0
s_waitcnt lgkmcnt(2)
v_cvt_pk_bf16_f32 v153, v24, v25
v_fma_f32 v27, v117, s28, v18
v_mfma_f32_16x16x32_bf16 v[68:71], v[164:167], a[160:163], 0
ds_read_b128 v[160:163], v1 offset:24704
v_fma_f32 v28, v118, s28, v18
v_mfma_f32_16x16x32_bf16 v[76:79], v[164:167], a[184:187], 0
s_mov_b32 s50, 256
ds_write_b64 v15, v[208:209] offset:0
v_mfma_f32_16x16x32_bf16 v[84:87], v[164:167], a[208:211], 0
buffer_store_dwordx4 v[192:195], v14, s[24:27], s50 offen sc1 nt
v_mfma_f32_16x16x32_bf16 v[92:95], v[164:167], a[232:235], 0
s_waitcnt lgkmcnt(3)
v_exp_f32 v26, v26
v_mfma_f32_16x16x32_bf16 v[64:67], v[168:171], a[164:167], v[64:67]
ds_read_b128 v[164:167], v1 offset:30848
v_fma_f32 v29, v119, s28, v18
v_mfma_f32_16x16x32_bf16 v[72:75], v[168:171], a[188:191], v[72:75]
v_exp_f32 v27, v27
v_mfma_f32_16x16x32_bf16 v[80:83], v[168:171], a[212:215], v[80:83]
v_cvt_pk_bf16_f32 v154, v26, v27
v_mfma_f32_16x16x32_bf16 v[88:91], v[168:171], a[236:239], v[88:91]
s_waitcnt lgkmcnt(3)
v_or3_b32 v30, v30, v153, v154
v_fma_f32 v24, v120, s28, v19
v_mfma_f32_16x16x32_bf16 v[68:71], v[172:175], a[164:167], v[68:71]
ds_read_b128 v[168:171], v2 offset:24704
v_fma_f32 v25, v121, s28, v19
v_mfma_f32_16x16x32_bf16 v[76:79], v[172:175], a[188:191], v[76:79]
buffer_load_dwordx4 v12, s[20:23], s38 offen offset:2048  lds
v_mfma_f32_16x16x32_bf16 v[84:87], v[172:175], a[212:215], v[84:87]
v_exp_f32_e64 v28, v28
v_mfma_f32_16x16x32_bf16 v[92:95], v[172:175], a[236:239], v[92:95]
s_waitcnt lgkmcnt(3)
v_exp_f32 v29, v29
v_mfma_f32_16x16x32_bf16 v[64:67], v[160:163], a[168:171], v[64:67]
ds_read_b128 v[172:175], v2 offset:30848
v_xor_b32_e64 v31, 32, v15
v_mfma_f32_16x16x32_bf16 v[72:75], v[160:163], a[192:195], v[72:75]
ds_write_b64 v31, v[210:211] offset:0
v_mfma_f32_16x16x32_bf16 v[80:83], v[160:163], a[216:219], v[80:83]
s_add_u32 m0, s35, 24576
v_cvt_pk_bf16_f32 v155, v28, v29
v_fma_f32 v26, v122, s28, v19
v_mfma_f32_16x16x32_bf16 v[88:91], v[160:163], a[240:243], v[88:91]
s_waitcnt lgkmcnt(3)
v_exp_f32 v24, v24
v_mfma_f32_16x16x32_bf16 v[68:71], v[164:167], a[168:171], v[68:71]
s_mov_b32 s38, 98304
ds_read_b128 v[160:163], v1 offset:24832
v_fma_f32 v27, v123, s28, v19
v_mfma_f32_16x16x32_bf16 v[76:79], v[164:167], a[192:195], v[76:79]
buffer_load_dwordx4 v7, s[16:19], s38 offen  lds
v_mfma_f32_16x16x32_bf16 v[84:87], v[164:167], a[216:219], v[84:87]
v_exp_f32 v25, v25
v_mfma_f32_16x16x32_bf16 v[92:95], v[164:167], a[240:243], v[92:95]
s_waitcnt lgkmcnt(3)
v_cvt_pk_bf16_f32 v156, v24, v25
v_or3_b32 v30, v30, v155, v156
v_mfma_f32_16x16x32_bf16 v[64:67], v[168:171], a[172:175], v[64:67]
ds_read_b128 v[164:167], v1 offset:30976
v_xor_b32_e64 v31, 64, v15
v_mfma_f32_16x16x32_bf16 v[72:75], v[168:171], a[196:199], v[72:75]
ds_write_b64 v31, v[212:213] offset:0
v_mfma_f32_16x16x32_bf16 v[80:83], v[168:171], a[220:223], v[80:83]
v_exp_f32_e64 v26, v26
v_mfma_f32_16x16x32_bf16 v[88:91], v[168:171], a[244:247], v[88:91]
s_waitcnt lgkmcnt(4)
v_exp_f32 v27, v27
v_mfma_f32_16x16x32_bf16 v[68:71], v[172:175], a[172:175], v[68:71]
ds_read_b128 v[168:171], v2 offset:24832
v_cvt_pk_bf16_f32 v157, v26, v27
v_mfma_f32_16x16x32_bf16 v[76:79], v[172:175], a[196:199], v[76:79]
buffer_load_dwordx4 v8, s[16:19], s38 offen offset:1024  lds
v_mfma_f32_16x16x32_bf16 v[84:87], v[172:175], a[220:223], v[84:87]
v_fma_f32 v28, v124, s28, v19
v_fma_f32 v29, v125, s28, v19
v_mfma_f32_16x16x32_bf16 v[92:95], v[172:175], a[244:247], v[92:95]
s_waitcnt lgkmcnt(3)
v_exp_f32 v28, v28
v_mfma_f32_16x16x32_bf16 v[64:67], v[160:163], a[176:179], v[64:67]
ds_read_b128 v[172:175], v2 offset:30976
v_fma_f32 v24, v126, s28, v19
v_mfma_f32_16x16x32_bf16 v[72:75], v[160:163], a[200:203], v[72:75]
v_exp_f32 v29, v29
v_mfma_f32_16x16x32_bf16 v[80:83], v[160:163], a[224:227], v[80:83]
v_cvt_pk_bf16_f32 v158, v28, v29
v_or3_b32 v30, v30, v157, v158
v_mfma_f32_16x16x32_bf16 v[88:91], v[160:163], a[248:251], v[88:91]
s_waitcnt lgkmcnt(3)
v_xor_b32 v31, 96, v15
v_fma_f32 v25, v127, s28, v19
v_mfma_f32_16x16x32_bf16 v[68:71], v[164:167], a[176:179], v[68:71]
L_pad2:
s_cbranch_execz L_warm_next
ds_read_b64_tr_b16 v[160:161], v3 offset:36864
ds_read_b64_tr_b16 v[162:163], v3 offset:43008
v_mfma_f32_16x16x32_bf16 v[76:79], v[164:167], a[200:203], v[76:79]
ds_write_b64 v31, v[214:215] offset:0
v_mfma_f32_16x16x32_bf16 v[84:87], v[164:167], a[224:227], v[84:87]
buffer_load_dwordx4 v9, s[16:19], s38 offen offset:2048  lds
v_mfma_f32_16x16x32_bf16 v[92:95], v[164:167], a[248:251], v[92:95]
s_waitcnt lgkmcnt(4)
v_exp_f32_e64 v24, v24
v_mfma_f32_16x16x32_bf16 v[64:67], v[168:171], a[180:183], v[64:67]
ds_read_b64_tr_b16 v[164:165], v4 offset:36864
ds_read_b64_tr_b16 v[166:167], v4 offset:43008
v_mfma_f32_16x16x32_bf16 v[72:75], v[168:171], a[204:207], v[72:75]
v_exp_f32_e64 v25, v25
v_mfma_f32_16x16x32_bf16 v[80:83], v[168:171], a[228:231], v[80:83]
v_cvt_pk_bf16_f32 v159, v24, v25
v_or_b32 v30, v30, v159
v_mfma_f32_16x16x32_bf16 v[88:91], v[168:171], a[252:255], v[88:91]
s_waitcnt lgkmcnt(5)
v_and_b32 v30, s29, v30
v_cmp_ne_u32 vcc, 0, v30
v_mfma_f32_16x16x32_bf16 v[68:71], v[172:175], a[180:183], v[68:71]
s_mov_b32 s50, 3328
ds_read_b64_tr_b16 v[168:169], v5 offset:36864
ds_read_b64_tr_b16 v[170:171], v5 offset:43008
v_mfma_f32_16x16x32_bf16 v[76:79], v[172:175], a[204:207], v[76:79]
buffer_store_dwordx4 v[196:199], v14, s[24:27], s50 offen sc1 nt
v_mfma_f32_16x16x32_bf16 v[84:87], v[172:175], a[228:231], v[84:87]
v_mfma_f32_16x16x32_bf16 v[92:95], v[172:175], a[252:255], v[92:95]
s_cbranch_vccnz L_tr3
L_bk3:
v_mfma_f32_16x16x32_bf16 v[20:23], v[180:183], v[144:147], v[20:23]
v_mfma_f32_16x16x32_bf16 v[176:179], v[180:183], v[148:151], v[176:179]
v_fma_f32 v24, v64, s28, v16
v_fma_f32 v25, v65, s28, v16
v_mfma_f32_16x16x32_bf16 v[184:187], v[180:183], v[152:155], v[184:187]
v_exp_f32 v24, v24
v_mfma_f32_16x16x32_bf16 v[188:191], v[180:183], v[156:159], v[188:191]
s_waitcnt lgkmcnt(5)
v_exp_f32 v25, v25
v_mfma_f32_16x16x32_bf16 a[0:3], v[160:163], v[144:147], a[0:3]
ds_read_b64_tr_b16 v[172:173], v6 offset:36864
ds_read_b64_tr_b16 v[174:175], v6 offset:43008
v_mfma_f32_16x16x32_bf16 a[40:43], v[160:163], v[148:151], a[40:43]
v_cvt_pk_bf16_f32 v128, v24, v25
v_fma_f32 v26, v66, s28, v16
v_mfma_f32_16x16x32_bf16 a[80:83], v[160:163], v[152:155], a[80:83]
v_exp_f32 v26, v26
v_mfma_f32_16x16x32_bf16 a[120:123], v[160:163], v[156:159], a[120:123]
s_waitcnt lgkmcnt(4)
v_fma_f32 v27, v67, s28, v16
v_fma_f32 v28, v68, s28, v16
v_mfma_f32_16x16x32_bf16 a[4:7], v[164:167], v[144:147], a[4:7]
ds_read_b64_tr_b16 v[160:161], v3 offset:36992
ds_read_b64_tr_b16 v[162:163], v3 offset:43136
v_mfma_f32_16x16x32_bf16 a[44:47], v[164:167], v[148:151], a[44:47]
v_exp_f32_e64 v27, v27
v_mfma_f32_16x16x32_bf16 a[84:87], v[164:167], v[152:155], a[84:87]
v_cvt_pk_bf16_f32 v129, v26, v27
v_fma_f32 v29, v69, s28, v16
v_mfma_f32_16x16x32_bf16 a[124:127], v[164:167], v[156:159], a[124:127]
s_waitcnt lgkmcnt(4)
v_exp_f32 v28, v28
v_mfma_f32_16x16x32_bf16 a[8:11], v[168:171], v[144:147], a[8:11]
ds_read_b64_tr_b16 v[164:165], v4 offset:36992
ds_read_b64_tr_b16 v[166:167], v4 offset:43136
v_mfma_f32_16x16x32_bf16 a[48:51], v[168:171], v[148:151], a[48:51]
s_waitcnt vmcnt(17)
s_barrier
v_mfma_f32_16x16x32_bf16 a[88:91], v[168:171], v[152:155], a[88:91]
s_add_u32 m0, s35, 36864
v_exp_f32 v29, v29
v_mfma_f32_16x16x32_bf16 a[128:131], v[168:171], v[156:159], a[128:131]
s_waitcnt lgkmcnt(4)
v_cvt_pk_bf16_f32 v130, v28, v29
v_or3_b32 v30, v128, v129, v130
v_mfma_f32_16x16x32_bf16 a[12:15], v[172:175], v[144:147], a[12:15]
s_mov_b32 s38, 86016
ds_read_b64_tr_b16 v[168:169], v5 offset:36992
ds_read_b64_tr_b16 v[170:171], v5 offset:43136
v_mfma_f32_16x16x32_bf16 a[52:55], v[172:175], v[148:151], a[52:55]
buffer_load_dwordx4 v10, s[20:23], s38 offen  lds
v_mfma_f32_16x16x32_bf16 a[92:95], v[172:175], v[152:155], a[92:95]
v_fma_f32 v24, v70, s28, v16
v_fma_f32 v25, v71, s28, v16
v_mfma_f32_16x16x32_bf16 a[132:135], v[172:175], v[156:159], a[132:135]
s_waitcnt lgkmcnt(4)
v_exp_f32 v24, v24
v_mfma_f32_16x16x32_bf16 a[16:19], v[160:163], v[144:147], a[16:19]
ds_read_b64_tr_b16 v[172:173], v6 offset:36992
ds_read_b64_tr_b16 v[174:175], v6 offset:43136
v_mfma_f32_16x16x32_bf16 a[56:59], v[160:163], v[148:151], a[56:59]
v_exp_f32 v25, v25
v_mfma_f32_16x16x32_bf16 a[96:99], v[160:163], v[152:155], a[96:99]
buffer_load_dwordx4 v11, s[20:23], s38 offen offset:1024  lds
v_mfma_f32_16x16x32_bf16 a[136:139], v[160:163], v[156:159], a[136:139]
s_waitcnt lgkmcnt(4)
v_cvt_pk_bf16_f32 v131, v24, v25
v_fma_f32 v26, v72, s28, v17
v_mfma_f32_16x16x32_bf16 a[20:23], v[164:167], v[144:147], a[20:23]
ds_read_b64_tr_b16 v[160:161], v3 offset:37120
ds_read_b64_tr_b16 v[162:163], v3 offset:43264
v_mfma_f32_16x16x32_bf16 a[60:63], v[164:167], v[148:151], a[60:63]
v_exp_f32_e64 v26, v26
v_mfma_f32_16x16x32_bf16 a[100:103], v[164:167], v[152:155], a[100:103]
v_fma_f32 v27, v73, s28, v17
v_fma_f32 v28, v74, s28, v17
v_mfma_f32_16x16x32_bf16 a[140:143], v[164:167], v[156:159], a[140:143]
s_waitcnt lgkmcnt(4)
v_exp_f32 v27, v27
v_mfma_f32_16x16x32_bf16 a[24:27], v[168:171], v[144:147], a[24:27]
ds_read_b64_tr_b16 v[164:165], v4 offset:37120
ds_read_b64_tr_b16 v[166:167], v4 offset:43264
v_mfma_f32_16x16x32_bf16 a[64:67], v[168:171], v[148:151], a[64:67]
v_cvt_pk_bf16_f32 v132, v26, v27
v_or3_b32 v30, v30, v131, v132
v_mfma_f32_16x16x32_bf16 a[104:107], v[168:171], v[152:155], a[104:107]
buffer_load_dwordx4 v12, s[20:23], s38 offen offset:2048  lds
v_mfma_f32_16x16x32_bf16 a[144:147], v[168:171], v[156:159], a[144:147]
s_waitcnt lgkmcnt(4)
v_exp_f32 v28, v28
v_mfma_f32_16x16x32_bf16 a[28:31], v[172:175], v[144:147], a[28:31]
ds_read_b64_tr_b16 v[168:169], v5 offset:37120
ds_read_b64_tr_b16 v[170:171], v5 offset:43264
v_mfma_f32_16x16x32_bf16 a[68:71], v[172:175], v[148:151], a[68:71]
v_fma_f32 v29, v75, s28, v17
v_fma_f32 v24, v76, s28, v17
v_mfma_f32_16x16x32_bf16 a[108:111], v[172:175], v[152:155], a[108:111]
v_exp_f32_e64 v29, v29
v_mfma_f32_16x16x32_bf16 a[148:151], v[172:175], v[156:159], a[148:151]
s_waitcnt lgkmcnt(4)
v_cvt_pk_bf16_f32 v133, v28, v29
v_fma_f32 v25, v77, s28, v17
v_mfma_f32_16x16x32_bf16 a[32:35], v[160:163], v[144:147], a[32:35]
s_sub_u32 s51, s34, s33
ds_read_b64_tr_b16 v[172:173], v6 offset:37120
ds_read_b64_tr_b16 v[174:175], v6 offset:43264
v_mfma_f32_16x16x32_bf16 a[72:75], v[160:163], v[148:151], a[72:75]
v_add_u32 v1, s51, v1
v_add_u32 v2, s51, v2
v_mfma_f32_16x16x32_bf16 a[112:115], v[160:163], v[152:155], a[112:115]
s_add_u32 m0, s36, 0
v_exp_f32 v24, v24
v_mfma_f32_16x16x32_bf16 a[152:155], v[160:163], v[156:159], a[152:155]
s_waitcnt lgkmcnt(4)
v_exp_f32 v25, v25
v_mfma_f32_16x16x32_bf16 a[36:39], v[164:167], v[144:147], a[36:39]
s_mov_b32 s38, 110592
ds_read_b128 v[160:163], v1 offset:0
v_cvt_pk_bf16_f32 v134, v24, v25
v_mfma_f32_16x16x32_bf16 a[76:79], v[164:167], v[148:151], a[76:79]
buffer_load_dwordx4 v7, s[16:19], s38 offen  lds
v_mfma_f32_16x16x32_bf16 a[116:119], v[164:167], v[152:155], a[116:119]
v_or3_b32 v30, v30, v133, v134
v_fma_f32 v26, v78, s28, v17
v_mfma_f32_16x16x32_bf16 a[156:159], v[164:167], v[156:159], a[156:159]
s_waitcnt lgkmcnt(3)
v_exp_f32 v26, v26
v_mfma_f32_16x16x32_bf16 v[32:35], v[168:171], v[144:147], v[32:35]
ds_read_b128 v[164:167], v1 offset:6144
v_fma_f32 v27, v79, s28, v17
v_mfma_f32_16x16x32_bf16 v[40:43], v[168:171], v[148:151], v[40:43]
v_exp_f32_e64 v27, v27
v_mfma_f32_16x16x32_bf16 v[48:51], v[168:171], v[152:155], v[48:51]
v_cvt_pk_bf16_f32 v135, v26, v27
v_fma_f32 v28, v80, s28, v18
v_mfma_f32_16x16x32_bf16 v[56:59], v[168:171], v[156:159], v[56:59]
s_waitcnt lgkmcnt(2)
v_exp_f32 v28, v28
v_mfma_f32_16x16x32_bf16 v[36:39], v[172:175], v[144:147], v[36:39]
ds_read_b128 v[168:171], v2 offset:0
v_fma_f32 v29, v81, s28, v18
v_mfma_f32_16x16x32_bf16 v[44:47], v[172:175], v[148:151], v[44:47]
buffer_load_dwordx4 v8, s[16:19], s38 offen offset:1024  lds
v_mfma_f32_16x16x32_bf16 v[52:55], v[172:175], v[152:155], v[52:55]
v_exp_f32 v29, v29
v_mfma_f32_16x16x32_bf16 v[60:63], v[172:175], v[156:159], v[60:63]
s_waitcnt lgkmcnt(2)
v_cvt_pk_bf16_f32 v136, v28, v29
v_or3_b32 v30, v30, v135, v136
v_mfma_f32_16x16x32_bf16 v[96:99], v[160:163], a[160:163], 0
ds_read_b128 v[172:175], v2 offset:6144
v_fma_f32 v24, v82, s28, v18
v_mfma_f32_16x16x32_bf16 v[104:107], v[160:163], a[184:187], 0
v_exp_f32_e64 v24, v24
v_mfma_f32_16x16x32_bf16 v[112:115], v[160:163], a[208:211], 0
v_fma_f32 v25, v83, s28, v18
v_fma_f32 v26, v84, s28, v18
v_mfma_f32_16x16x32_bf16 v[120:123], v[160:163], a[232:235], 0
s_waitcnt lgkmcnt(2)
v_exp_f32 v25, v25
v_mfma_f32_16x16x32_bf16 v[100:103], v[164:167], a[160:163], 0
ds_read_b128 v[160:163], v1 offset:128
v_cvt_pk_bf16_f32 v137, v24, v25
v_mfma_f32_16x16x32_bf16 v[108:111], v[164:167], a[184:187], 0
s_mov_b32 s50, 6400
ds_write_b64 v15, v[216:217] offset:2048
v_mfma_f32_16x16x32_bf16 v[116:119], v[164:167], a[208:211], 0
buffer_store_dwordx4 v[200:203], v14, s[24:27], s50 offen sc1 nt
v_mfma_f32_16x16x32_bf16 v[124:127], v[164:167], a[232:235], 0
s_waitcnt lgkmcnt(3)
v_exp_f32 v26, v26
v_mfma_f32_16x16x32_bf16 v[96:99], v[168:171], a[164:167], v[96:99]
ds_read_b128 v[164:167], v1 offset:6272
v_fma_f32 v27, v85, s28, v18
v_mfma_f32_16x16x32_bf16 v[104:107], v[168:171], a[188:191], v[104:107]
v_exp_f32 v27, v27
v_mfma_f32_16x16x32_bf16 v[112:115], v[168:171], a[212:215], v[112:115]
v_cvt_pk_bf16_f32 v138, v26, v27
v_or3_b32 v30, v30, v137, v138
v_mfma_f32_16x16x32_bf16 v[120:123], v[168:171], a[236:239], v[120:123]
s_waitcnt lgkmcnt(3)
v_fma_f32 v28, v86, s28, v18
v_fma_f32 v29, v87, s28, v18
v_mfma_f32_16x16x32_bf16 v[100:103], v[172:175], a[164:167], v[100:103]
ds_read_b128 v[168:171], v2 offset:128
v_fma_f32 v24, v88, s28, v19
v_mfma_f32_16x16x32_bf16 v[108:111], v[172:175], a[188:191], v[108:111]
buffer_load_dwordx4 v9, s[16:19], s38 offen offset:2048  lds
v_mfma_f32_16x16x32_bf16 v[116:119], v[172:175], a[212:215], v[116:119]
v_exp_f32_e64 v28, v28
v_mfma_f32_16x16x32_bf16 v[124:127], v[172:175], a[236:239], v[124:127]
s_waitcnt lgkmcnt(3)
v_exp_f32 v29, v29
v_mfma_f32_16x16x32_bf16 v[96:99], v[160:163], a[168:171], v[96:99]
ds_read_b128 v[172:175], v2 offset:6272
v_xor_b32_e64 v31, 32, v15
v_mfma_f32_16x16x32_bf16 v[104:107], v[160:163], a[192:195], v[104:107]
ds_write_b64 v31, v[218:219] offset:2048
v_mfma_f32_16x16x32_bf16 v[112:115], v[160:163], a[216:219], v[112:115]
s_add_u32 m0, s36, 12288
v_cvt_pk_bf16_f32 v139, v28, v29
v_fma_f32 v25, v89, s28, v19
v_mfma_f32_16x16x32_bf16 v[120:123], v[160:163], a[240:243], v[120:123]
s_waitcnt lgkmcnt(3)
v_exp_f32 v24, v24
v_mfma_f32_16x16x32_bf16 v[100:103], v[164:167], a[168:171], v[100:103]
s_mov_b32 s38, 98304
ds_read_b128 v[160:163], v1 offset:256
v_fma_f32 v26, v90, s28, v19
v_mfma_f32_16x16x32_bf16 v[108:111], v[164:167], a[192:195], v[108:111]
buffer_load_dwordx4 v10, s[20:23], s38 offen  lds
v_mfma_f32_16x16x32_bf16 v[116:119], v[164:167], a[216:219], v[116:119]
v_exp_f32 v25, v25
v_mfma_f32_16x16x32_bf16 v[124:127], v[164:167], a[240:243], v[124:127]
s_waitcnt lgkmcnt(3)
v_cvt_pk_bf16_f32 v140, v24, v25
v_or3_b32 v30, v30, v139, v140
v_mfma_f32_16x16x32_bf16 v[96:99], v[168:171], a[172:175], v[96:99]
ds_read_b128 v[164:167], v1 offset:6400
v_xor_b32_e64 v31, 64, v15
v_mfma_f32_16x16x32_bf16 v[104:107], v[168:171], a[196:199], v[104:107]
ds_write_b64 v31, v[220:221] offset:2048
v_mfma_f32_16x16x32_bf16 v[112:115], v[168:171], a[220:223], v[112:115]
v_exp_f32 v26, v26
v_mfma_f32_16x16x32_bf16 v[120:123], v[168:171], a[244:247], v[120:123]
s_waitcnt lgkmcnt(4)
v_fma_f32 v27, v91, s28, v19
v_fma_f32 v28, v92, s28, v19
v_mfma_f32_16x16x32_bf16 v[100:103], v[172:175], a[172:175], v[100:103]
s_sub_u32 s51, s34, s33
ds_read_b128 v[168:171], v2 offset:256
v_add_u32 v3, s51, v3
v_mfma_f32_16x16x32_bf16 v[108:111], v[172:175], a[196:199], v[108:111]
v_add_u32 v4, s51, v4
v_add_u32 v5, s51, v5
v_mfma_f32_16x16x32_bf16 v[116:119], v[172:175], a[220:223], v[116:119]
v_add_u32_e64 v6, s51, v6
v_fma_f32 v29, v93, s28, v19
v_mfma_f32_16x16x32_bf16 v[124:127], v[172:175], a[244:247], v[124:127]
s_waitcnt lgkmcnt(3)
v_exp_f32 v27, v27
v_mfma_f32_16x16x32_bf16 v[96:99], v[160:163], a[176:179], v[96:99]
ds_read_b128 v[172:175], v2 offset:6400
v_cvt_pk_bf16_f32 v141, v26, v27
v_mfma_f32_16x16x32_bf16 v[104:107], v[160:163], a[200:203], v[104:107]
buffer_load_dwordx4 v11, s[20:23], s38 offen offset:1024  lds
v_mfma_f32_16x16x32_bf16 v[112:115], v[160:163], a[224:227], v[112:115]
v_exp_f32 v28, v28
v_mfma_f32_16x16x32_bf16 v[120:123], v[160:163], a[248:251], v[120:123]
s_waitcnt lgkmcnt(3)
v_xor_b32 v31, 96, v15
v_fma_f32 v24, v94, s28, v19
v_mfma_f32_16x16x32_bf16 v[100:103], v[164:167], a[176:179], v[100:103]
ds_read_b64_tr_b16 v[160:161], v3 offset:12288
ds_read_b64_tr_b16 v[162:163], v3 offset:18432
v_mfma_f32_16x16x32_bf16 v[108:111], v[164:167], a[200:203], v[108:111]
ds_write_b64 v31, v[222:223] offset:2048
v_mfma_f32_16x16x32_bf16 v[116:119], v[164:167], a[224:227], v[116:119]
buffer_load_dwordx4 v12, s[20:23], s38 offen offset:2048  lds
v_mfma_f32_16x16x32_bf16 v[124:127], v[164:167], a[248:251], v[124:127]
s_waitcnt lgkmcnt(4)
v_exp_f32 v29, v29
v_mfma_f32_16x16x32_bf16 v[96:99], v[168:171], a[180:183], v[96:99]
ds_read_b64_tr_b16 v[164:165], v4 offset:12288
ds_read_b64_tr_b16 v[166:167], v4 offset:18432
v_mfma_f32_16x16x32_bf16 v[104:107], v[168:171], a[204:207], v[104:107]
ds_read_b128 v[208:211], v13 offset:0
v_cvt_pk_bf16_f32 v142, v28, v29
v_mfma_f32_16x16x32_bf16 v[112:115], v[168:171], a[228:231], v[112:115]
ds_read_b128 v[212:215], v13 offset:1024
v_or3_b32 v30, v30, v141, v142
v_mfma_f32_16x16x32_bf16 v[120:123], v[168:171], a[252:255], v[120:123]
s_waitcnt lgkmcnt(7)
ds_read_b128 v[216:219], v13 offset:2048
v_fma_f32 v25, v95, s28, v19
v_mfma_f32_16x16x32_bf16 v[100:103], v[172:175], a[180:183], v[100:103]
ds_read_b64_tr_b16 v[168:169], v5 offset:12288
ds_read_b64_tr_b16 v[170:171], v5 offset:18432
v_mfma_f32_16x16x32_bf16 v[108:111], v[172:175], a[204:207], v[108:111]
s_mov_b32 s50, 9472
ds_read_b128 v[220:223], v13 offset:3072
v_mfma_f32_16x16x32_bf16 v[116:119], v[172:175], a[228:231], v[116:119]
buffer_store_dwordx4 v[204:207], v14, s[24:27], s50 offen sc1 nt
v_mfma_f32_16x16x32_bf16 v[124:127], v[172:175], a[252:255], v[124:127]
v_exp_f32 v24, v24
v_exp_f32 v25, v25
s_nop 0
v_cvt_pk_bf16_f32 v143, v24, v25
v_or_b32 v30, v30, v143
v_and_b32 v30, s29, v30
v_cmp_ne_u32 vcc, 0, v30
s_cbranch_vccnz L_tr4
L_bk4:
v_mfma_f32_16x16x32_bf16 v[20:23], v[180:183], v[128:131], v[20:23]
v_mfma_f32_16x16x32_bf16 v[176:179], v[180:183], v[132:135], v[176:179]
v_fma_f32 v24, v96, s28, v16
v_fma_f32 v25, v97, s28, v16
v_mfma_f32_16x16x32_bf16 v[184:187], v[180:183], v[136:139], v[184:187]
v_exp_f32_e64 v24, v24
v_mfma_f32_16x16x32_bf16 v[188:191], v[180:183], v[140:143], v[188:191]
s_waitcnt lgkmcnt(9)
v_exp_f32 v25, v25
v_mfma_f32_16x16x32_bf16 a[0:3], v[160:163], v[128:131], a[0:3]
ds_read_b64_tr_b16 v[172:173], v6 offset:12288
ds_read_b64_tr_b16 v[174:175], v6 offset:18432
v_mfma_f32_16x16x32_bf16 a[40:43], v[160:163], v[132:135], a[40:43]
v_cvt_pk_bf16_f32 v144, v24, v25
v_fma_f32 v26, v98, s28, v16
v_mfma_f32_16x16x32_bf16 a[80:83], v[160:163], v[136:139], a[80:83]
v_exp_f32 v26, v26
v_mfma_f32_16x16x32_bf16 a[120:123], v[160:163], v[140:143], a[120:123]
s_waitcnt lgkmcnt(8)
v_fma_f32 v27, v99, s28, v16
v_fma_f32 v28, v100, s28, v16
v_mfma_f32_16x16x32_bf16 a[4:7], v[164:167], v[128:131], a[4:7]
ds_read_b64_tr_b16 v[160:161], v3 offset:12416
ds_read_b64_tr_b16 v[162:163], v3 offset:18560
v_mfma_f32_16x16x32_bf16 a[44:47], v[164:167], v[132:135], a[44:47]
v_exp_f32_e64 v27, v27
v_mfma_f32_16x16x32_bf16 a[84:87], v[164:167], v[136:139], a[84:87]
v_cvt_pk_bf16_f32 v145, v26, v27
v_fma_f32 v29, v101, s28, v16
v_mfma_f32_16x16x32_bf16 a[124:127], v[164:167], v[140:143], a[124:127]
s_waitcnt lgkmcnt(5)
v_exp_f32 v28, v28
v_mfma_f32_16x16x32_bf16 a[8:11], v[168:171], v[128:131], a[8:11]
ds_read_b64_tr_b16 v[164:165], v4 offset:12416
ds_read_b64_tr_b16 v[166:167], v4 offset:18560
v_mfma_f32_16x16x32_bf16 a[48:51], v[168:171], v[132:135], a[48:51]
s_waitcnt vmcnt(22)
s_barrier
v_mfma_f32_16x16x32_bf16 a[88:91], v[168:171], v[136:139], a[88:91]
s_add_u32 m0, s36, 24576
v_exp_f32 v29, v29
v_mfma_f32_16x16x32_bf16 a[128:131], v[168:171], v[140:143], a[128:131]
s_waitcnt lgkmcnt(4)
v_cvt_pk_bf16_f32 v146, v28, v29
v_or3_b32 v30, v144, v145, v146
v_mfma_f32_16x16x32_bf16 a[12:15], v[172:175], v[128:131], a[12:15]
s_mov_b32 s38, 122880
ds_read_b64_tr_b16 v[168:169], v5 offset:12416
ds_read_b64_tr_b16 v[170:171], v5 offset:18560
v_mfma_f32_16x16x32_bf16 a[52:55], v[172:175], v[132:135], a[52:55]
buffer_load_dwordx4 v7, s[16:19], s38 offen  lds
v_mfma_f32_16x16x32_bf16 a[92:95], v[172:175], v[136:139], a[92:95]
v_fma_f32 v24, v102, s28, v16
v_fma_f32 v25, v103, s28, v16
v_mfma_f32_16x16x32_bf16 a[132:135], v[172:175], v[140:143], a[132:135]
s_waitcnt lgkmcnt(4)
v_exp_f32 v24, v24
v_mfma_f32_16x16x32_bf16 a[16:19], v[160:163], v[128:131], a[16:19]
ds_read_b64_tr_b16 v[172:173], v6 offset:12416
ds_read_b64_tr_b16 v[174:175], v6 offset:18560
v_mfma_f32_16x16x32_bf16 a[56:59], v[160:163], v[132:135], a[56:59]
v_exp_f32 v25, v25
v_mfma_f32_16x16x32_bf16 a[96:99], v[160:163], v[136:139], a[96:99]
buffer_load_dwordx4 v8, s[16:19], s38 offen offset:1024  lds
v_mfma_f32_16x16x32_bf16 a[136:139], v[160:163], v[140:143], a[136:139]
s_waitcnt lgkmcnt(4)
v_cvt_pk_bf16_f32 v147, v24, v25
v_fma_f32 v26, v104, s28, v17
v_mfma_f32_16x16x32_bf16 a[20:23], v[164:167], v[128:131], a[20:23]
ds_read_b64_tr_b16 v[160:161], v3 offset:12544
ds_read_b64_tr_b16 v[162:163], v3 offset:18688
v_mfma_f32_16x16x32_bf16 a[60:63], v[164:167], v[132:135], a[60:63]
v_exp_f32_e64 v26, v26
v_mfma_f32_16x16x32_bf16 a[100:103], v[164:167], v[136:139], a[100:103]
v_fma_f32 v27, v105, s28, v17
v_fma_f32 v28, v106, s28, v17
v_mfma_f32_16x16x32_bf16 a[140:143], v[164:167], v[140:143], a[140:143]
s_waitcnt lgkmcnt(4)
v_exp_f32 v27, v27
v_mfma_f32_16x16x32_bf16 a[24:27], v[168:171], v[128:131], a[24:27]
ds_read_b64_tr_b16 v[164:165], v4 offset:12544
ds_read_b64_tr_b16 v[166:167], v4 offset:18688
v_mfma_f32_16x16x32_bf16 a[64:67], v[168:171], v[132:135], a[64:67]
v_cvt_pk_bf16_f32 v148, v26, v27
v_or3_b32 v30, v30, v147, v148
v_mfma_f32_16x16x32_bf16 a[104:107], v[168:171], v[136:139], a[104:107]
buffer_load_dwordx4 v9, s[16:19], s38 offen offset:2048  lds
v_mfma_f32_16x16x32_bf16 a[144:147], v[168:171], v[140:143], a[144:147]
s_waitcnt lgkmcnt(4)
v_exp_f32 v28, v28
v_mfma_f32_16x16x32_bf16 a[28:31], v[172:175], v[128:131], a[28:31]
ds_read_b64_tr_b16 v[168:169], v5 offset:12544
ds_read_b64_tr_b16 v[170:171], v5 offset:18688
v_mfma_f32_16x16x32_bf16 a[68:71], v[172:175], v[132:135], a[68:71]
v_fma_f32 v29, v107, s28, v17
v_fma_f32 v24, v108, s28, v17
v_mfma_f32_16x16x32_bf16 a[108:111], v[172:175], v[136:139], a[108:111]
v_exp_f32 v29, v29
v_mfma_f32_16x16x32_bf16 a[148:151], v[172:175], v[140:143], a[148:151]
s_waitcnt lgkmcnt(4)
v_cvt_pk_bf16_f32 v149, v28, v29
v_fma_f32 v25, v109, s28, v17
v_mfma_f32_16x16x32_bf16 a[32:35], v[160:163], v[128:131], a[32:35]
ds_read_b64_tr_b16 v[172:173], v6 offset:12544
ds_read_b64_tr_b16 v[174:175], v6 offset:18688
v_mfma_f32_16x16x32_bf16 a[72:75], v[160:163], v[132:135], a[72:75]
v_exp_f32_e64 v24, v24
v_mfma_f32_16x16x32_bf16 a[112:115], v[160:163], v[136:139], a[112:115]
s_add_u32 m0, s36, 36864
v_exp_f32 v25, v25
v_mfma_f32_16x16x32_bf16 a[152:155], v[160:163], v[140:143], a[152:155]
s_waitcnt lgkmcnt(4)
v_cvt_pk_bf16_f32 v150, v24, v25
v_or3_b32 v30, v30, v149, v150
v_mfma_f32_16x16x32_bf16 a[36:39], v[164:167], v[128:131], a[36:39]
s_mov_b32 s38, 110592
ds_read_b128 v[160:163], v1 offset:24576
v_fma_f32 v26, v110, s28, v17
v_mfma_f32_16x16x32_bf16 a[76:79], v[164:167], v[132:135], a[76:79]
buffer_load_dwordx4 v10, s[20:23], s38 offen  lds
v_mfma_f32_16x16x32_bf16 a[116:119], v[164:167], v[136:139], a[116:119]
v_exp_f32 v26, v26
v_mfma_f32_16x16x32_bf16 a[156:159], v[164:167], v[140:143], a[156:159]
s_waitcnt lgkmcnt(3)
v_fma_f32 v27, v111, s28, v17
v_fma_f32 v28, v112, s28, v18
v_mfma_f32_16x16x32_bf16 v[32:35], v[168:171], v[128:131], v[32:35]
ds_read_b128 v[164:167], v1 offset:30720
v_fma_f32 v29, v113, s28, v18
v_mfma_f32_16x16x32_bf16 v[40:43], v[168:171], v[132:135], v[40:43]
v_exp_f32_e64 v27, v27
v_mfma_f32_16x16x32_bf16 v[48:51], v[168:171], v[136:139], v[48:51]
v_cvt_pk_bf16_f32 v151, v26, v27
v_fma_f32 v24, v114, s28, v18
v_mfma_f32_16x16x32_bf16 v[56:59], v[168:171], v[140:143], v[56:59]
s_waitcnt lgkmcnt(2)
v_exp_f32 v28, v28
v_mfma_f32_16x16x32_bf16 v[36:39], v[172:175], v[128:131], v[36:39]
ds_read_b128 v[168:171], v2 offset:24576
v_fma_f32 v25, v115, s28, v18
v_mfma_f32_16x16x32_bf16 v[44:47], v[172:175], v[132:135], v[44:47]
buffer_load_dwordx4 v11, s[20:23], s38 offen offset:1024  lds
v_mfma_f32_16x16x32_bf16 v[52:55], v[172:175], v[136:139], v[52:55]
v_exp_f32 v29, v29
v_mfma_f32_16x16x32_bf16 v[60:63], v[172:175], v[140:143], v[60:63]
s_waitcnt lgkmcnt(2)
v_cvt_pk_bf16_f32 v152, v28, v29
v_or3_b32 v30, v30, v151, v152
v_mfma_f32_16x16x32_bf16 v[64:67], v[160:163], a[160:163], 0
ds_read_b128 v[172:175], v2 offset:30720
v_fma_f32 v26, v116, s28, v18
v_mfma_f32_16x16x32_bf16 v[72:75], v[160:163], a[184:187], 0
v_exp_f32_e64 v24, v24
v_mfma_f32_16x16x32_bf16 v[80:83], v[160:163], a[208:211], 0
v_exp_f32 v25, v25
v_mfma_f32_16x16x32_bf16 v[88:91], v[160:163], a[232:235], 0
s_waitcnt lgkmcnt(2)
v_cvt_pk_bf16_f32 v153, v24, v25
v_fma_f32 v27, v117, s28, v18
v_mfma_f32_16x16x32_bf16 v[68:71], v[164:167], a[160:163], 0
ds_read_b128 v[160:163], v1 offset:24704
v_fma_f32 v28, v118, s28, v18
v_mfma_f32_16x16x32_bf16 v[76:79], v[164:167], a[184:187], 0
s_mov_b32 s50, 12288
ds_write_b64 v15, v[224:225] offset:0
v_mfma_f32_16x16x32_bf16 v[84:87], v[164:167], a[208:211], 0
buffer_store_dwordx4 v[208:211], v14, s[24:27], s50 offen sc1 nt
v_mfma_f32_16x16x32_bf16 v[92:95], v[164:167], a[232:235], 0
s_waitcnt lgkmcnt(3)
v_exp_f32 v26, v26
v_mfma_f32_16x16x32_bf16 v[64:67], v[168:171], a[164:167], v[64:67]
ds_read_b128 v[164:167], v1 offset:30848
v_fma_f32 v29, v119, s28, v18
v_mfma_f32_16x16x32_bf16 v[72:75], v[168:171], a[188:191], v[72:75]
s_add_u32 s43, s31, 25165824
s_cmp_lt_u32 s30, 3
s_cselect_b32 s43, s43, 0
s_cselect_b32 s44, 98304, 0
s_cselect_b32 s45, 196608, 0
v_mfma_f32_16x16x32_bf16 v[80:83], v[168:171], a[212:215], v[80:83]
v_exp_f32 v27, v27
v_mfma_f32_16x16x32_bf16 v[88:91], v[168:171], a[236:239], v[88:91]
s_waitcnt lgkmcnt(3)
v_cvt_pk_bf16_f32 v154, v26, v27
v_or3_b32 v30, v30, v153, v154
v_mfma_f32_16x16x32_bf16 v[68:71], v[172:175], a[164:167], v[68:71]
ds_read_b128 v[168:171], v2 offset:24704
v_fma_f32 v24, v120, s28, v19
v_mfma_f32_16x16x32_bf16 v[76:79], v[172:175], a[188:191], v[76:79]
buffer_load_dwordx4 v12, s[20:23], s38 offen offset:2048  lds
v_mfma_f32_16x16x32_bf16 v[84:87], v[172:175], a[212:215], v[84:87]
v_exp_f32_e64 v28, v28
v_mfma_f32_16x16x32_bf16 v[92:95], v[172:175], a[236:239], v[92:95]
s_waitcnt lgkmcnt(3)
v_exp_f32 v29, v29
v_mfma_f32_16x16x32_bf16 v[64:67], v[160:163], a[168:171], v[64:67]
ds_read_b128 v[172:175], v2 offset:30848
v_xor_b32 v31, 32, v15
v_mfma_f32_16x16x32_bf16 v[72:75], v[160:163], a[192:195], v[72:75]
ds_write_b64 v31, v[226:227] offset:0
v_mfma_f32_16x16x32_bf16 v[80:83], v[160:163], a[216:219], v[80:83]
s_add_u32 m0, s37, 0
v_cvt_pk_bf16_f32 v155, v28, v29
v_fma_f32 v25, v121, s28, v19
v_mfma_f32_16x16x32_bf16 v[88:91], v[160:163], a[240:243], v[88:91]
s_waitcnt lgkmcnt(3)
v_exp_f32 v24, v24
v_mfma_f32_16x16x32_bf16 v[68:71], v[164:167], a[168:171], v[68:71]
s_mov_b32 s38, 135168
ds_read_b128 v[160:163], v1 offset:24832
v_fma_f32 v26, v122, s28, v19
v_mfma_f32_16x16x32_bf16 v[76:79], v[164:167], a[192:195], v[76:79]
buffer_load_dwordx4 v7, s[16:19], s38 offen  lds
v_mfma_f32_16x16x32_bf16 v[84:87], v[164:167], a[216:219], v[84:87]
v_exp_f32 v25, v25
v_mfma_f32_16x16x32_bf16 v[92:95], v[164:167], a[240:243], v[92:95]
s_waitcnt lgkmcnt(3)
v_cvt_pk_bf16_f32 v156, v24, v25
v_or3_b32 v30, v30, v155, v156
v_mfma_f32_16x16x32_bf16 v[64:67], v[168:171], a[172:175], v[64:67]
ds_read_b128 v[164:167], v1 offset:30976
v_xor_b32_e64 v31, 64, v15
v_mfma_f32_16x16x32_bf16 v[72:75], v[168:171], a[196:199], v[72:75]
ds_write_b64 v31, v[228:229] offset:0
v_mfma_f32_16x16x32_bf16 v[80:83], v[168:171], a[220:223], v[80:83]
v_exp_f32 v26, v26
v_mfma_f32_16x16x32_bf16 v[88:91], v[168:171], a[244:247], v[88:91]
s_waitcnt lgkmcnt(4)
v_fma_f32 v27, v123, s28, v19
v_fma_f32 v28, v124, s28, v19
v_mfma_f32_16x16x32_bf16 v[68:71], v[172:175], a[172:175], v[68:71]
ds_read_b128 v[168:171], v2 offset:24832
v_fma_f32 v29, v125, s28, v19
v_mfma_f32_16x16x32_bf16 v[76:79], v[172:175], a[196:199], v[76:79]
buffer_load_dwordx4 v8, s[16:19], s38 offen offset:1024  lds
v_mfma_f32_16x16x32_bf16 v[84:87], v[172:175], a[220:223], v[84:87]
v_exp_f32 v27, v27
v_mfma_f32_16x16x32_bf16 v[92:95], v[172:175], a[244:247], v[92:95]
s_waitcnt lgkmcnt(3)
v_cvt_pk_bf16_f32 v157, v26, v27
v_fma_f32 v24, v126, s28, v19
v_mfma_f32_16x16x32_bf16 v[64:67], v[160:163], a[176:179], v[64:67]
ds_read_b128 v[172:175], v2 offset:30976
v_fma_f32 v25, v127, s28, v19
v_mfma_f32_16x16x32_bf16 v[72:75], v[160:163], a[200:203], v[72:75]
v_exp_f32_e64 v28, v28
v_mfma_f32_16x16x32_bf16 v[80:83], v[160:163], a[224:227], v[80:83]
v_exp_f32 v29, v29
v_mfma_f32_16x16x32_bf16 v[88:91], v[160:163], a[248:251], v[88:91]
s_waitcnt lgkmcnt(3)
v_xor_b32 v31, 96, v15
v_cvt_pk_bf16_f32 v158, v28, v29
v_mfma_f32_16x16x32_bf16 v[68:71], v[164:167], a[176:179], v[68:71]
L_pad3:
s_cbranch_execz L_warm_next
ds_read_b64_tr_b16 v[160:161], v3 offset:36864
ds_read_b64_tr_b16 v[162:163], v3 offset:43008
v_mfma_f32_16x16x32_bf16 v[76:79], v[164:167], a[200:203], v[76:79]
ds_write_b64 v31, v[230:231] offset:0
v_mfma_f32_16x16x32_bf16 v[84:87], v[164:167], a[224:227], v[84:87]
buffer_load_dwordx4 v9, s[16:19], s38 offen offset:2048  lds
v_mfma_f32_16x16x32_bf16 v[92:95], v[164:167], a[248:251], v[92:95]
s_waitcnt lgkmcnt(4)
v_or3_b32 v30, v30, v157, v158
v_mfma_f32_16x16x32_bf16 v[64:67], v[168:171], a[180:183], v[64:67]
ds_read_b64_tr_b16 v[164:165], v4 offset:36864
ds_read_b64_tr_b16 v[166:167], v4 offset:43008
v_mfma_f32_16x16x32_bf16 v[72:75], v[168:171], a[204:207], v[72:75]
v_exp_f32_e64 v24, v24
v_mfma_f32_16x16x32_bf16 v[80:83], v[168:171], a[228:231], v[80:83]
v_exp_f32_e64 v25, v25
v_mfma_f32_16x16x32_bf16 v[88:91], v[168:171], a[252:255], v[88:91]
s_waitcnt lgkmcnt(5)
v_cvt_pk_bf16_f32 v159, v24, v25
v_or_b32 v30, v30, v159
v_mfma_f32_16x16x32_bf16 v[68:71], v[172:175], a[180:183], v[68:71]
s_mov_b32 s50, 15360
ds_read_b64_tr_b16 v[168:169], v5 offset:36864
ds_read_b64_tr_b16 v[170:171], v5 offset:43008
v_mfma_f32_16x16x32_bf16 v[76:79], v[172:175], a[204:207], v[76:79]
buffer_store_dwordx4 v[212:215], v14, s[24:27], s50 offen sc1 nt
v_mfma_f32_16x16x32_bf16 v[84:87], v[172:175], a[228:231], v[84:87]
v_and_b32_e64 v30, s29, v30
v_cmp_ne_u32 vcc, 0, v30
v_mfma_f32_16x16x32_bf16 v[92:95], v[172:175], a[252:255], v[92:95]
s_cbranch_vccnz L_tr5
L_bk5:
v_mfma_f32_16x16x32_bf16 v[20:23], v[180:183], v[144:147], v[20:23]
v_mfma_f32_16x16x32_bf16 v[176:179], v[180:183], v[148:151], v[176:179]
v_fma_f32 v24, v64, s28, v16
v_fma_f32 v25, v65, s28, v16
v_mfma_f32_16x16x32_bf16 v[184:187], v[180:183], v[152:155], v[184:187]
v_exp_f32_e64 v24, v24
v_mfma_f32_16x16x32_bf16 v[188:191], v[180:183], v[156:159], v[188:191]
s_waitcnt lgkmcnt(5)
v_exp_f32 v25, v25
v_mfma_f32_16x16x32_bf16 a[0:3], v[160:163], v[144:147], a[0:3]
ds_read_b64_tr_b16 v[172:173], v6 offset:36864
ds_read_b64_tr_b16 v[174:175], v6 offset:43008
v_mfma_f32_16x16x32_bf16 a[40:43], v[160:163], v[148:151], a[40:43]
v_cvt_pk_bf16_f32 v128, v24, v25
v_fma_f32 v26, v66, s28, v16
v_mfma_f32_16x16x32_bf16 a[80:83], v[160:163], v[152:155], a[80:83]
v_exp_f32 v26, v26
v_mfma_f32_16x16x32_bf16 a[120:123], v[160:163], v[156:159], a[120:123]
s_waitcnt lgkmcnt(4)
v_fma_f32 v27, v67, s28, v16
v_fma_f32 v28, v68, s28, v16
v_mfma_f32_16x16x32_bf16 a[4:7], v[164:167], v[144:147], a[4:7]
ds_read_b64_tr_b16 v[160:161], v3 offset:36992
ds_read_b64_tr_b16 v[162:163], v3 offset:43136
v_mfma_f32_16x16x32_bf16 a[44:47], v[164:167], v[148:151], a[44:47]
v_exp_f32_e64 v27, v27
v_mfma_f32_16x16x32_bf16 a[84:87], v[164:167], v[152:155], a[84:87]
v_cvt_pk_bf16_f32 v129, v26, v27
v_fma_f32 v29, v69, s28, v16
v_mfma_f32_16x16x32_bf16 a[124:127], v[164:167], v[156:159], a[124:127]
s_waitcnt lgkmcnt(4)
v_exp_f32 v28, v28
v_mfma_f32_16x16x32_bf16 a[8:11], v[168:171], v[144:147], a[8:11]
ds_read_b64_tr_b16 v[164:165], v4 offset:36992
ds_read_b64_tr_b16 v[166:167], v4 offset:43136
v_mfma_f32_16x16x32_bf16 a[48:51], v[168:171], v[148:151], a[48:51]
s_waitcnt vmcnt(26)
s_barrier
v_mfma_f32_16x16x32_bf16 a[88:91], v[168:171], v[152:155], a[88:91]
s_add_u32 m0, s37, 12288
v_exp_f32 v29, v29
v_mfma_f32_16x16x32_bf16 a[128:131], v[168:171], v[156:159], a[128:131]
s_waitcnt lgkmcnt(4)
v_cvt_pk_bf16_f32 v130, v28, v29
v_or3_b32 v30, v128, v129, v130
v_mfma_f32_16x16x32_bf16 a[12:15], v[172:175], v[144:147], a[12:15]
s_mov_b32 s38, 122880
ds_read_b64_tr_b16 v[168:169], v5 offset:36992
ds_read_b64_tr_b16 v[170:171], v5 offset:43136
v_mfma_f32_16x16x32_bf16 a[52:55], v[172:175], v[148:151], a[52:55]
buffer_load_dwordx4 v10, s[20:23], s38 offen  lds
v_mfma_f32_16x16x32_bf16 a[92:95], v[172:175], v[152:155], a[92:95]
v_fma_f32 v24, v70, s28, v16
v_fma_f32 v25, v71, s28, v16
v_mfma_f32_16x16x32_bf16 a[132:135], v[172:175], v[156:159], a[132:135]
s_waitcnt lgkmcnt(4)
v_exp_f32 v24, v24
v_mfma_f32_16x16x32_bf16 a[16:19], v[160:163], v[144:147], a[16:19]
ds_read_b64_tr_b16 v[172:173], v6 offset:36992
ds_read_b64_tr_b16 v[174:175], v6 offset:43136
v_mfma_f32_16x16x32_bf16 a[56:59], v[160:163], v[148:151], a[56:59]
v_exp_f32_e64 v25, v25
v_mfma_f32_16x16x32_bf16 a[96:99], v[160:163], v[152:155], a[96:99]
v_cvt_pk_bf16_f32 v131, v24, v25
v_fma_f32 v26, v72, s28, v17
v_mfma_f32_16x16x32_bf16 a[136:139], v[160:163], v[156:159], a[136:139]
s_waitcnt lgkmcnt(4)
v_exp_f32 v26, v26
v_mfma_f32_16x16x32_bf16 a[20:23], v[164:167], v[144:147], a[20:23]
ds_read_b64_tr_b16 v[160:161], v3 offset:37120
ds_read_b64_tr_b16 v[162:163], v3 offset:43264
v_mfma_f32_16x16x32_bf16 a[60:63], v[164:167], v[148:151], a[60:63]
buffer_load_dwordx4 v11, s[20:23], s38 offen offset:1024  lds
v_mfma_f32_16x16x32_bf16 a[100:103], v[164:167], v[152:155], a[100:103]
v_fma_f32 v27, v73, s28, v17
v_fma_f32 v28, v74, s28, v17
v_mfma_f32_16x16x32_bf16 a[140:143], v[164:167], v[156:159], a[140:143]
s_waitcnt lgkmcnt(4)
v_exp_f32 v27, v27
v_mfma_f32_16x16x32_bf16 a[24:27], v[168:171], v[144:147], a[24:27]
ds_read_b64_tr_b16 v[164:165], v4 offset:37120
ds_read_b64_tr_b16 v[166:167], v4 offset:43264
v_mfma_f32_16x16x32_bf16 a[64:67], v[168:171], v[148:151], a[64:67]
v_cvt_pk_bf16_f32 v132, v26, v27
v_or3_b32 v30, v30, v131, v132
v_mfma_f32_16x16x32_bf16 a[104:107], v[168:171], v[152:155], a[104:107]
v_exp_f32 v28, v28
v_mfma_f32_16x16x32_bf16 a[144:147], v[168:171], v[156:159], a[144:147]
s_waitcnt lgkmcnt(4)
v_fma_f32 v29, v75, s28, v17
v_fma_f32 v24, v76, s28, v17
v_mfma_f32_16x16x32_bf16 a[28:31], v[172:175], v[144:147], a[28:31]
ds_read_b64_tr_b16 v[168:169], v5 offset:37120
ds_read_b64_tr_b16 v[170:171], v5 offset:43264
v_mfma_f32_16x16x32_bf16 a[68:71], v[172:175], v[148:151], a[68:71]
v_exp_f32_e64 v29, v29
v_mfma_f32_16x16x32_bf16 a[108:111], v[172:175], v[152:155], a[108:111]
v_cvt_pk_bf16_f32 v133, v28, v29
v_fma_f32 v25, v77, s28, v17
v_mfma_f32_16x16x32_bf16 a[148:151], v[172:175], v[156:159], a[148:151]
s_waitcnt lgkmcnt(4)
v_exp_f32_e64 v24, v24
v_mfma_f32_16x16x32_bf16 a[32:35], v[160:163], v[144:147], a[32:35]
s_sub_u32 s51, s32, s34
ds_read_b64_tr_b16 v[172:173], v6 offset:37120
ds_read_b64_tr_b16 v[174:175], v6 offset:43264
v_mfma_f32_16x16x32_bf16 a[72:75], v[160:163], v[148:151], a[72:75]
v_add_u32 v1, s51, v1
v_add_u32 v2, s51, v2
v_mfma_f32_16x16x32_bf16 a[112:115], v[160:163], v[152:155], a[112:115]
buffer_load_dwordx4 v12, s[20:23], s38 offen offset:2048  lds
v_mfma_f32_16x16x32_bf16 a[152:155], v[160:163], v[156:159], a[152:155]
s_waitcnt lgkmcnt(4)
v_exp_f32 v25, v25
v_mfma_f32_16x16x32_bf16 a[36:39], v[164:167], v[144:147], a[36:39]
ds_read_b128 v[160:163], v1 offset:0
v_cvt_pk_bf16_f32 v134, v24, v25
v_mfma_f32_16x16x32_bf16 a[76:79], v[164:167], v[148:151], a[76:79]
v_or3_b32 v30, v30, v133, v134
v_fma_f32 v26, v78, s28, v17
v_mfma_f32_16x16x32_bf16 a[116:119], v[164:167], v[152:155], a[116:119]
v_exp_f32 v26, v26
v_mfma_f32_16x16x32_bf16 a[156:159], v[164:167], v[156:159], a[156:159]
s_waitcnt lgkmcnt(3)
v_fma_f32 v27, v79, s28, v17
v_fma_f32 v28, v80, s28, v18
v_mfma_f32_16x16x32_bf16 v[32:35], v[168:171], v[144:147], v[32:35]
ds_read_b128 v[164:167], v1 offset:6144
v_fma_f32 v29, v81, s28, v18
v_mfma_f32_16x16x32_bf16 v[40:43], v[168:171], v[148:151], v[40:43]
v_exp_f32_e64 v27, v27
v_mfma_f32_16x16x32_bf16 v[48:51], v[168:171], v[152:155], v[48:51]
v_cvt_pk_bf16_f32 v135, v26, v27
v_fma_f32 v24, v82, s28, v18
v_mfma_f32_16x16x32_bf16 v[56:59], v[168:171], v[156:159], v[56:59]
s_waitcnt lgkmcnt(2)
v_exp_f32 v28, v28
v_mfma_f32_16x16x32_bf16 v[36:39], v[172:175], v[144:147], v[36:39]
s_mov_b32 s50, 18432
ds_read_b128 v[168:171], v2 offset:0
v_fma_f32 v25, v83, s28, v18
v_mfma_f32_16x16x32_bf16 v[44:47], v[172:175], v[148:151], v[44:47]
buffer_store_dwordx4 v[216:219], v14, s[24:27], s50 offen sc1 nt
v_mfma_f32_16x16x32_bf16 v[52:55], v[172:175], v[152:155], v[52:55]
v_exp_f32 v29, v29
v_mfma_f32_16x16x32_bf16 v[60:63], v[172:175], v[156:159], v[60:63]
s_waitcnt lgkmcnt(2)
v_cvt_pk_bf16_f32 v136, v28, v29
v_or3_b32 v30, v30, v135, v136
v_mfma_f32_16x16x32_bf16 v[96:99], v[160:163], a[160:163], 0
ds_read_b128 v[172:175], v2 offset:6144
v_fma_f32 v26, v84, s28, v18
v_mfma_f32_16x16x32_bf16 v[104:107], v[160:163], a[184:187], 0
v_exp_f32_e64 v24, v24
v_mfma_f32_16x16x32_bf16 v[112:115], v[160:163], a[208:211], 0
v_exp_f32 v25, v25
v_mfma_f32_16x16x32_bf16 v[120:123], v[160:163], a[232:235], 0
s_waitcnt lgkmcnt(2)
v_cvt_pk_bf16_f32 v137, v24, v25
v_fma_f32 v27, v85, s28, v18
v_mfma_f32_16x16x32_bf16 v[100:103], v[164:167], a[160:163], 0
ds_read_b128 v[160:163], v1 offset:128
v_fma_f32 v28, v86, s28, v18
v_mfma_f32_16x16x32_bf16 v[108:111], v[164:167], a[184:187], 0
ds_write_b64 v15, v[232:233] offset:2048
v_mfma_f32_16x16x32_bf16 v[116:119], v[164:167], a[208:211], 0
s_add_u32 m0, s37, 24576
v_exp_f32_e64 v26, v26
v_mfma_f32_16x16x32_bf16 v[124:127], v[164:167], a[232:235], 0
s_waitcnt lgkmcnt(3)
v_exp_f32 v27, v27
v_mfma_f32_16x16x32_bf16 v[96:99], v[168:171], a[164:167], v[96:99]
s_mov_b32 s38, 147456
ds_read_b128 v[164:167], v1 offset:6272
v_cvt_pk_bf16_f32 v138, v26, v27
v_mfma_f32_16x16x32_bf16 v[104:107], v[168:171], a[188:191], v[104:107]
buffer_load_dwordx4 v7, s[16:19], s38 offen  lds
v_mfma_f32_16x16x32_bf16 v[112:115], v[168:171], a[212:215], v[112:115]
s_add_u32 s12, s4, s43
s_addc_u32 s13, s5, 0
s_mov_b32 s14, s44
v_mfma_f32_16x16x32_bf16 v[120:123], v[168:171], a[236:239], v[120:123]
s_waitcnt lgkmcnt(3)
v_or3_b32 v30, v30, v137, v138
v_fma_f32 v29, v87, s28, v18
v_mfma_f32_16x16x32_bf16 v[100:103], v[172:175], a[164:167], v[100:103]
ds_read_b128 v[168:171], v2 offset:128
v_fma_f32 v24, v88, s28, v19
v_mfma_f32_16x16x32_bf16 v[108:111], v[172:175], a[188:191], v[108:111]
v_exp_f32_e64 v28, v28
v_mfma_f32_16x16x32_bf16 v[116:119], v[172:175], a[212:215], v[116:119]
v_exp_f32 v29, v29
v_mfma_f32_16x16x32_bf16 v[124:127], v[172:175], a[236:239], v[124:127]
s_waitcnt lgkmcnt(3)
v_cvt_pk_bf16_f32 v139, v28, v29
v_fma_f32 v25, v89, s28, v19
v_mfma_f32_16x16x32_bf16 v[96:99], v[160:163], a[168:171], v[96:99]
ds_read_b128 v[172:175], v2 offset:6272
v_xor_b32_e64 v31, 32, v15
v_mfma_f32_16x16x32_bf16 v[104:107], v[160:163], a[192:195], v[104:107]
ds_write_b64 v31, v[234:235] offset:2048
v_mfma_f32_16x16x32_bf16 v[112:115], v[160:163], a[216:219], v[112:115]
v_exp_f32_e64 v24, v24
v_mfma_f32_16x16x32_bf16 v[120:123], v[160:163], a[240:243], v[120:123]
s_waitcnt lgkmcnt(3)
v_exp_f32 v25, v25
v_mfma_f32_16x16x32_bf16 v[100:103], v[164:167], a[168:171], v[100:103]
ds_read_b128 v[160:163], v1 offset:256
v_cvt_pk_bf16_f32 v140, v24, v25
v_mfma_f32_16x16x32_bf16 v[108:111], v[164:167], a[192:195], v[108:111]
buffer_load_dwordx4 v8, s[16:19], s38 offen offset:1024  lds
v_mfma_f32_16x16x32_bf16 v[116:119], v[164:167], a[216:219], v[116:119]
v_or3_b32 v30, v30, v139, v140
v_fma_f32 v26, v90, s28, v19
v_mfma_f32_16x16x32_bf16 v[124:127], v[164:167], a[240:243], v[124:127]
s_waitcnt lgkmcnt(3)
v_exp_f32 v26, v26
v_mfma_f32_16x16x32_bf16 v[96:99], v[168:171], a[172:175], v[96:99]
ds_read_b128 v[164:167], v1 offset:6400
v_xor_b32_e64 v31, 64, v15
v_mfma_f32_16x16x32_bf16 v[104:107], v[168:171], a[196:199], v[104:107]
ds_write_b64 v31, v[236:237] offset:2048
v_mfma_f32_16x16x32_bf16 v[112:115], v[168:171], a[220:223], v[112:115]
v_fma_f32 v27, v91, s28, v19
v_fma_f32 v28, v92, s28, v19
v_mfma_f32_16x16x32_bf16 v[120:123], v[168:171], a[244:247], v[120:123]
s_waitcnt lgkmcnt(4)
v_exp_f32 v27, v27
v_mfma_f32_16x16x32_bf16 v[100:103], v[172:175], a[172:175], v[100:103]
s_sub_u32 s51, s32, s34
ds_read_b128 v[168:171], v2 offset:256
v_add_u32 v3, s51, v3
v_mfma_f32_16x16x32_bf16 v[108:111], v[172:175], a[196:199], v[108:111]
v_add_u32 v4, s51, v4
v_add_u32 v5, s51, v5
v_mfma_f32_16x16x32_bf16 v[116:119], v[172:175], a[220:223], v[116:119]
v_add_u32_e64 v6, s51, v6
v_cvt_pk_bf16_f32 v141, v26, v27
v_mfma_f32_16x16x32_bf16 v[124:127], v[172:175], a[244:247], v[124:127]
s_waitcnt lgkmcnt(3)
v_exp_f32 v28, v28
v_mfma_f32_16x16x32_bf16 v[96:99], v[160:163], a[176:179], v[96:99]
ds_read_b128 v[172:175], v2 offset:6400
v_fma_f32 v29, v93, s28, v19
v_mfma_f32_16x16x32_bf16 v[104:107], v[160:163], a[200:203], v[104:107]
buffer_load_dwordx4 v9, s[16:19], s38 offen offset:2048  lds
v_mfma_f32_16x16x32_bf16 v[112:115], v[160:163], a[224:227], v[112:115]
v_exp_f32 v29, v29
v_mfma_f32_16x16x32_bf16 v[120:123], v[160:163], a[248:251], v[120:123]
s_waitcnt lgkmcnt(3)
v_xor_b32 v31, 96, v15
v_cvt_pk_bf16_f32 v142, v28, v29
v_mfma_f32_16x16x32_bf16 v[100:103], v[164:167], a[176:179], v[100:103]
ds_read_b64_tr_b16 v[160:161], v3 offset:12288
ds_read_b64_tr_b16 v[162:163], v3 offset:18432
v_mfma_f32_16x16x32_bf16 v[108:111], v[164:167], a[200:203], v[108:111]
ds_write_b64 v31, v[238:239] offset:2048
v_mfma_f32_16x16x32_bf16 v[116:119], v[164:167], a[224:227], v[116:119]
v_or3_b32 v30, v30, v141, v142
v_fma_f32 v24, v94, s28, v19
v_mfma_f32_16x16x32_bf16 v[124:127], v[164:167], a[248:251], v[124:127]
s_waitcnt lgkmcnt(4)
v_exp_f32_e64 v24, v24
v_mfma_f32_16x16x32_bf16 v[96:99], v[168:171], a[180:183], v[96:99]
ds_read_b64_tr_b16 v[164:165], v4 offset:12288
ds_read_b64_tr_b16 v[166:167], v4 offset:18432
v_mfma_f32_16x16x32_bf16 v[104:107], v[168:171], a[204:207], v[104:107]
ds_read_b128 v[224:227], v13 offset:0
v_fma_f32 v25, v95, s28, v19
v_mfma_f32_16x16x32_bf16 v[112:115], v[168:171], a[228:231], v[112:115]
ds_read_b128 v[228:231], v13 offset:1024
v_mfma_f32_16x16x32_bf16 v[120:123], v[168:171], a[252:255], v[120:123]
s_waitcnt lgkmcnt(7)
ds_read_b128 v[232:235], v13 offset:2048
v_mfma_f32_16x16x32_bf16 v[100:103], v[172:175], a[180:183], v[100:103]
ds_read_b64_tr_b16 v[168:169], v5 offset:12288
ds_read_b64_tr_b16 v[170:171], v5 offset:18432
v_mfma_f32_16x16x32_bf16 v[108:111], v[172:175], a[204:207], v[108:111]
s_mov_b32 s50, 21504
ds_read_b128 v[236:239], v13 offset:3072
v_mfma_f32_16x16x32_bf16 v[116:119], v[172:175], a[228:231], v[116:119]
buffer_store_dwordx4 v[220:223], v14, s[24:27], s50 offen sc1 nt
v_mfma_f32_16x16x32_bf16 v[124:127], v[172:175], a[252:255], v[124:127]
v_exp_f32 v25, v25
s_nop 0
v_cvt_pk_bf16_f32 v143, v24, v25
v_or_b32 v30, v30, v143
v_and_b32 v30, s29, v30
v_cmp_ne_u32 vcc, 0, v30
s_cbranch_vccnz L_tr6
L_bk6:
v_mfma_f32_16x16x32_bf16 v[20:23], v[180:183], v[128:131], v[20:23]
v_mfma_f32_16x16x32_bf16 v[176:179], v[180:183], v[132:135], v[176:179]
v_fma_f32 v24, v96, s28, v16
v_fma_f32 v25, v97, s28, v16
v_mfma_f32_16x16x32_bf16 v[184:187], v[180:183], v[136:139], v[184:187]
v_exp_f32_e64 v24, v24
v_mfma_f32_16x16x32_bf16 v[188:191], v[180:183], v[140:143], v[188:191]
s_waitcnt lgkmcnt(9)
v_exp_f32 v25, v25
v_mfma_f32_16x16x32_bf16 a[0:3], v[160:163], v[128:131], a[0:3]
ds_read_b64_tr_b16 v[172:173], v6 offset:12288
ds_read_b64_tr_b16 v[174:175], v6 offset:18432
v_mfma_f32_16x16x32_bf16 a[40:43], v[160:163], v[132:135], a[40:43]
v_cvt_pk_bf16_f32 v144, v24, v25
v_fma_f32 v26, v98, s28, v16
v_mfma_f32_16x16x32_bf16 a[80:83], v[160:163], v[136:139], a[80:83]
v_exp_f32 v26, v26
v_mfma_f32_16x16x32_bf16 a[120:123], v[160:163], v[140:143], a[120:123]
s_waitcnt lgkmcnt(8)
v_fma_f32 v27, v99, s28, v16
v_fma_f32 v28, v100, s28, v16
v_mfma_f32_16x16x32_bf16 a[4:7], v[164:167], v[128:131], a[4:7]
ds_read_b64_tr_b16 v[160:161], v3 offset:12416
ds_read_b64_tr_b16 v[162:163], v3 offset:18560
v_mfma_f32_16x16x32_bf16 a[44:47], v[164:167], v[132:135], a[44:47]
v_exp_f32_e64 v27, v27
v_mfma_f32_16x16x32_bf16 a[84:87], v[164:167], v[136:139], a[84:87]
v_cvt_pk_bf16_f32 v145, v26, v27
v_fma_f32 v29, v101, s28, v16
v_mfma_f32_16x16x32_bf16 a[124:127], v[164:167], v[140:143], a[124:127]
s_waitcnt lgkmcnt(5)
v_exp_f32 v28, v28
v_mfma_f32_16x16x32_bf16 a[8:11], v[168:171], v[128:131], a[8:11]
ds_read_b64_tr_b16 v[164:165], v4 offset:12416
ds_read_b64_tr_b16 v[166:167], v4 offset:18560
v_mfma_f32_16x16x32_bf16 a[48:51], v[168:171], v[132:135], a[48:51]
s_waitcnt vmcnt(27)
s_barrier
v_mfma_f32_16x16x32_bf16 a[88:91], v[168:171], v[136:139], a[88:91]
s_add_u32 m0, s37, 36864
v_exp_f32 v29, v29
v_mfma_f32_16x16x32_bf16 a[128:131], v[168:171], v[140:143], a[128:131]
s_waitcnt lgkmcnt(4)
v_cvt_pk_bf16_f32 v146, v28, v29
v_or3_b32 v30, v144, v145, v146
v_mfma_f32_16x16x32_bf16 a[12:15], v[172:175], v[128:131], a[12:15]
s_mov_b32 s38, 135168
ds_read_b64_tr_b16 v[168:169], v5 offset:12416
ds_read_b64_tr_b16 v[170:171], v5 offset:18560
v_mfma_f32_16x16x32_bf16 a[52:55], v[172:175], v[132:135], a[52:55]
buffer_load_dwordx4 v10, s[20:23], s38 offen  lds
v_mfma_f32_16x16x32_bf16 a[92:95], v[172:175], v[136:139], a[92:95]
v_fma_f32 v24, v102, s28, v16
v_fma_f32 v25, v103, s28, v16
v_mfma_f32_16x16x32_bf16 a[132:135], v[172:175], v[140:143], a[132:135]
s_waitcnt lgkmcnt(4)
v_exp_f32 v24, v24
v_mfma_f32_16x16x32_bf16 a[16:19], v[160:163], v[128:131], a[16:19]
ds_read_b64_tr_b16 v[172:173], v6 offset:12416
ds_read_b64_tr_b16 v[174:175], v6 offset:18560
v_mfma_f32_16x16x32_bf16 a[56:59], v[160:163], v[132:135], a[56:59]
v_exp_f32 v25, v25
v_mfma_f32_16x16x32_bf16 a[96:99], v[160:163], v[136:139], a[96:99]
v_cvt_pk_bf16_f32 v147, v24, v25
v_mfma_f32_16x16x32_bf16 a[136:139], v[160:163], v[140:143], a[136:139]
s_waitcnt lgkmcnt(4)
v_fma_f32 v26, v104, s28, v17
v_fma_f32 v27, v105, s28, v17
v_mfma_f32_16x16x32_bf16 a[20:23], v[164:167], v[128:131], a[20:23]
ds_read_b64_tr_b16 v[160:161], v3 offset:12544
ds_read_b64_tr_b16 v[162:163], v3 offset:18688
v_mfma_f32_16x16x32_bf16 a[60:63], v[164:167], v[132:135], a[60:63]
buffer_load_dwordx4 v11, s[20:23], s38 offen offset:1024  lds
v_mfma_f32_16x16x32_bf16 a[100:103], v[164:167], v[136:139], a[100:103]
v_exp_f32_e64 v26, v26
v_mfma_f32_16x16x32_bf16 a[140:143], v[164:167], v[140:143], a[140:143]
s_waitcnt lgkmcnt(4)
v_exp_f32 v27, v27
v_mfma_f32_16x16x32_bf16 a[24:27], v[168:171], v[128:131], a[24:27]
ds_read_b64_tr_b16 v[164:165], v4 offset:12544
ds_read_b64_tr_b16 v[166:167], v4 offset:18688
v_mfma_f32_16x16x32_bf16 a[64:67], v[168:171], v[132:135], a[64:67]
v_cvt_pk_bf16_f32 v148, v26, v27
v_or3_b32 v30, v30, v147, v148
v_mfma_f32_16x16x32_bf16 a[104:107], v[168:171], v[136:139], a[104:107]
v_fma_f32 v28, v106, s28, v17
v_fma_f32 v29, v107, s28, v17
v_mfma_f32_16x16x32_bf16 a[144:147], v[168:171], v[140:143], a[144:147]
s_waitcnt lgkmcnt(4)
v_exp_f32 v28, v28
v_mfma_f32_16x16x32_bf16 a[28:31], v[172:175], v[128:131], a[28:31]
ds_read_b64_tr_b16 v[168:169], v5 offset:12544
ds_read_b64_tr_b16 v[170:171], v5 offset:18688
v_mfma_f32_16x16x32_bf16 a[68:71], v[172:175], v[132:135], a[68:71]
v_mfma_f32_16x16x32_bf16 a[108:111], v[172:175], v[136:139], a[108:111]
v_exp_f32 v29, v29
v_mfma_f32_16x16x32_bf16 a[148:151], v[172:175], v[140:143], a[148:151]
s_waitcnt lgkmcnt(4)
v_cvt_pk_bf16_f32 v149, v28, v29
v_fma_f32 v24, v108, s28, v17
v_mfma_f32_16x16x32_bf16 a[32:35], v[160:163], v[128:131], a[32:35]
ds_read_b64_tr_b16 v[172:173], v6 offset:12544
ds_read_b64_tr_b16 v[174:175], v6 offset:18688
v_mfma_f32_16x16x32_bf16 a[72:75], v[160:163], v[132:135], a[72:75]
buffer_load_dwordx4 v12, s[20:23], s38 offen offset:2048  lds
v_mfma_f32_16x16x32_bf16 a[112:115], v[160:163], v[136:139], a[112:115]
v_exp_f32 v24, v24
v_mfma_f32_16x16x32_bf16 a[152:155], v[160:163], v[140:143], a[152:155]
s_waitcnt lgkmcnt(4)
v_fma_f32 v25, v109, s28, v17
v_fma_f32 v26, v110, s28, v17
v_mfma_f32_16x16x32_bf16 a[36:39], v[164:167], v[128:131], a[36:39]
ds_read_b128 v[160:163], v1 offset:24576
v_fma_f32 v27, v111, s28, v17
v_mfma_f32_16x16x32_bf16 a[76:79], v[164:167], v[132:135], a[76:79]
v_exp_f32_e64 v25, v25
v_mfma_f32_16x16x32_bf16 a[116:119], v[164:167], v[136:139], a[116:119]
v_cvt_pk_bf16_f32 v150, v24, v25
v_or3_b32 v30, v30, v149, v150
v_mfma_f32_16x16x32_bf16 a[156:159], v[164:167], v[140:143], a[156:159]
s_waitcnt lgkmcnt(3)
v_exp_f32 v26, v26
v_mfma_f32_16x16x32_bf16 v[32:35], v[168:171], v[128:131], v[32:35]
ds_read_b128 v[164:167], v1 offset:30720
v_fma_f32 v28, v112, s28, v18
v_mfma_f32_16x16x32_bf16 v[40:43], v[168:171], v[132:135], v[40:43]
v_exp_f32_e64 v27, v27
v_mfma_f32_16x16x32_bf16 v[48:51], v[168:171], v[136:139], v[48:51]
v_cvt_pk_bf16_f32 v151, v26, v27
v_fma_f32 v29, v113, s28, v18
v_mfma_f32_16x16x32_bf16 v[56:59], v[168:171], v[140:143], v[56:59]
s_waitcnt lgkmcnt(2)
v_exp_f32 v28, v28
v_mfma_f32_16x16x32_bf16 v[36:39], v[172:175], v[128:131], v[36:39]
s_mov_b32 s50, 12416
ds_read_b128 v[168:171], v2 offset:24576
v_fma_f32 v24, v114, s28, v18
v_mfma_f32_16x16x32_bf16 v[44:47], v[172:175], v[132:135], v[44:47]
buffer_store_dwordx4 v[224:227], v14, s[24:27], s50 offen sc1 nt
v_mfma_f32_16x16x32_bf16 v[52:55], v[172:175], v[136:139], v[52:55]
v_exp_f32 v29, v29
v_mfma_f32_16x16x32_bf16 v[60:63], v[172:175], v[140:143], v[60:63]
s_waitcnt lgkmcnt(2)
v_cvt_pk_bf16_f32 v152, v28, v29
v_or3_b32 v30, v30, v151, v152
v_mfma_f32_16x16x32_bf16 v[64:67], v[160:163], a[160:163], 0
ds_read_b128 v[172:175], v2 offset:30720
v_fma_f32 v25, v115, s28, v18
v_mfma_f32_16x16x32_bf16 v[72:75], v[160:163], a[184:187], 0
v_mfma_f32_16x16x32_bf16 v[80:83], v[160:163], a[208:211], 0
v_exp_f32_e64 v24, v24
v_mfma_f32_16x16x32_bf16 v[88:91], v[160:163], a[232:235], 0
s_waitcnt lgkmcnt(2)
v_exp_f32 v25, v25
v_mfma_f32_16x16x32_bf16 v[68:71], v[164:167], a[160:163], 0
ds_read_b128 v[160:163], v1 offset:24704
v_cvt_pk_bf16_f32 v153, v24, v25
v_mfma_f32_16x16x32_bf16 v[76:79], v[164:167], a[184:187], 0
ds_write_b64 v15, v[240:241] offset:0
v_mfma_f32_16x16x32_bf16 v[84:87], v[164:167], a[208:211], 0
s_add_u32 m0, s35, 0
v_fma_f32 v26, v116, s28, v18
v_fma_f32 v27, v117, s28, v18
v_mfma_f32_16x16x32_bf16 v[92:95], v[164:167], a[232:235], 0
s_waitcnt lgkmcnt(3)
v_exp_f32_e64 v26, v26
v_mfma_f32_16x16x32_bf16 v[64:67], v[168:171], a[164:167], v[64:67]
s_mov_b32 s38, 159744
ds_read_b128 v[164:167], v1 offset:30848
v_fma_f32 v28, v118, s28, v18
v_mfma_f32_16x16x32_bf16 v[72:75], v[168:171], a[188:191], v[72:75]
buffer_load_dwordx4 v7, s[16:19], s38 offen  lds
v_mfma_f32_16x16x32_bf16 v[80:83], v[168:171], a[212:215], v[80:83]
v_exp_f32 v27, v27
v_mfma_f32_16x16x32_bf16 v[88:91], v[168:171], a[236:239], v[88:91]
s_waitcnt lgkmcnt(3)
v_cvt_pk_bf16_f32 v154, v26, v27
v_or3_b32 v30, v30, v153, v154
v_mfma_f32_16x16x32_bf16 v[68:71], v[172:175], a[164:167], v[68:71]
ds_read_b128 v[168:171], v2 offset:24704
v_fma_f32 v29, v119, s28, v18
v_mfma_f32_16x16x32_bf16 v[76:79], v[172:175], a[188:191], v[76:79]
v_exp_f32_e64 v28, v28
v_mfma_f32_16x16x32_bf16 v[84:87], v[172:175], a[212:215], v[84:87]
v_exp_f32 v29, v29
v_mfma_f32_16x16x32_bf16 v[92:95], v[172:175], a[236:239], v[92:95]
s_waitcnt lgkmcnt(3)
v_cvt_pk_bf16_f32 v155, v28, v29
v_fma_f32 v24, v120, s28, v19
v_mfma_f32_16x16x32_bf16 v[64:67], v[160:163], a[168:171], v[64:67]
ds_read_b128 v[172:175], v2 offset:30848
v_xor_b32_e64 v31, 32, v15
v_mfma_f32_16x16x32_bf16 v[72:75], v[160:163], a[192:195], v[72:75]
ds_write_b64 v31, v[242:243] offset:0
v_mfma_f32_16x16x32_bf16 v[80:83], v[160:163], a[216:219], v[80:83]
v_exp_f32 v24, v24
v_mfma_f32_16x16x32_bf16 v[88:91], v[160:163], a[240:243], v[88:91]
s_waitcnt lgkmcnt(3)
v_fma_f32 v25, v121, s28, v19
v_fma_f32 v26, v122, s28, v19
v_mfma_f32_16x16x32_bf16 v[68:71], v[164:167], a[168:171], v[68:71]
ds_read_b128 v[160:163], v1 offset:24832
v_fma_f32 v27, v123, s28, v19
v_mfma_f32_16x16x32_bf16 v[76:79], v[164:167], a[192:195], v[76:79]
buffer_load_dwordx4 v8, s[16:19], s38 offen offset:1024  lds
v_mfma_f32_16x16x32_bf16 v[84:87], v[164:167], a[216:219], v[84:87]
v_mfma_f32_16x16x32_bf16 v[92:95], v[164:167], a[240:243], v[92:95]
s_waitcnt lgkmcnt(3)
v_exp_f32 v25, v25
v_mfma_f32_16x16x32_bf16 v[64:67], v[168:171], a[172:175], v[64:67]
ds_read_b128 v[164:167], v1 offset:30976
v_xor_b32_e64 v31, 64, v15
v_mfma_f32_16x16x32_bf16 v[72:75], v[168:171], a[196:199], v[72:75]
ds_write_b64 v31, v[244:245] offset:0
v_mfma_f32_16x16x32_bf16 v[80:83], v[168:171], a[220:223], v[80:83]
v_cvt_pk_bf16_f32 v156, v24, v25
v_or3_b32 v30, v30, v155, v156
v_mfma_f32_16x16x32_bf16 v[88:91], v[168:171], a[244:247], v[88:91]
s_waitcnt lgkmcnt(4)
v_exp_f32 v26, v26
v_mfma_f32_16x16x32_bf16 v[68:71], v[172:175], a[172:175], v[68:71]
ds_read_b128 v[168:171], v2 offset:24832
v_fma_f32 v28, v124, s28, v19
v_mfma_f32_16x16x32_bf16 v[76:79], v[172:175], a[196:199], v[76:79]
v_exp_f32_e64 v27, v27
v_mfma_f32_16x16x32_bf16 v[84:87], v[172:175], a[220:223], v[84:87]
v_cvt_pk_bf16_f32 v157, v26, v27
v_fma_f32 v29, v125, s28, v19
v_mfma_f32_16x16x32_bf16 v[92:95], v[172:175], a[244:247], v[92:95]
s_waitcnt lgkmcnt(3)
v_exp_f32 v28, v28
v_mfma_f32_16x16x32_bf16 v[64:67], v[160:163], a[176:179], v[64:67]
ds_read_b128 v[172:175], v2 offset:30976
v_fma_f32 v24, v126, s28, v19
v_mfma_f32_16x16x32_bf16 v[72:75], v[160:163], a[200:203], v[72:75]
buffer_load_dwordx4 v9, s[16:19], s38 offen offset:2048  lds
v_mfma_f32_16x16x32_bf16 v[80:83], v[160:163], a[224:227], v[80:83]
v_exp_f32 v29, v29
v_mfma_f32_16x16x32_bf16 v[88:91], v[160:163], a[248:251], v[88:91]
s_waitcnt lgkmcnt(3)
v_xor_b32 v31, 96, v15
v_cvt_pk_bf16_f32 v158, v28, v29
v_mfma_f32_16x16x32_bf16 v[68:71], v[164:167], a[176:179], v[68:71]
ds_read_b64_tr_b16 v[160:161], v3 offset:36864
ds_read_b64_tr_b16 v[162:163], v3 offset:43008
v_mfma_f32_16x16x32_bf16 v[76:79], v[164:167], a[200:203], v[76:79]
L_pad4:
s_cbranch_execz L_warm_next
ds_write_b64 v31, v[246:247] offset:0
v_mfma_f32_16x16x32_bf16 v[84:87], v[164:167], a[224:227], v[84:87]
v_or3_b32 v30, v30, v157, v158
v_fma_f32 v25, v127, s28, v19
v_mfma_f32_16x16x32_bf16 v[92:95], v[164:167], a[248:251], v[92:95]
s_waitcnt lgkmcnt(4)
v_exp_f32_e64 v24, v24
v_mfma_f32_16x16x32_bf16 v[64:67], v[168:171], a[180:183], v[64:67]
ds_read_b64_tr_b16 v[164:165], v4 offset:36864
ds_read_b64_tr_b16 v[166:167], v4 offset:43008
v_mfma_f32_16x16x32_bf16 v[72:75], v[168:171], a[204:207], v[72:75]
s_mov_b32 s50, 15488
v_exp_f32_e64 v25, v25
v_mfma_f32_16x16x32_bf16 v[80:83], v[168:171], a[228:231], v[80:83]
buffer_store_dwordx4 v[228:231], v14, s[24:27], s50 offen sc1 nt
v_mfma_f32_16x16x32_bf16 v[88:91], v[168:171], a[252:255], v[88:91]
s_waitcnt lgkmcnt(5)
v_cvt_pk_bf16_f32 v159, v24, v25
v_or_b32 v30, v30, v159
v_mfma_f32_16x16x32_bf16 v[68:71], v[172:175], a[180:183], v[68:71]
ds_read_b64_tr_b16 v[168:169], v5 offset:36864
ds_read_b64_tr_b16 v[170:171], v5 offset:43008
v_mfma_f32_16x16x32_bf16 v[76:79], v[172:175], a[204:207], v[76:79]
v_and_b32_e64 v30, s29, v30
v_cmp_ne_u32 vcc, 0, v30
v_mfma_f32_16x16x32_bf16 v[84:87], v[172:175], a[228:231], v[84:87]
v_mfma_f32_16x16x32_bf16 v[92:95], v[172:175], a[252:255], v[92:95]
s_cbranch_vccnz L_tr7
L_bk7:
v_mfma_f32_16x16x32_bf16 v[20:23], v[180:183], v[144:147], v[20:23]
v_mfma_f32_16x16x32_bf16 v[176:179], v[180:183], v[148:151], v[176:179]
v_fma_f32 v24, v64, s28, v16
v_fma_f32 v25, v65, s28, v16
v_mfma_f32_16x16x32_bf16 v[184:187], v[180:183], v[152:155], v[184:187]
v_exp_f32_e64 v24, v24
v_mfma_f32_16x16x32_bf16 v[188:191], v[180:183], v[156:159], v[188:191]
s_waitcnt lgkmcnt(5)
v_exp_f32 v25, v25
v_mfma_f32_16x16x32_bf16 a[0:3], v[160:163], v[144:147], a[0:3]
ds_read_b64_tr_b16 v[172:173], v6 offset:36864
ds_read_b64_tr_b16 v[174:175], v6 offset:43008
v_mfma_f32_16x16x32_bf16 a[40:43], v[160:163], v[148:151], a[40:43]
v_cvt_pk_bf16_f32 v128, v24, v25
v_fma_f32 v26, v66, s28, v16
v_mfma_f32_16x16x32_bf16 a[80:83], v[160:163], v[152:155], a[80:83]
v_exp_f32 v26, v26
v_mfma_f32_16x16x32_bf16 a[120:123], v[160:163], v[156:159], a[120:123]
s_waitcnt lgkmcnt(4)
v_fma_f32 v27, v67, s28, v16
v_fma_f32 v28, v68, s28, v16
v_mfma_f32_16x16x32_bf16 a[4:7], v[164:167], v[144:147], a[4:7]
ds_read_b64_tr_b16 v[160:161], v3 offset:36992
ds_read_b64_tr_b16 v[162:163], v3 offset:43136
v_mfma_f32_16x16x32_bf16 a[44:47], v[164:167], v[148:151], a[44:47]
v_exp_f32_e64 v27, v27
v_mfma_f32_16x16x32_bf16 a[84:87], v[164:167], v[152:155], a[84:87]
v_cvt_pk_bf16_f32 v129, v26, v27
v_fma_f32 v29, v69, s28, v16
v_mfma_f32_16x16x32_bf16 a[124:127], v[164:167], v[156:159], a[124:127]
s_waitcnt lgkmcnt(4)
v_exp_f32 v28, v28
v_mfma_f32_16x16x32_bf16 a[8:11], v[168:171], v[144:147], a[8:11]
ds_read_b64_tr_b16 v[164:165], v4 offset:36992
ds_read_b64_tr_b16 v[166:167], v4 offset:43136
v_mfma_f32_16x16x32_bf16 a[48:51], v[168:171], v[148:151], a[48:51]
s_waitcnt vmcnt(28)
s_barrier
v_mfma_f32_16x16x32_bf16 a[88:91], v[168:171], v[152:155], a[88:91]
s_add_u32 m0, s35, 12288
v_exp_f32 v29, v29
v_mfma_f32_16x16x32_bf16 a[128:131], v[168:171], v[156:159], a[128:131]
s_waitcnt lgkmcnt(4)
v_cvt_pk_bf16_f32 v130, v28, v29
v_or3_b32 v30, v128, v129, v130
v_mfma_f32_16x16x32_bf16 a[12:15], v[172:175], v[144:147], a[12:15]
s_mov_b32 s38, 147456
ds_read_b64_tr_b16 v[168:169], v5 offset:36992
ds_read_b64_tr_b16 v[170:171], v5 offset:43136
v_mfma_f32_16x16x32_bf16 a[52:55], v[172:175], v[148:151], a[52:55]
buffer_load_dwordx4 v10, s[20:23], s38 offen  lds
v_mfma_f32_16x16x32_bf16 a[92:95], v[172:175], v[152:155], a[92:95]
v_fma_f32 v24, v70, s28, v16
v_fma_f32 v25, v71, s28, v16
v_mfma_f32_16x16x32_bf16 a[132:135], v[172:175], v[156:159], a[132:135]
s_waitcnt lgkmcnt(4)
v_exp_f32 v24, v24
v_mfma_f32_16x16x32_bf16 a[16:19], v[160:163], v[144:147], a[16:19]
ds_read_b64_tr_b16 v[172:173], v6 offset:36992
ds_read_b64_tr_b16 v[174:175], v6 offset:43136
v_mfma_f32_16x16x32_bf16 a[56:59], v[160:163], v[148:151], a[56:59]
v_exp_f32_e64 v25, v25
v_mfma_f32_16x16x32_bf16 a[96:99], v[160:163], v[152:155], a[96:99]
v_cvt_pk_bf16_f32 v131, v24, v25
v_fma_f32 v26, v72, s28, v17
v_mfma_f32_16x16x32_bf16 a[136:139], v[160:163], v[156:159], a[136:139]
s_waitcnt lgkmcnt(4)
v_exp_f32 v26, v26
v_mfma_f32_16x16x32_bf16 a[20:23], v[164:167], v[144:147], a[20:23]
ds_read_b64_tr_b16 v[160:161], v3 offset:37120
ds_read_b64_tr_b16 v[162:163], v3 offset:43264
v_mfma_f32_16x16x32_bf16 a[60:63], v[164:167], v[148:151], a[60:63]
buffer_load_dwordx4 v11, s[20:23], s38 offen offset:1024  lds
v_mfma_f32_16x16x32_bf16 a[100:103], v[164:167], v[152:155], a[100:103]
v_fma_f32 v27, v73, s28, v17
v_fma_f32 v28, v74, s28, v17
v_mfma_f32_16x16x32_bf16 a[140:143], v[164:167], v[156:159], a[140:143]
s_waitcnt lgkmcnt(4)
v_exp_f32 v27, v27
v_mfma_f32_16x16x32_bf16 a[24:27], v[168:171], v[144:147], a[24:27]
ds_read_b64_tr_b16 v[164:165], v4 offset:37120
ds_read_b64_tr_b16 v[166:167], v4 offset:43264
v_mfma_f32_16x16x32_bf16 a[64:67], v[168:171], v[148:151], a[64:67]
v_cvt_pk_bf16_f32 v132, v26, v27
v_or3_b32 v30, v30, v131, v132
v_mfma_f32_16x16x32_bf16 a[104:107], v[168:171], v[152:155], a[104:107]
v_exp_f32 v28, v28
v_mfma_f32_16x16x32_bf16 a[144:147], v[168:171], v[156:159], a[144:147]
s_waitcnt lgkmcnt(4)
v_fma_f32 v29, v75, s28, v17
v_fma_f32 v24, v76, s28, v17
v_mfma_f32_16x16x32_bf16 a[28:31], v[172:175], v[144:147], a[28:31]
ds_read_b64_tr_b16 v[168:169], v5 offset:37120
ds_read_b64_tr_b16 v[170:171], v5 offset:43264
v_mfma_f32_16x16x32_bf16 a[68:71], v[172:175], v[148:151], a[68:71]
v_exp_f32_e64 v29, v29
v_mfma_f32_16x16x32_bf16 a[108:111], v[172:175], v[152:155], a[108:111]
v_cvt_pk_bf16_f32 v133, v28, v29
v_fma_f32 v25, v77, s28, v17
v_mfma_f32_16x16x32_bf16 a[148:151], v[172:175], v[156:159], a[148:151]
s_waitcnt lgkmcnt(4)
v_exp_f32_e64 v24, v24
v_mfma_f32_16x16x32_bf16 a[32:35], v[160:163], v[144:147], a[32:35]
s_sub_u32 s51, s33, s32
ds_read_b64_tr_b16 v[172:173], v6 offset:37120
ds_read_b64_tr_b16 v[174:175], v6 offset:43264
v_mfma_f32_16x16x32_bf16 a[72:75], v[160:163], v[148:151], a[72:75]
v_add_u32 v1, s51, v1
v_add_u32 v2, s51, v2
v_mfma_f32_16x16x32_bf16 a[112:115], v[160:163], v[152:155], a[112:115]
buffer_load_dwordx4 v12, s[20:23], s38 offen offset:2048  lds
v_mfma_f32_16x16x32_bf16 a[152:155], v[160:163], v[156:159], a[152:155]
s_waitcnt lgkmcnt(4)
v_exp_f32 v25, v25
v_mfma_f32_16x16x32_bf16 a[36:39], v[164:167], v[144:147], a[36:39]
ds_read_b128 v[160:163], v1 offset:0
v_cvt_pk_bf16_f32 v134, v24, v25
v_mfma_f32_16x16x32_bf16 a[76:79], v[164:167], v[148:151], a[76:79]
v_or3_b32 v30, v30, v133, v134
v_fma_f32 v26, v78, s28, v17
v_mfma_f32_16x16x32_bf16 a[116:119], v[164:167], v[152:155], a[116:119]
v_exp_f32 v26, v26
v_mfma_f32_16x16x32_bf16 a[156:159], v[164:167], v[156:159], a[156:159]
s_waitcnt lgkmcnt(3)
v_fma_f32 v27, v79, s28, v17
v_fma_f32 v28, v80, s28, v18
v_mfma_f32_16x16x32_bf16 v[32:35], v[168:171], v[144:147], v[32:35]
ds_read_b128 v[164:167], v1 offset:6144
v_fma_f32 v29, v81, s28, v18
v_mfma_f32_16x16x32_bf16 v[40:43], v[168:171], v[148:151], v[40:43]
v_exp_f32_e64 v27, v27
v_mfma_f32_16x16x32_bf16 v[48:51], v[168:171], v[152:155], v[48:51]
v_cvt_pk_bf16_f32 v135, v26, v27
v_fma_f32 v24, v82, s28, v18
v_mfma_f32_16x16x32_bf16 v[56:59], v[168:171], v[156:159], v[56:59]
s_waitcnt lgkmcnt(2)
v_exp_f32 v28, v28
v_mfma_f32_16x16x32_bf16 v[36:39], v[172:175], v[144:147], v[36:39]
s_mov_b32 s50, 18560
ds_read_b128 v[168:171], v2 offset:0
v_fma_f32 v25, v83, s28, v18
v_mfma_f32_16x16x32_bf16 v[44:47], v[172:175], v[148:151], v[44:47]
buffer_store_dwordx4 v[232:235], v14, s[24:27], s50 offen sc1 nt
v_mfma_f32_16x16x32_bf16 v[52:55], v[172:175], v[152:155], v[52:55]
v_exp_f32 v29, v29
v_mfma_f32_16x16x32_bf16 v[60:63], v[172:175], v[156:159], v[60:63]
s_waitcnt lgkmcnt(2)
v_cvt_pk_bf16_f32 v136, v28, v29
v_or3_b32 v30, v30, v135, v136
v_mfma_f32_16x16x32_bf16 v[96:99], v[160:163], a[160:163], 0
ds_read_b128 v[172:175], v2 offset:6144
v_fma_f32 v26, v84, s28, v18
v_mfma_f32_16x16x32_bf16 v[104:107], v[160:163], a[184:187], 0
v_exp_f32_e64 v24, v24
v_mfma_f32_16x16x32_bf16 v[112:115], v[160:163], a[208:211], 0
v_exp_f32 v25, v25
v_mfma_f32_16x16x32_bf16 v[120:123], v[160:163], a[232:235], 0
s_waitcnt lgkmcnt(2)
v_cvt_pk_bf16_f32 v137, v24, v25
v_fma_f32 v27, v85, s28, v18
v_mfma_f32_16x16x32_bf16 v[100:103], v[164:167], a[160:163], 0
ds_read_b128 v[160:163], v1 offset:128
v_fma_f32 v28, v86, s28, v18
v_mfma_f32_16x16x32_bf16 v[108:111], v[164:167], a[184:187], 0
ds_write_b64 v15, v[248:249] offset:2048
v_mfma_f32_16x16x32_bf16 v[116:119], v[164:167], a[208:211], 0
s_add_u32 m0, s35, 24576
v_exp_f32_e64 v26, v26
v_mfma_f32_16x16x32_bf16 v[124:127], v[164:167], a[232:235], 0
s_waitcnt lgkmcnt(3)
v_exp_f32 v27, v27
v_mfma_f32_16x16x32_bf16 v[96:99], v[168:171], a[164:167], v[96:99]
s_mov_b32 s38, 172032
ds_read_b128 v[164:167], v1 offset:6272
v_cvt_pk_bf16_f32 v138, v26, v27
v_mfma_f32_16x16x32_bf16 v[104:107], v[168:171], a[188:191], v[104:107]
buffer_load_dwordx4 v7, s[16:19], s38 offen  lds
v_mfma_f32_16x16x32_bf16 v[112:115], v[168:171], a[212:215], v[112:115]
v_or3_b32 v30, v30, v137, v138
v_fma_f32 v29, v87, s28, v18
v_mfma_f32_16x16x32_bf16 v[120:123], v[168:171], a[236:239], v[120:123]
s_waitcnt lgkmcnt(3)
v_exp_f32 v28, v28
v_mfma_f32_16x16x32_bf16 v[100:103], v[172:175], a[164:167], v[100:103]
ds_read_b128 v[168:171], v2 offset:128
v_fma_f32 v24, v88, s28, v19
v_mfma_f32_16x16x32_bf16 v[108:111], v[172:175], a[188:191], v[108:111]
v_exp_f32_e64 v29, v29
v_mfma_f32_16x16x32_bf16 v[116:119], v[172:175], a[212:215], v[116:119]
v_cvt_pk_bf16_f32 v139, v28, v29
v_fma_f32 v25, v89, s28, v19
v_mfma_f32_16x16x32_bf16 v[124:127], v[172:175], a[236:239], v[124:127]
s_waitcnt lgkmcnt(3)
v_exp_f32 v24, v24
v_mfma_f32_16x16x32_bf16 v[96:99], v[160:163], a[168:171], v[96:99]
ds_read_b128 v[172:175], v2 offset:6272
v_xor_b32_e64 v31, 32, v15
v_mfma_f32_16x16x32_bf16 v[104:107], v[160:163], a[192:195], v[104:107]
ds_write_b64 v31, v[250:251] offset:2048
v_mfma_f32_16x16x32_bf16 v[112:115], v[160:163], a[216:219], v[112:115]
v_exp_f32 v25, v25
v_mfma_f32_16x16x32_bf16 v[120:123], v[160:163], a[240:243], v[120:123]
s_waitcnt lgkmcnt(3)
v_cvt_pk_bf16_f32 v140, v24, v25
v_or3_b32 v30, v30, v139, v140
v_mfma_f32_16x16x32_bf16 v[100:103], v[164:167], a[168:171], v[100:103]
ds_read_b128 v[160:163], v1 offset:256
v_fma_f32 v26, v90, s28, v19
v_mfma_f32_16x16x32_bf16 v[108:111], v[164:167], a[192:195], v[108:111]
buffer_load_dwordx4 v8, s[16:19], s38 offen offset:1024  lds
v_mfma_f32_16x16x32_bf16 v[116:119], v[164:167], a[216:219], v[116:119]
v_exp_f32 v26, v26
v_mfma_f32_16x16x32_bf16 v[124:127], v[164:167], a[240:243], v[124:127]
s_waitcnt lgkmcnt(3)
v_fma_f32 v27, v91, s28, v19
v_fma_f32 v28, v92, s28, v19
v_mfma_f32_16x16x32_bf16 v[96:99], v[168:171], a[172:175], v[96:99]
ds_read_b128 v[164:167], v1 offset:6400
v_xor_b32_e64 v31, 64, v15
v_mfma_f32_16x16x32_bf16 v[104:107], v[168:171], a[196:199], v[104:107]
ds_write_b64 v31, v[252:253] offset:2048
v_mfma_f32_16x16x32_bf16 v[112:115], v[168:171], a[220:223], v[112:115]
v_exp_f32 v27, v27
v_mfma_f32_16x16x32_bf16 v[120:123], v[168:171], a[244:247], v[120:123]
s_waitcnt lgkmcnt(4)
v_cvt_pk_bf16_f32 v141, v26, v27
v_fma_f32 v29, v93, s28, v19
v_mfma_f32_16x16x32_bf16 v[100:103], v[172:175], a[172:175], v[100:103]
s_sub_u32 s51, s33, s32
ds_read_b128 v[168:171], v2 offset:256
v_add_u32 v3, s51, v3
v_mfma_f32_16x16x32_bf16 v[108:111], v[172:175], a[196:199], v[108:111]
v_add_u32 v4, s51, v4
v_add_u32 v5, s51, v5
v_mfma_f32_16x16x32_bf16 v[116:119], v[172:175], a[220:223], v[116:119]
v_add_u32_e64 v6, s51, v6
v_fma_f32 v24, v94, s28, v19
v_mfma_f32_16x16x32_bf16 v[124:127], v[172:175], a[244:247], v[124:127]
s_waitcnt lgkmcnt(3)
v_exp_f32 v28, v28
v_mfma_f32_16x16x32_bf16 v[96:99], v[160:163], a[176:179], v[96:99]
ds_read_b128 v[172:175], v2 offset:6400
v_fma_f32 v25, v95, s28, v19
v_mfma_f32_16x16x32_bf16 v[104:107], v[160:163], a[200:203], v[104:107]
buffer_load_dwordx4 v9, s[16:19], s38 offen offset:2048  lds
v_mfma_f32_16x16x32_bf16 v[112:115], v[160:163], a[224:227], v[112:115]
v_exp_f32 v29, v29
v_mfma_f32_16x16x32_bf16 v[120:123], v[160:163], a[248:251], v[120:123]
s_waitcnt lgkmcnt(3)
v_xor_b32 v31, 96, v15
v_cvt_pk_bf16_f32 v142, v28, v29
v_mfma_f32_16x16x32_bf16 v[100:103], v[164:167], a[176:179], v[100:103]
ds_read_b64_tr_b16 v[160:161], v3 offset:12288
ds_read_b64_tr_b16 v[162:163], v3 offset:18432
v_mfma_f32_16x16x32_bf16 v[108:111], v[164:167], a[200:203], v[108:111]
ds_write_b64 v31, v[254:255] offset:2048
v_mfma_f32_16x16x32_bf16 v[116:119], v[164:167], a[224:227], v[116:119]
v_or3_b32 v30, v30, v141, v142
v_mfma_f32_16x16x32_bf16 v[124:127], v[164:167], a[248:251], v[124:127]
s_waitcnt lgkmcnt(4)
v_exp_f32_e64 v24, v24
v_mfma_f32_16x16x32_bf16 v[96:99], v[168:171], a[180:183], v[96:99]
ds_read_b64_tr_b16 v[164:165], v4 offset:12288
ds_read_b64_tr_b16 v[166:167], v4 offset:18432
v_mfma_f32_16x16x32_bf16 v[104:107], v[168:171], a[204:207], v[104:107]
ds_read_b128 v[240:243], v13 offset:0
v_mfma_f32_16x16x32_bf16 v[112:115], v[168:171], a[228:231], v[112:115]
ds_read_b128 v[244:247], v13 offset:1024
v_mfma_f32_16x16x32_bf16 v[120:123], v[168:171], a[252:255], v[120:123]
s_waitcnt lgkmcnt(7)
ds_read_b128 v[248:251], v13 offset:2048
v_mfma_f32_16x16x32_bf16 v[100:103], v[172:175], a[180:183], v[100:103]
ds_read_b64_tr_b16 v[168:169], v5 offset:12288
ds_read_b64_tr_b16 v[170:171], v5 offset:18432
v_mfma_f32_16x16x32_bf16 v[108:111], v[172:175], a[204:207], v[108:111]
s_mov_b32 s50, 21632
ds_read_b128 v[252:255], v13 offset:3072
v_mfma_f32_16x16x32_bf16 v[116:119], v[172:175], a[228:231], v[116:119]
buffer_store_dwordx4 v[236:239], v14, s[24:27], s50 offen sc1 nt
v_mfma_f32_16x16x32_bf16 v[124:127], v[172:175], a[252:255], v[124:127]
v_exp_f32 v25, v25
s_nop 0
v_cvt_pk_bf16_f32 v143, v24, v25
v_or_b32 v30, v30, v143
v_and_b32 v30, s29, v30
v_cmp_ne_u32 vcc, 0, v30
s_cbranch_vccnz L_tr8
L_bk8:
v_mfma_f32_16x16x32_bf16 v[20:23], v[180:183], v[128:131], v[20:23]
v_mfma_f32_16x16x32_bf16 v[176:179], v[180:183], v[132:135], v[176:179]
v_fma_f32 v24, v96, s28, v16
v_fma_f32 v25, v97, s28, v16
v_mfma_f32_16x16x32_bf16 v[184:187], v[180:183], v[136:139], v[184:187]
v_exp_f32_e64 v24, v24
v_mfma_f32_16x16x32_bf16 v[188:191], v[180:183], v[140:143], v[188:191]
s_waitcnt lgkmcnt(9)
v_exp_f32 v25, v25
v_mfma_f32_16x16x32_bf16 a[0:3], v[160:163], v[128:131], a[0:3]
ds_read_b64_tr_b16 v[172:173], v6 offset:12288
ds_read_b64_tr_b16 v[174:175], v6 offset:18432
v_mfma_f32_16x16x32_bf16 a[40:43], v[160:163], v[132:135], a[40:43]
v_cvt_pk_bf16_f32 v144, v24, v25
v_fma_f32 v26, v98, s28, v16
v_mfma_f32_16x16x32_bf16 a[80:83], v[160:163], v[136:139], a[80:83]
v_exp_f32 v26, v26
v_mfma_f32_16x16x32_bf16 a[120:123], v[160:163], v[140:143], a[120:123]
s_waitcnt lgkmcnt(8)
v_fma_f32 v27, v99, s28, v16
v_fma_f32 v28, v100, s28, v16
v_mfma_f32_16x16x32_bf16 a[4:7], v[164:167], v[128:131], a[4:7]
ds_read_b64_tr_b16 v[160:161], v3 offset:12416
ds_read_b64_tr_b16 v[162:163], v3 offset:18560
v_mfma_f32_16x16x32_bf16 a[44:47], v[164:167], v[132:135], a[44:47]
v_exp_f32_e64 v27, v27
v_mfma_f32_16x16x32_bf16 a[84:87], v[164:167], v[136:139], a[84:87]
v_cvt_pk_bf16_f32 v145, v26, v27
v_mfma_f32_16x16x32_bf16 a[124:127], v[164:167], v[140:143], a[124:127]
s_waitcnt lgkmcnt(5)
v_exp_f32 v28, v28
v_mfma_f32_16x16x32_bf16 a[8:11], v[168:171], v[128:131], a[8:11]
ds_read_b64_tr_b16 v[164:165], v4 offset:12416
ds_read_b64_tr_b16 v[166:167], v4 offset:18560
v_mfma_f32_16x16x32_bf16 a[48:51], v[168:171], v[132:135], a[48:51]
s_waitcnt vmcnt(28)
s_barrier
v_mfma_f32_16x16x32_bf16 a[88:91], v[168:171], v[136:139], a[88:91]
s_add_u32 m0, s35, 36864
v_fma_f32 v29, v101, s28, v16
v_fma_f32 v24, v102, s28, v16
v_mfma_f32_16x16x32_bf16 a[128:131], v[168:171], v[140:143], a[128:131]
s_waitcnt lgkmcnt(4)
v_mfma_f32_16x16x32_bf16 a[12:15], v[172:175], v[128:131], a[12:15]
s_mov_b32 s38, 159744
ds_read_b64_tr_b16 v[168:169], v5 offset:12416
ds_read_b64_tr_b16 v[170:171], v5 offset:18560
v_mfma_f32_16x16x32_bf16 a[52:55], v[172:175], v[132:135], a[52:55]
buffer_load_dwordx4 v10, s[20:23], s38 offen  lds
v_mfma_f32_16x16x32_bf16 a[92:95], v[172:175], v[136:139], a[92:95]
v_exp_f32_e64 v29, v29
v_mfma_f32_16x16x32_bf16 a[132:135], v[172:175], v[140:143], a[132:135]
s_waitcnt lgkmcnt(4)
v_cvt_pk_bf16_f32 v146, v28, v29
v_or3_b32 v30, v144, v145, v146
v_mfma_f32_16x16x32_bf16 a[16:19], v[160:163], v[128:131], a[16:19]
ds_read_b64_tr_b16 v[172:173], v6 offset:12416
ds_read_b64_tr_b16 v[174:175], v6 offset:18560
v_mfma_f32_16x16x32_bf16 a[56:59], v[160:163], v[132:135], a[56:59]
v_exp_f32_e64 v24, v24
v_mfma_f32_16x16x32_bf16 a[96:99], v[160:163], v[136:139], a[96:99]
v_fma_f32 v25, v103, s28, v16
v_fma_f32 v26, v104, s28, v17
v_mfma_f32_16x16x32_bf16 a[136:139], v[160:163], v[140:143], a[136:139]
s_waitcnt lgkmcnt(4)
v_exp_f32 v25, v25
v_mfma_f32_16x16x32_bf16 a[20:23], v[164:167], v[128:131], a[20:23]
ds_read_b64_tr_b16 v[160:161], v3 offset:12544
ds_read_b64_tr_b16 v[162:163], v3 offset:18688
v_mfma_f32_16x16x32_bf16 a[60:63], v[164:167], v[132:135], a[60:63]
buffer_load_dwordx4 v11, s[20:23], s38 offen offset:1024  lds
v_mfma_f32_16x16x32_bf16 a[100:103], v[164:167], v[136:139], a[100:103]
v_cvt_pk_bf16_f32 v147, v24, v25
v_fma_f32 v27, v105, s28, v17
v_mfma_f32_16x16x32_bf16 a[140:143], v[164:167], v[140:143], a[140:143]
s_waitcnt lgkmcnt(4)
v_mfma_f32_16x16x32_bf16 a[24:27], v[168:171], v[128:131], a[24:27]
ds_read_b64_tr_b16 v[164:165], v4 offset:12544
ds_read_b64_tr_b16 v[166:167], v4 offset:18688
v_mfma_f32_16x16x32_bf16 a[64:67], v[168:171], v[132:135], a[64:67]
v_exp_f32 v26, v26
v_mfma_f32_16x16x32_bf16 a[104:107], v[168:171], v[136:139], a[104:107]
v_exp_f32 v27, v27
v_mfma_f32_16x16x32_bf16 a[144:147], v[168:171], v[140:143], a[144:147]
s_waitcnt lgkmcnt(4)
v_cvt_pk_bf16_f32 v148, v26, v27
v_or3_b32 v30, v30, v147, v148
v_mfma_f32_16x16x32_bf16 a[28:31], v[172:175], v[128:131], a[28:31]
ds_read_b64_tr_b16 v[168:169], v5 offset:12544
ds_read_b64_tr_b16 v[170:171], v5 offset:18688
v_mfma_f32_16x16x32_bf16 a[68:71], v[172:175], v[132:135], a[68:71]
v_fma_f32 v28, v106, s28, v17
v_fma_f32 v29, v107, s28, v17
v_mfma_f32_16x16x32_bf16 a[108:111], v[172:175], v[136:139], a[108:111]
v_exp_f32_e64 v28, v28
v_mfma_f32_16x16x32_bf16 a[148:151], v[172:175], v[140:143], a[148:151]
s_waitcnt lgkmcnt(4)
v_exp_f32 v29, v29
v_mfma_f32_16x16x32_bf16 a[32:35], v[160:163], v[128:131], a[32:35]
ds_read_b64_tr_b16 v[172:173], v6 offset:12544
ds_read_b64_tr_b16 v[174:175], v6 offset:18688
v_mfma_f32_16x16x32_bf16 a[72:75], v[160:163], v[132:135], a[72:75]
buffer_load_dwordx4 v12, s[20:23], s38 offen offset:2048  lds
v_mfma_f32_16x16x32_bf16 a[112:115], v[160:163], v[136:139], a[112:115]
v_cvt_pk_bf16_f32 v149, v28, v29
v_mfma_f32_16x16x32_bf16 a[152:155], v[160:163], v[140:143], a[152:155]
s_waitcnt lgkmcnt(4)
v_fma_f32 v24, v108, s28, v17
v_fma_f32 v25, v109, s28, v17
v_mfma_f32_16x16x32_bf16 a[36:39], v[164:167], v[128:131], a[36:39]
ds_read_b128 v[160:163], v1 offset:24576
v_fma_f32 v26, v110, s28, v17
v_mfma_f32_16x16x32_bf16 a[76:79], v[164:167], v[132:135], a[76:79]
v_exp_f32 v24, v24
v_mfma_f32_16x16x32_bf16 a[116:119], v[164:167], v[136:139], a[116:119]
v_mfma_f32_16x16x32_bf16 a[156:159], v[164:167], v[140:143], a[156:159]
s_waitcnt lgkmcnt(3)
v_exp_f32 v25, v25
v_mfma_f32_16x16x32_bf16 v[32:35], v[168:171], v[128:131], v[32:35]
ds_read_b128 v[164:167], v1 offset:30720
v_cvt_pk_bf16_f32 v150, v24, v25
v_mfma_f32_16x16x32_bf16 v[40:43], v[168:171], v[132:135], v[40:43]
v_or3_b32 v30, v30, v149, v150
v_fma_f32 v27, v111, s28, v17
v_mfma_f32_16x16x32_bf16 v[48:51], v[168:171], v[136:139], v[48:51]
v_exp_f32_e64 v26, v26
v_mfma_f32_16x16x32_bf16 v[56:59], v[168:171], v[140:143], v[56:59]
s_waitcnt lgkmcnt(2)
v_exp_f32 v27, v27
v_mfma_f32_16x16x32_bf16 v[36:39], v[172:175], v[128:131], v[36:39]
s_mov_b32 s50, 12544
ds_read_b128 v[168:171], v2 offset:24576
v_cvt_pk_bf16_f32 v151, v26, v27
v_mfma_f32_16x16x32_bf16 v[44:47], v[172:175], v[132:135], v[44:47]
buffer_store_dwordx4 v[240:243], v14, s[24:27], s50 offen sc1 nt
v_mfma_f32_16x16x32_bf16 v[52:55], v[172:175], v[136:139], v[52:55]
v_fma_f32 v28, v112, s28, v18
v_fma_f32 v29, v113, s28, v18
v_mfma_f32_16x16x32_bf16 v[60:63], v[172:175], v[140:143], v[60:63]
s_waitcnt lgkmcnt(2)
v_mfma_f32_16x16x32_bf16 v[64:67], v[160:163], a[160:163], 0
ds_read_b128 v[172:175], v2 offset:30720
v_fma_f32 v24, v114, s28, v18
v_mfma_f32_16x16x32_bf16 v[72:75], v[160:163], a[184:187], 0
v_exp_f32 v28, v28
v_mfma_f32_16x16x32_bf16 v[80:83], v[160:163], a[208:211], 0
v_exp_f32 v29, v29
v_mfma_f32_16x16x32_bf16 v[88:91], v[160:163], a[232:235], 0
s_waitcnt lgkmcnt(2)
v_cvt_pk_bf16_f32 v152, v28, v29
v_or3_b32 v30, v30, v151, v152
v_mfma_f32_16x16x32_bf16 v[68:71], v[164:167], a[160:163], 0
ds_read_b128 v[160:163], v1 offset:24704
v_fma_f32 v25, v115, s28, v18
v_mfma_f32_16x16x32_bf16 v[76:79], v[164:167], a[184:187], 0
v_exp_f32 v24, v24
v_mfma_f32_16x16x32_bf16 v[84:87], v[164:167], a[208:211], 0
s_add_u32 m0, s36, 0
v_exp_f32 v25, v25
v_mfma_f32_16x16x32_bf16 v[92:95], v[164:167], a[232:235], 0
s_waitcnt lgkmcnt(2)
v_cvt_pk_bf16_f32 v153, v24, v25
v_fma_f32 v26, v116, s28, v18
v_mfma_f32_16x16x32_bf16 v[64:67], v[168:171], a[164:167], v[64:67]
s_mov_b32 s38, 184320
ds_read_b128 v[164:167], v1 offset:30848
v_mfma_f32_16x16x32_bf16 v[72:75], v[168:171], a[188:191], v[72:75]
buffer_load_dwordx4 v7, s[16:19], s38 offen  lds
v_mfma_f32_16x16x32_bf16 v[80:83], v[168:171], a[212:215], v[80:83]
v_exp_f32 v26, v26
v_mfma_f32_16x16x32_bf16 v[88:91], v[168:171], a[236:239], v[88:91]
s_waitcnt lgkmcnt(2)
v_fma_f32 v27, v117, s28, v18
v_fma_f32 v28, v118, s28, v18
v_mfma_f32_16x16x32_bf16 v[68:71], v[172:175], a[164:167], v[68:71]
ds_read_b128 v[168:171], v2 offset:24704
v_fma_f32 v29, v119, s28, v18
v_mfma_f32_16x16x32_bf16 v[76:79], v[172:175], a[188:191], v[76:79]
v_mfma_f32_16x16x32_bf16 v[84:87], v[172:175], a[212:215], v[84:87]
v_exp_f32 v27, v27
v_mfma_f32_16x16x32_bf16 v[92:95], v[172:175], a[236:239], v[92:95]
s_waitcnt lgkmcnt(2)
v_cvt_pk_bf16_f32 v154, v26, v27
v_or3_b32 v30, v30, v153, v154
v_mfma_f32_16x16x32_bf16 v[64:67], v[160:163], a[168:171], v[64:67]
ds_read_b128 v[172:175], v2 offset:30848
v_fma_f32 v24, v120, s28, v19
v_mfma_f32_16x16x32_bf16 v[72:75], v[160:163], a[192:195], v[72:75]
v_exp_f32_e64 v28, v28
v_mfma_f32_16x16x32_bf16 v[80:83], v[160:163], a[216:219], v[80:83]
v_exp_f32 v29, v29
v_mfma_f32_16x16x32_bf16 v[88:91], v[160:163], a[240:243], v[88:91]
s_waitcnt lgkmcnt(2)
v_cvt_pk_bf16_f32 v155, v28, v29
v_fma_f32 v25, v121, s28, v19
v_mfma_f32_16x16x32_bf16 v[68:71], v[164:167], a[168:171], v[68:71]
ds_read_b128 v[160:163], v1 offset:24832
v_fma_f32 v26, v122, s28, v19
v_mfma_f32_16x16x32_bf16 v[76:79], v[164:167], a[192:195], v[76:79]
buffer_load_dwordx4 v8, s[16:19], s38 offen offset:1024  lds
v_mfma_f32_16x16x32_bf16 v[84:87], v[164:167], a[216:219], v[84:87]
v_mfma_f32_16x16x32_bf16 v[92:95], v[164:167], a[240:243], v[92:95]
s_waitcnt lgkmcnt(2)
v_exp_f32 v24, v24
v_mfma_f32_16x16x32_bf16 v[64:67], v[168:171], a[172:175], v[64:67]
ds_read_b128 v[164:167], v1 offset:30976
v_fma_f32 v27, v123, s28, v19
v_mfma_f32_16x16x32_bf16 v[72:75], v[168:171], a[196:199], v[72:75]
v_exp_f32_e64 v25, v25
v_mfma_f32_16x16x32_bf16 v[80:83], v[168:171], a[220:223], v[80:83]
v_cvt_pk_bf16_f32 v156, v24, v25
v_or3_b32 v30, v30, v155, v156
v_mfma_f32_16x16x32_bf16 v[88:91], v[168:171], a[244:247], v[88:91]
s_waitcnt lgkmcnt(2)
v_exp_f32 v26, v26
v_mfma_f32_16x16x32_bf16 v[68:71], v[172:175], a[172:175], v[68:71]
ds_read_b128 v[168:171], v2 offset:24832
v_fma_f32 v28, v124, s28, v19
v_mfma_f32_16x16x32_bf16 v[76:79], v[172:175], a[196:199], v[76:79]
v_exp_f32_e64 v27, v27
v_mfma_f32_16x16x32_bf16 v[84:87], v[172:175], a[220:223], v[84:87]
v_cvt_pk_bf16_f32 v157, v26, v27
v_mfma_f32_16x16x32_bf16 v[92:95], v[172:175], a[244:247], v[92:95]
s_waitcnt lgkmcnt(2)
v_exp_f32 v28, v28
v_mfma_f32_16x16x32_bf16 v[64:67], v[160:163], a[176:179], v[64:67]
ds_read_b128 v[172:175], v2 offset:30976
v_fma_f32 v29, v125, s28, v19
v_mfma_f32_16x16x32_bf16 v[72:75], v[160:163], a[200:203], v[72:75]
buffer_load_dwordx4 v9, s[16:19], s38 offen offset:2048  lds
v_mfma_f32_16x16x32_bf16 v[80:83], v[160:163], a[224:227], v[80:83]
v_exp_f32 v29, v29
v_mfma_f32_16x16x32_bf16 v[88:91], v[160:163], a[248:251], v[88:91]
s_waitcnt lgkmcnt(2)
v_cvt_pk_bf16_f32 v158, v28, v29
v_mfma_f32_16x16x32_bf16 v[68:71], v[164:167], a[176:179], v[68:71]
ds_read_b64_tr_b16 v[160:161], v3 offset:36864
ds_read_b64_tr_b16 v[162:163], v3 offset:43008
v_mfma_f32_16x16x32_bf16 v[76:79], v[164:167], a[200:203], v[76:79]
v_or3_b32 v30, v30, v157, v158
v_fma_f32 v24, v126, s28, v19
v_mfma_f32_16x16x32_bf16 v[84:87], v[164:167], a[224:227], v[84:87]
v_exp_f32 v24, v24
v_mfma_f32_16x16x32_bf16 v[92:95], v[164:167], a[248:251], v[92:95]
s_waitcnt lgkmcnt(3)
v_fma_f32 v25, v127, s28, v19
v_mfma_f32_16x16x32_bf16 v[64:67], v[168:171], a[180:183], v[64:67]
ds_read_b64_tr_b16 v[164:165], v4 offset:36864
ds_read_b64_tr_b16 v[166:167], v4 offset:43008
v_mfma_f32_16x16x32_bf16 v[72:75], v[168:171], a[204:207], v[72:75]
s_mov_b32 s50, 15616
v_exp_f32_e64 v25, v25
v_mfma_f32_16x16x32_bf16 v[80:83], v[168:171], a[228:231], v[80:83]
L_pad5:
s_cbranch_execz L_warm_next
buffer_store_dwordx4 v[244:247], v14, s[24:27], s50 offen sc1 nt
v_mfma_f32_16x16x32_bf16 v[88:91], v[168:171], a[252:255], v[88:91]
s_waitcnt lgkmcnt(4)
v_cvt_pk_bf16_f32 v159, v24, v25
v_or_b32_e64 v30, v30, v159
v_mfma_f32_16x16x32_bf16 v[68:71], v[172:175], a[180:183], v[68:71]
ds_read_b64_tr_b16 v[168:169], v5 offset:36864
ds_read_b64_tr_b16 v[170:171], v5 offset:43008
v_mfma_f32_16x16x32_bf16 v[76:79], v[172:175], a[204:207], v[76:79]
v_and_b32_e64 v30, s29, v30
v_cmp_ne_u32 vcc, 0, v30
v_mfma_f32_16x16x32_bf16 v[84:87], v[172:175], a[228:231], v[84:87]
v_mfma_f32_16x16x32_bf16 v[92:95], v[172:175], a[252:255], v[92:95]
s_cbranch_vccnz L_tr9
L_bk9:
v_mfma_f32_16x16x32_bf16 v[20:23], v[180:183], v[144:147], v[20:23]
v_mfma_f32_16x16x32_bf16 v[176:179], v[180:183], v[148:151], v[176:179]
v_fma_f32 v24, v64, s28, v16
v_fma_f32 v25, v65, s28, v16
v_mfma_f32_16x16x32_bf16 v[184:187], v[180:183], v[152:155], v[184:187]
v_exp_f32_e64 v24, v24
v_mfma_f32_16x16x32_bf16 v[188:191], v[180:183], v[156:159], v[188:191]
s_waitcnt lgkmcnt(4)
v_exp_f32 v25, v25
v_mfma_f32_16x16x32_bf16 a[0:3], v[160:163], v[144:147], a[0:3]
ds_read_b64_tr_b16 v[172:173], v6 offset:36864
ds_read_b64_tr_b16 v[174:175], v6 offset:43008
v_mfma_f32_16x16x32_bf16 a[40:43], v[160:163], v[148:151], a[40:43]
v_cvt_pk_bf16_f32 v128, v24, v25
v_fma_f32 v26, v66, s28, v16
v_mfma_f32_16x16x32_bf16 a[80:83], v[160:163], v[152:155], a[80:83]
v_exp_f32 v26, v26
v_mfma_f32_16x16x32_bf16 a[120:123], v[160:163], v[156:159], a[120:123]
s_waitcnt lgkmcnt(4)
v_fma_f32 v27, v67, s28, v16
v_fma_f32 v28, v68, s28, v16
v_mfma_f32_16x16x32_bf16 a[4:7], v[164:167], v[144:147], a[4:7]
ds_read_b64_tr_b16 v[160:161], v3 offset:36992
ds_read_b64_tr_b16 v[162:163], v3 offset:43136
v_mfma_f32_16x16x32_bf16 a[44:47], v[164:167], v[148:151], a[44:47]
v_exp_f32_e64 v27, v27
v_mfma_f32_16x16x32_bf16 a[84:87], v[164:167], v[152:155], a[84:87]
v_cvt_pk_bf16_f32 v129, v26, v27
v_fma_f32 v29, v69, s28, v16
v_mfma_f32_16x16x32_bf16 a[124:127], v[164:167], v[156:159], a[124:127]
s_waitcnt lgkmcnt(4)
v_exp_f32 v28, v28
v_mfma_f32_16x16x32_bf16 a[8:11], v[168:171], v[144:147], a[8:11]
ds_read_b64_tr_b16 v[164:165], v4 offset:36992
ds_read_b64_tr_b16 v[166:167], v4 offset:43136
v_mfma_f32_16x16x32_bf16 a[48:51], v[168:171], v[148:151], a[48:51]
s_waitcnt vmcnt(29)
s_barrier
v_mfma_f32_16x16x32_bf16 a[88:91], v[168:171], v[152:155], a[88:91]
s_add_u32 m0, s36, 12288
v_mfma_f32_16x16x32_bf16 a[128:131], v[168:171], v[156:159], a[128:131]
s_waitcnt lgkmcnt(4)
v_exp_f32 v29, v29
v_mfma_f32_16x16x32_bf16 a[12:15], v[172:175], v[144:147], a[12:15]
s_mov_b32 s38, 172032
ds_read_b64_tr_b16 v[168:169], v5 offset:36992
ds_read_b64_tr_b16 v[170:171], v5 offset:43136
v_mfma_f32_16x16x32_bf16 a[52:55], v[172:175], v[148:151], a[52:55]
buffer_load_dwordx4 v10, s[20:23], s38 offen  lds
v_mfma_f32_16x16x32_bf16 a[92:95], v[172:175], v[152:155], a[92:95]
v_cvt_pk_bf16_f32 v130, v28, v29
v_or3_b32 v30, v128, v129, v130
v_mfma_f32_16x16x32_bf16 a[132:135], v[172:175], v[156:159], a[132:135]
s_waitcnt lgkmcnt(4)
v_fma_f32 v24, v70, s28, v16
v_fma_f32 v25, v71, s28, v16
v_mfma_f32_16x16x32_bf16 a[16:19], v[160:163], v[144:147], a[16:19]
ds_read_b64_tr_b16 v[172:173], v6 offset:36992
ds_read_b64_tr_b16 v[174:175], v6 offset:43136
v_mfma_f32_16x16x32_bf16 a[56:59], v[160:163], v[148:151], a[56:59]
v_exp_f32 v24, v24
v_mfma_f32_16x16x32_bf16 a[96:99], v[160:163], v[152:155], a[96:99]
v_exp_f32 v25, v25
v_mfma_f32_16x16x32_bf16 a[136:139], v[160:163], v[156:159], a[136:139]
s_waitcnt lgkmcnt(4)
v_cvt_pk_bf16_f32 v131, v24, v25
v_fma_f32 v26, v72, s28, v17
v_mfma_f32_16x16x32_bf16 a[20:23], v[164:167], v[144:147], a[20:23]
ds_read_b64_tr_b16 v[160:161], v3 offset:37120
ds_read_b64_tr_b16 v[162:163], v3 offset:43264
v_mfma_f32_16x16x32_bf16 a[60:63], v[164:167], v[148:151], a[60:63]
buffer_load_dwordx4 v11, s[20:23], s38 offen offset:1024  lds
v_mfma_f32_16x16x32_bf16 a[100:103], v[164:167], v[152:155], a[100:103]
v_exp_f32 v26, v26
v_mfma_f32_16x16x32_bf16 a[140:143], v[164:167], v[156:159], a[140:143]
s_waitcnt lgkmcnt(4)
v_fma_f32 v27, v73, s28, v17
v_fma_f32 v28, v74, s28, v17
v_mfma_f32_16x16x32_bf16 a[24:27], v[168:171], v[144:147], a[24:27]
ds_read_b64_tr_b16 v[164:165], v4 offset:37120
ds_read_b64_tr_b16 v[166:167], v4 offset:43264
v_mfma_f32_16x16x32_bf16 a[64:67], v[168:171], v[148:151], a[64:67]
v_exp_f32 v27, v27
v_mfma_f32_16x16x32_bf16 a[104:107], v[168:171], v[152:155], a[104:107]
v_cvt_pk_bf16_f32 v132, v26, v27
v_mfma_f32_16x16x32_bf16 a[144:147], v[168:171], v[156:159], a[144:147]
s_waitcnt lgkmcnt(4)
v_or3_b32 v30, v30, v131, v132
v_fma_f32 v29, v75, s28, v17
v_mfma_f32_16x16x32_bf16 a[28:31], v[172:175], v[144:147], a[28:31]
ds_read_b64_tr_b16 v[168:169], v5 offset:37120
ds_read_b64_tr_b16 v[170:171], v5 offset:43264
v_mfma_f32_16x16x32_bf16 a[68:71], v[172:175], v[148:151], a[68:71]
v_exp_f32_e64 v28, v28
v_mfma_f32_16x16x32_bf16 a[108:111], v[172:175], v[152:155], a[108:111]
v_exp_f32_e64 v29, v29
v_mfma_f32_16x16x32_bf16 a[148:151], v[172:175], v[156:159], a[148:151]
s_waitcnt lgkmcnt(4)
v_cvt_pk_bf16_f32 v133, v28, v29
v_fma_f32 v24, v76, s28, v17
v_mfma_f32_16x16x32_bf16 a[32:35], v[160:163], v[144:147], a[32:35]
s_sub_u32 s51, s34, s33
ds_read_b64_tr_b16 v[172:173], v6 offset:37120
ds_read_b64_tr_b16 v[174:175], v6 offset:43264
v_mfma_f32_16x16x32_bf16 a[72:75], v[160:163], v[148:151], a[72:75]
v_add_u32_e64 v1, s51, v1
v_add_u32 v2, s51, v2
v_mfma_f32_16x16x32_bf16 a[112:115], v[160:163], v[152:155], a[112:115]
buffer_load_dwordx4 v12, s[20:23], s38 offen offset:2048  lds
v_mfma_f32_16x16x32_bf16 a[152:155], v[160:163], v[156:159], a[152:155]
s_waitcnt lgkmcnt(4)
v_mfma_f32_16x16x32_bf16 a[36:39], v[164:167], v[144:147], a[36:39]
ds_read_b128 v[160:163], v1 offset:0
v_fma_f32 v25, v77, s28, v17
v_mfma_f32_16x16x32_bf16 a[76:79], v[164:167], v[148:151], a[76:79]
v_exp_f32_e64 v24, v24
v_mfma_f32_16x16x32_bf16 a[116:119], v[164:167], v[152:155], a[116:119]
v_exp_f32 v25, v25
v_mfma_f32_16x16x32_bf16 a[156:159], v[164:167], v[156:159], a[156:159]
s_waitcnt lgkmcnt(3)
v_cvt_pk_bf16_f32 v134, v24, v25
v_or3_b32 v30, v30, v133, v134
v_mfma_f32_16x16x32_bf16 v[32:35], v[168:171], v[144:147], v[32:35]
ds_read_b128 v[164:167], v1 offset:6144
v_fma_f32 v26, v78, s28, v17
v_mfma_f32_16x16x32_bf16 v[40:43], v[168:171], v[148:151], v[40:43]
v_exp_f32_e64 v26, v26
v_mfma_f32_16x16x32_bf16 v[48:51], v[168:171], v[152:155], v[48:51]
v_fma_f32 v27, v79, s28, v17
v_fma_f32 v28, v80, s28, v18
v_mfma_f32_16x16x32_bf16 v[56:59], v[168:171], v[156:159], v[56:59]
s_waitcnt lgkmcnt(2)
v_exp_f32 v27, v27
v_mfma_f32_16x16x32_bf16 v[36:39], v[172:175], v[144:147], v[36:39]
s_mov_b32 s50, 18688
ds_read_b128 v[168:171], v2 offset:0
v_cvt_pk_bf16_f32 v135, v26, v27
v_mfma_f32_16x16x32_bf16 v[44:47], v[172:175], v[148:151], v[44:47]
buffer_store_dwordx4 v[248:251], v14, s[24:27], s50 offen sc1 nt
v_mfma_f32_16x16x32_bf16 v[52:55], v[172:175], v[152:155], v[52:55]
v_exp_f32 v28, v28
v_mfma_f32_16x16x32_bf16 v[60:63], v[172:175], v[156:159], v[60:63]
s_waitcnt lgkmcnt(2)
v_fma_f32 v29, v81, s28, v18
v_mfma_f32_16x16x32_bf16 v[96:99], v[160:163], a[160:163], 0
ds_read_b128 v[172:175], v2 offset:6144
v_fma_f32 v24, v82, s28, v18
v_mfma_f32_16x16x32_bf16 v[104:107], v[160:163], a[184:187], 0
v_exp_f32_e64 v29, v29
v_mfma_f32_16x16x32_bf16 v[112:115], v[160:163], a[208:211], 0
v_cvt_pk_bf16_f32 v136, v28, v29
v_or3_b32 v30, v30, v135, v136
v_mfma_f32_16x16x32_bf16 v[120:123], v[160:163], a[232:235], 0
s_waitcnt lgkmcnt(2)
v_exp_f32 v24, v24
v_mfma_f32_16x16x32_bf16 v[100:103], v[164:167], a[160:163], 0
ds_read_b128 v[160:163], v1 offset:128
v_fma_f32 v25, v83, s28, v18
v_mfma_f32_16x16x32_bf16 v[108:111], v[164:167], a[184:187], 0
v_mfma_f32_16x16x32_bf16 v[116:119], v[164:167], a[208:211], 0
s_add_u32 m0, s36, 24576
v_exp_f32 v25, v25
v_mfma_f32_16x16x32_bf16 v[124:127], v[164:167], a[232:235], 0
s_waitcnt lgkmcnt(2)
v_cvt_pk_bf16_f32 v137, v24, v25
v_fma_f32 v26, v84, s28, v18
v_mfma_f32_16x16x32_bf16 v[96:99], v[168:171], a[164:167], v[96:99]
s_mov_b32 s38, 184320
ds_read_b128 v[164:167], v1 offset:6272
v_fma_f32 v27, v85, s28, v18
v_mfma_f32_16x16x32_bf16 v[104:107], v[168:171], a[188:191], v[104:107]
buffer_load_dwordx4 v10, s[20:23], s38 offen  lds
v_mfma_f32_16x16x32_bf16 v[112:115], v[168:171], a[212:215], v[112:115]
v_exp_f32_e64 v26, v26
v_mfma_f32_16x16x32_bf16 v[120:123], v[168:171], a[236:239], v[120:123]
s_waitcnt lgkmcnt(2)
v_exp_f32 v27, v27
v_mfma_f32_16x16x32_bf16 v[100:103], v[172:175], a[164:167], v[100:103]
ds_read_b128 v[168:171], v2 offset:128
v_cvt_pk_bf16_f32 v138, v26, v27
v_mfma_f32_16x16x32_bf16 v[108:111], v[172:175], a[188:191], v[108:111]
v_or3_b32 v30, v30, v137, v138
v_fma_f32 v28, v86, s28, v18
v_mfma_f32_16x16x32_bf16 v[116:119], v[172:175], a[212:215], v[116:119]
v_exp_f32 v28, v28
v_mfma_f32_16x16x32_bf16 v[124:127], v[172:175], a[236:239], v[124:127]
s_waitcnt lgkmcnt(2)
v_fma_f32 v29, v87, s28, v18
v_fma_f32 v24, v88, s28, v19
v_mfma_f32_16x16x32_bf16 v[96:99], v[160:163], a[168:171], v[96:99]
ds_read_b128 v[172:175], v2 offset:6272
v_fma_f32 v25, v89, s28, v19
v_mfma_f32_16x16x32_bf16 v[104:107], v[160:163], a[192:195], v[104:107]
v_mfma_f32_16x16x32_bf16 v[112:115], v[160:163], a[216:219], v[112:115]
v_exp_f32 v29, v29
v_mfma_f32_16x16x32_bf16 v[120:123], v[160:163], a[240:243], v[120:123]
s_waitcnt lgkmcnt(2)
v_cvt_pk_bf16_f32 v139, v28, v29
v_fma_f32 v26, v90, s28, v19
v_mfma_f32_16x16x32_bf16 v[100:103], v[164:167], a[168:171], v[100:103]
ds_read_b128 v[160:163], v1 offset:256
v_fma_f32 v27, v91, s28, v19
v_mfma_f32_16x16x32_bf16 v[108:111], v[164:167], a[192:195], v[108:111]
buffer_load_dwordx4 v11, s[20:23], s38 offen offset:1024  lds
v_mfma_f32_16x16x32_bf16 v[116:119], v[164:167], a[216:219], v[116:119]
v_exp_f32_e64 v24, v24
v_mfma_f32_16x16x32_bf16 v[124:127], v[164:167], a[240:243], v[124:127]
s_waitcnt lgkmcnt(2)
v_exp_f32 v25, v25
v_mfma_f32_16x16x32_bf16 v[96:99], v[168:171], a[172:175], v[96:99]
ds_read_b128 v[164:167], v1 offset:6400
v_cvt_pk_bf16_f32 v140, v24, v25
v_mfma_f32_16x16x32_bf16 v[104:107], v[168:171], a[196:199], v[104:107]
v_or3_b32 v30, v30, v139, v140
v_fma_f32 v28, v92, s28, v19
v_mfma_f32_16x16x32_bf16 v[112:115], v[168:171], a[220:223], v[112:115]
v_exp_f32_e64 v26, v26
v_mfma_f32_16x16x32_bf16 v[120:123], v[168:171], a[244:247], v[120:123]
s_waitcnt lgkmcnt(2)
v_exp_f32 v27, v27
v_mfma_f32_16x16x32_bf16 v[100:103], v[172:175], a[172:175], v[100:103]
s_sub_u32 s51, s34, s33
ds_read_b128 v[168:171], v2 offset:256
v_add_u32 v3, s51, v3
v_mfma_f32_16x16x32_bf16 v[108:111], v[172:175], a[196:199], v[108:111]
v_add_u32 v4, s51, v4
v_add_u32 v5, s51, v5
v_mfma_f32_16x16x32_bf16 v[116:119], v[172:175], a[220:223], v[116:119]
v_add_u32 v6, s51, v6
v_cvt_pk_bf16_f32 v141, v26, v27
v_mfma_f32_16x16x32_bf16 v[124:127], v[172:175], a[244:247], v[124:127]
s_waitcnt lgkmcnt(2)
v_mfma_f32_16x16x32_bf16 v[96:99], v[160:163], a[176:179], v[96:99]
ds_read_b128 v[172:175], v2 offset:6400
v_fma_f32 v29, v93, s28, v19
v_mfma_f32_16x16x32_bf16 v[104:107], v[160:163], a[200:203], v[104:107]
buffer_load_dwordx4 v12, s[20:23], s38 offen offset:2048  lds
v_mfma_f32_16x16x32_bf16 v[112:115], v[160:163], a[224:227], v[112:115]
v_exp_f32_e64 v28, v28
v_mfma_f32_16x16x32_bf16 v[120:123], v[160:163], a[248:251], v[120:123]
s_waitcnt lgkmcnt(2)
v_exp_f32 v29, v29
v_mfma_f32_16x16x32_bf16 v[100:103], v[164:167], a[176:179], v[100:103]
ds_read_b64_tr_b16 v[160:161], v3 offset:12288
ds_read_b64_tr_b16 v[162:163], v3 offset:18432
v_mfma_f32_16x16x32_bf16 v[108:111], v[164:167], a[200:203], v[108:111]
v_cvt_pk_bf16_f32 v142, v28, v29
v_or3_b32 v30, v30, v141, v142
v_mfma_f32_16x16x32_bf16 v[116:119], v[164:167], a[224:227], v[116:119]
v_fma_f32 v24, v94, s28, v19
v_fma_f32 v25, v95, s28, v19
v_mfma_f32_16x16x32_bf16 v[124:127], v[164:167], a[248:251], v[124:127]
s_waitcnt lgkmcnt(3)
v_exp_f32 v24, v24
v_mfma_f32_16x16x32_bf16 v[96:99], v[168:171], a[180:183], v[96:99]
ds_read_b64_tr_b16 v[164:165], v4 offset:12288
ds_read_b64_tr_b16 v[166:167], v4 offset:18432
v_mfma_f32_16x16x32_bf16 v[104:107], v[168:171], a[204:207], v[104:107]
s_mov_b32 s50, 21760
v_exp_f32_e64 v25, v25
v_mfma_f32_16x16x32_bf16 v[112:115], v[168:171], a[228:231], v[112:115]
buffer_store_dwordx4 v[252:255], v14, s[24:27], s50 offen sc1 nt
v_mfma_f32_16x16x32_bf16 v[120:123], v[168:171], a[252:255], v[120:123]
s_waitcnt lgkmcnt(4)
v_cvt_pk_bf16_f32 v143, v24, v25
v_or_b32 v30, v30, v143
v_mfma_f32_16x16x32_bf16 v[100:103], v[172:175], a[180:183], v[100:103]
ds_read_b64_tr_b16 v[168:169], v5 offset:12288
ds_read_b64_tr_b16 v[170:171], v5 offset:18432
v_mfma_f32_16x16x32_bf16 v[108:111], v[172:175], a[204:207], v[108:111]
v_and_b32_e64 v30, s29, v30
v_cmp_ne_u32 vcc, 0, v30
v_mfma_f32_16x16x32_bf16 v[116:119], v[172:175], a[228:231], v[116:119]
v_mfma_f32_16x16x32_bf16 v[124:127], v[172:175], a[252:255], v[124:127]
s_cbranch_vccnz L_tr10
L_bk10:
v_mfma_f32_16x16x32_bf16 v[20:23], v[180:183], v[128:131], v[20:23]
v_mfma_f32_16x16x32_bf16 v[176:179], v[180:183], v[132:135], v[176:179]
v_fma_f32 v24, v96, s28, v16
v_fma_f32 v25, v97, s28, v16
v_mfma_f32_16x16x32_bf16 v[184:187], v[180:183], v[136:139], v[184:187]
v_exp_f32_e64 v24, v24
v_mfma_f32_16x16x32_bf16 v[188:191], v[180:183], v[140:143], v[188:191]
s_waitcnt lgkmcnt(4)
v_exp_f32 v25, v25
v_mfma_f32_16x16x32_bf16 a[0:3], v[160:163], v[128:131], a[0:3]
ds_read_b64_tr_b16 v[172:173], v6 offset:12288
ds_read_b64_tr_b16 v[174:175], v6 offset:18432
v_mfma_f32_16x16x32_bf16 a[40:43], v[160:163], v[132:135], a[40:43]
v_cvt_pk_bf16_f32 v144, v24, v25
v_fma_f32 v26, v98, s28, v16
v_mfma_f32_16x16x32_bf16 a[80:83], v[160:163], v[136:139], a[80:83]
v_exp_f32 v26, v26
v_mfma_f32_16x16x32_bf16 a[120:123], v[160:163], v[140:143], a[120:123]
s_waitcnt lgkmcnt(4)
v_fma_f32 v27, v99, s28, v16
v_fma_f32 v28, v100, s28, v16
v_mfma_f32_16x16x32_bf16 a[4:7], v[164:167], v[128:131], a[4:7]
ds_read_b64_tr_b16 v[160:161], v3 offset:12416
ds_read_b64_tr_b16 v[162:163], v3 offset:18560
v_mfma_f32_16x16x32_bf16 a[44:47], v[164:167], v[132:135], a[44:47]
v_mfma_f32_16x16x32_bf16 a[84:87], v[164:167], v[136:139], a[84:87]
v_exp_f32 v27, v27
v_mfma_f32_16x16x32_bf16 a[124:127], v[164:167], v[140:143], a[124:127]
s_waitcnt lgkmcnt(4)
v_cvt_pk_bf16_f32 v145, v26, v27
v_fma_f32 v29, v101, s28, v16
v_mfma_f32_16x16x32_bf16 a[8:11], v[168:171], v[128:131], a[8:11]
ds_read_b64_tr_b16 v[164:165], v4 offset:12416
ds_read_b64_tr_b16 v[166:167], v4 offset:18560
v_mfma_f32_16x16x32_bf16 a[48:51], v[168:171], v[132:135], a[48:51]
s_waitcnt vmcnt(29)
s_barrier
v_mfma_f32_16x16x32_bf16 a[88:91], v[168:171], v[136:139], a[88:91]
s_add_u32 m0, s36, 36864
v_exp_f32_e64 v28, v28
v_mfma_f32_16x16x32_bf16 a[128:131], v[168:171], v[140:143], a[128:131]
s_waitcnt lgkmcnt(4)
v_exp_f32 v29, v29
v_mfma_f32_16x16x32_bf16 a[12:15], v[172:175], v[128:131], a[12:15]
s_mov_b32 s38, 0
ds_read_b64_tr_b16 v[168:169], v5 offset:12416
ds_read_b64_tr_b16 v[170:171], v5 offset:18560
v_mfma_f32_16x16x32_bf16 a[52:55], v[172:175], v[132:135], a[52:55]
buffer_load_dwordx4 v7, s[12:15], s38 offen sc1 nt lds
v_mfma_f32_16x16x32_bf16 a[92:95], v[172:175], v[136:139], a[92:95]
v_cvt_pk_bf16_f32 v146, v28, v29
v_or3_b32 v30, v144, v145, v146
v_mfma_f32_16x16x32_bf16 a[132:135], v[172:175], v[140:143], a[132:135]
s_waitcnt lgkmcnt(4)
v_fma_f32 v24, v102, s28, v16
v_fma_f32 v25, v103, s28, v16
v_mfma_f32_16x16x32_bf16 a[16:19], v[160:163], v[128:131], a[16:19]
ds_read_b64_tr_b16 v[172:173], v6 offset:12416
ds_read_b64_tr_b16 v[174:175], v6 offset:18560
v_mfma_f32_16x16x32_bf16 a[56:59], v[160:163], v[132:135], a[56:59]
v_mfma_f32_16x16x32_bf16 a[96:99], v[160:163], v[136:139], a[96:99]
v_exp_f32_e64 v24, v24
v_mfma_f32_16x16x32_bf16 a[136:139], v[160:163], v[140:143], a[136:139]
s_waitcnt lgkmcnt(4)
v_exp_f32 v25, v25
v_mfma_f32_16x16x32_bf16 a[20:23], v[164:167], v[128:131], a[20:23]
ds_read_b64_tr_b16 v[160:161], v3 offset:12544
ds_read_b64_tr_b16 v[162:163], v3 offset:18688
v_mfma_f32_16x16x32_bf16 a[60:63], v[164:167], v[132:135], a[60:63]
v_cvt_pk_bf16_f32 v147, v24, v25
v_fma_f32 v26, v104, s28, v17
v_mfma_f32_16x16x32_bf16 a[100:103], v[164:167], v[136:139], a[100:103]
v_exp_f32 v26, v26
v_mfma_f32_16x16x32_bf16 a[140:143], v[164:167], v[140:143], a[140:143]
s_waitcnt lgkmcnt(4)
v_fma_f32 v27, v105, s28, v17
v_fma_f32 v28, v106, s28, v17
v_mfma_f32_16x16x32_bf16 a[24:27], v[168:171], v[128:131], a[24:27]
ds_read_b64_tr_b16 v[164:165], v4 offset:12544
ds_read_b64_tr_b16 v[166:167], v4 offset:18688
v_mfma_f32_16x16x32_bf16 a[64:67], v[168:171], v[132:135], a[64:67]
buffer_load_dwordx4 v8, s[12:15], s38 offen offset:1024 sc1 nt lds
v_mfma_f32_16x16x32_bf16 a[104:107], v[168:171], v[136:139], a[104:107]
v_mfma_f32_16x16x32_bf16 a[144:147], v[168:171], v[140:143], a[144:147]
s_waitcnt lgkmcnt(4)
v_exp_f32 v27, v27
v_mfma_f32_16x16x32_bf16 a[28:31], v[172:175], v[128:131], a[28:31]
ds_read_b64_tr_b16 v[168:169], v5 offset:12544
ds_read_b64_tr_b16 v[170:171], v5 offset:18688
v_mfma_f32_16x16x32_bf16 a[68:71], v[172:175], v[132:135], a[68:71]
v_cvt_pk_bf16_f32 v148, v26, v27
v_or3_b32 v30, v30, v147, v148
v_mfma_f32_16x16x32_bf16 a[108:111], v[172:175], v[136:139], a[108:111]
v_exp_f32 v28, v28
v_mfma_f32_16x16x32_bf16 a[148:151], v[172:175], v[140:143], a[148:151]
s_waitcnt lgkmcnt(4)
v_fma_f32 v29, v107, s28, v17
v_fma_f32 v24, v108, s28, v17
v_mfma_f32_16x16x32_bf16 a[32:35], v[160:163], v[128:131], a[32:35]
ds_read_b64_tr_b16 v[172:173], v6 offset:12544
ds_read_b64_tr_b16 v[174:175], v6 offset:18688
v_mfma_f32_16x16x32_bf16 a[72:75], v[160:163], v[132:135], a[72:75]
v_exp_f32_e64 v29, v29
v_mfma_f32_16x16x32_bf16 a[112:115], v[160:163], v[136:139], a[112:115]
v_cvt_pk_bf16_f32 v149, v28, v29
v_fma_f32 v25, v109, s28, v17
v_mfma_f32_16x16x32_bf16 a[152:155], v[160:163], v[140:143], a[152:155]
s_waitcnt lgkmcnt(4)
v_mfma_f32_16x16x32_bf16 a[36:39], v[164:167], v[128:131], a[36:39]
ds_read_b128 v[160:163], v1 offset:24576
v_fma_f32 v26, v110, s28, v17
v_mfma_f32_16x16x32_bf16 a[76:79], v[164:167], v[132:135], a[76:79]
v_exp_f32 v24, v24
v_mfma_f32_16x16x32_bf16 a[116:119], v[164:167], v[136:139], a[116:119]
v_exp_f32 v25, v25
v_mfma_f32_16x16x32_bf16 a[156:159], v[164:167], v[140:143], a[156:159]
s_waitcnt lgkmcnt(3)
v_cvt_pk_bf16_f32 v150, v24, v25
v_or3_b32 v30, v30, v149, v150
v_mfma_f32_16x16x32_bf16 v[32:35], v[168:171], v[128:131], v[32:35]
ds_read_b128 v[164:167], v1 offset:30720
v_fma_f32 v27, v111, s28, v17
v_mfma_f32_16x16x32_bf16 v[40:43], v[168:171], v[132:135], v[40:43]
buffer_load_dwordx4 v9, s[12:15], s38 offen offset:2048 sc1 nt lds
v_mfma_f32_16x16x32_bf16 v[48:51], v[168:171], v[136:139], v[48:51]
v_exp_f32 v26, v26
v_mfma_f32_16x16x32_bf16 v[56:59], v[168:171], v[140:143], v[56:59]
s_waitcnt lgkmcnt(2)
v_mfma_f32_16x16x32_bf16 v[36:39], v[172:175], v[128:131], v[36:39]
ds_read_b128 v[168:171], v2 offset:24576
v_fma_f32 v28, v112, s28, v18
v_mfma_f32_16x16x32_bf16 v[44:47], v[172:175], v[132:135], v[44:47]
v_exp_f32_e64 v27, v27
v_mfma_f32_16x16x32_bf16 v[52:55], v[172:175], v[136:139], v[52:55]
v_cvt_pk_bf16_f32 v151, v26, v27
v_fma_f32 v29, v113, s28, v18
v_mfma_f32_16x16x32_bf16 v[60:63], v[172:175], v[140:143], v[60:63]
s_waitcnt lgkmcnt(2)
v_exp_f32 v28, v28
v_mfma_f32_16x16x32_bf16 v[64:67], v[160:163], a[160:163], 0
ds_read_b128 v[172:175], v2 offset:30720
v_fma_f32 v24, v114, s28, v18
v_mfma_f32_16x16x32_bf16 v[72:75], v[160:163], a[184:187], 0
v_exp_f32_e64 v29, v29
v_mfma_f32_16x16x32_bf16 v[80:83], v[160:163], a[208:211], 0
v_cvt_pk_bf16_f32 v152, v28, v29
v_or3_b32 v30, v30, v151, v152
v_mfma_f32_16x16x32_bf16 v[88:91], v[160:163], a[232:235], 0
s_waitcnt lgkmcnt(2)
v_mfma_f32_16x16x32_bf16 v[68:71], v[164:167], a[160:163], 0
ds_read_b128 v[160:163], v1 offset:24704
v_fma_f32 v25, v115, s28, v18
v_mfma_f32_16x16x32_bf16 v[76:79], v[164:167], a[184:187], 0
s_add_u32 s16, s6, s43
s_addc_u32 s17, s7, 0
s_mov_b32 s18, s45
v_mfma_f32_16x16x32_bf16 v[84:87], v[164:167], a[208:211], 0
s_add_u32 m0, s37, 0
v_exp_f32 v24, v24
v_mfma_f32_16x16x32_bf16 v[92:95], v[164:167], a[232:235], 0
s_waitcnt lgkmcnt(2)
v_exp_f32 v25, v25
v_mfma_f32_16x16x32_bf16 v[64:67], v[168:171], a[164:167], v[64:67]
s_mov_b32 s38, 12288
ds_read_b128 v[164:167], v1 offset:30848
v_cvt_pk_bf16_f32 v153, v24, v25
v_mfma_f32_16x16x32_bf16 v[72:75], v[168:171], a[188:191], v[72:75]
buffer_load_dwordx4 v7, s[12:15], s38 offen sc1 nt lds
v_mfma_f32_16x16x32_bf16 v[80:83], v[168:171], a[212:215], v[80:83]
v_fma_f32 v26, v116, s28, v18
v_fma_f32 v27, v117, s28, v18
v_mfma_f32_16x16x32_bf16 v[88:91], v[168:171], a[236:239], v[88:91]
s_waitcnt lgkmcnt(2)
v_exp_f32 v26, v26
v_mfma_f32_16x16x32_bf16 v[68:71], v[172:175], a[164:167], v[68:71]
ds_read_b128 v[168:171], v2 offset:24704
v_fma_f32 v28, v118, s28, v18
v_mfma_f32_16x16x32_bf16 v[76:79], v[172:175], a[188:191], v[76:79]
v_mfma_f32_16x16x32_bf16 v[84:87], v[172:175], a[212:215], v[84:87]
v_exp_f32 v27, v27
v_mfma_f32_16x16x32_bf16 v[92:95], v[172:175], a[236:239], v[92:95]
s_waitcnt lgkmcnt(2)
v_cvt_pk_bf16_f32 v154, v26, v27
v_or3_b32 v30, v30, v153, v154
v_mfma_f32_16x16x32_bf16 v[64:67], v[160:163], a[168:171], v[64:67]
ds_read_b128 v[172:175], v2 offset:30848
v_fma_f32 v29, v119, s28, v18
v_mfma_f32_16x16x32_bf16 v[72:75], v[160:163], a[192:195], v[72:75]
v_exp_f32_e64 v28, v28
v_mfma_f32_16x16x32_bf16 v[80:83], v[160:163], a[216:219], v[80:83]
v_exp_f32 v29, v29
v_mfma_f32_16x16x32_bf16 v[88:91], v[160:163], a[240:243], v[88:91]
s_waitcnt lgkmcnt(2)
v_cvt_pk_bf16_f32 v155, v28, v29
v_fma_f32 v24, v120, s28, v19
v_mfma_f32_16x16x32_bf16 v[68:71], v[164:167], a[168:171], v[68:71]
ds_read_b128 v[160:163], v1 offset:24832
v_mfma_f32_16x16x32_bf16 v[76:79], v[164:167], a[192:195], v[76:79]
v_exp_f32_e64 v24, v24
v_mfma_f32_16x16x32_bf16 v[84:87], v[164:167], a[216:219], v[84:87]
v_fma_f32 v25, v121, s28, v19
v_fma_f32 v26, v122, s28, v19
v_mfma_f32_16x16x32_bf16 v[92:95], v[164:167], a[240:243], v[92:95]
s_waitcnt lgkmcnt(2)
v_exp_f32 v25, v25
v_mfma_f32_16x16x32_bf16 v[64:67], v[168:171], a[172:175], v[64:67]
ds_read_b128 v[164:167], v1 offset:30976
v_mfma_f32_16x16x32_bf16 v[72:75], v[168:171], a[196:199], v[72:75]
buffer_load_dwordx4 v8, s[12:15], s38 offen offset:1024 sc1 nt lds
v_mfma_f32_16x16x32_bf16 v[80:83], v[168:171], a[220:223], v[80:83]
v_cvt_pk_bf16_f32 v156, v24, v25
v_or3_b32 v30, v30, v155, v156
v_mfma_f32_16x16x32_bf16 v[88:91], v[168:171], a[244:247], v[88:91]
s_waitcnt lgkmcnt(2)
v_exp_f32 v26, v26
v_mfma_f32_16x16x32_bf16 v[68:71], v[172:175], a[172:175], v[68:71]
ds_read_b128 v[168:171], v2 offset:24832
v_fma_f32 v27, v123, s28, v19
v_mfma_f32_16x16x32_bf16 v[76:79], v[172:175], a[196:199], v[76:79]
v_mfma_f32_16x16x32_bf16 v[84:87], v[172:175], a[220:223], v[84:87]
v_exp_f32 v27, v27
v_mfma_f32_16x16x32_bf16 v[92:95], v[172:175], a[244:247], v[92:95]
s_waitcnt lgkmcnt(2)
v_cvt_pk_bf16_f32 v157, v26, v27
v_fma_f32 v28, v124, s28, v19
v_mfma_f32_16x16x32_bf16 v[64:67], v[160:163], a[176:179], v[64:67]
ds_read_b128 v[172:175], v2 offset:30976
v_fma_f32 v29, v125, s28, v19
v_mfma_f32_16x16x32_bf16 v[72:75], v[160:163], a[200:203], v[72:75]
v_exp_f32_e64 v28, v28
v_mfma_f32_16x16x32_bf16 v[80:83], v[160:163], a[224:227], v[80:83]
v_exp_f32 v29, v29
v_mfma_f32_16x16x32_bf16 v[88:91], v[160:163], a[248:251], v[88:91]
s_waitcnt lgkmcnt(2)
v_cvt_pk_bf16_f32 v158, v28, v29
v_or3_b32 v30, v30, v157, v158
v_mfma_f32_16x16x32_bf16 v[68:71], v[164:167], a[176:179], v[68:71]
ds_read_b64_tr_b16 v[160:161], v3 offset:36864
ds_read_b64_tr_b16 v[162:163], v3 offset:43008
v_mfma_f32_16x16x32_bf16 v[76:79], v[164:167], a[200:203], v[76:79]
v_fma_f32 v24, v126, s28, v19
v_mfma_f32_16x16x32_bf16 v[84:87], v[164:167], a[224:227], v[84:87]
buffer_load_dwordx4 v9, s[12:15], s38 offen offset:2048 sc1 nt lds
v_mfma_f32_16x16x32_bf16 v[92:95], v[164:167], a[248:251], v[92:95]
s_waitcnt lgkmcnt(3)
v_exp_f32 v24, v24
v_mfma_f32_16x16x32_bf16 v[64:67], v[168:171], a[180:183], v[64:67]
ds_read_b64_tr_b16 v[164:165], v4 offset:36864
ds_read_b64_tr_b16 v[166:167], v4 offset:43008
v_mfma_f32_16x16x32_bf16 v[72:75], v[168:171], a[204:207], v[72:75]
v_fma_f32 v25, v127, s28, v19
v_mfma_f32_16x16x32_bf16 v[80:83], v[168:171], a[228:231], v[80:83]
v_exp_f32_e64 v25, v25
v_mfma_f32_16x16x32_bf16 v[88:91], v[168:171], a[252:255], v[88:91]
s_waitcnt lgkmcnt(4)
v_cvt_pk_bf16_f32 v159, v24, v25
v_or_b32 v30, v30, v159
v_mfma_f32_16x16x32_bf16 v[68:71], v[172:175], a[180:183], v[68:71]
ds_read_b64_tr_b16 v[168:169], v5 offset:36864
ds_read_b64_tr_b16 v[170:171], v5 offset:43008
v_mfma_f32_16x16x32_bf16 v[76:79], v[172:175], a[204:207], v[76:79]
v_and_b32_e64 v30, s29, v30
v_cmp_ne_u32 vcc, 0, v30
v_mfma_f32_16x16x32_bf16 v[84:87], v[172:175], a[228:231], v[84:87]
v_mfma_f32_16x16x32_bf16 v[92:95], v[172:175], a[252:255], v[92:95]
s_cbranch_vccnz L_tr11
L_bk11:
v_mfma_f32_16x16x32_bf16 v[20:23], v[180:183], v[144:147], v[20:23]
v_mfma_f32_16x16x32_bf16 v[176:179], v[180:183], v[148:151], v[176:179]
v_fma_f32 v24, v64, s28, v16
v_fma_f32 v25, v65, s28, v16
v_mfma_f32_16x16x32_bf16 v[184:187], v[180:183], v[152:155], v[184:187]
v_exp_f32_e64 v24, v24
v_mfma_f32_16x16x32_bf16 v[188:191], v[180:183], v[156:159], v[188:191]
s_waitcnt lgkmcnt(4)
v_exp_f32 v25, v25
v_mfma_f32_16x16x32_bf16 a[0:3], v[160:163], v[144:147], a[0:3]
ds_read_b64_tr_b16 v[172:173], v6 offset:36864
ds_read_b64_tr_b16 v[174:175], v6 offset:43008
v_mfma_f32_16x16x32_bf16 a[40:43], v[160:163], v[148:151], a[40:43]
L_pad6:
s_cbranch_execz L_warm_next
v_cvt_pk_bf16_f32 v128, v24, v25
v_fma_f32 v26, v66, s28, v16
v_mfma_f32_16x16x32_bf16 a[80:83], v[160:163], v[152:155], a[80:83]
v_exp_f32_e64 v26, v26
v_mfma_f32_16x16x32_bf16 a[120:123], v[160:163], v[156:159], a[120:123]
s_waitcnt lgkmcnt(4)
v_fma_f32 v27, v67, s28, v16
v_fma_f32 v28, v68, s28, v16
v_mfma_f32_16x16x32_bf16 a[4:7], v[164:167], v[144:147], a[4:7]
ds_read_b64_tr_b16 v[160:161], v3 offset:36992
ds_read_b64_tr_b16 v[162:163], v3 offset:43136
v_mfma_f32_16x16x32_bf16 a[44:47], v[164:167], v[148:151], a[44:47]
v_exp_f32 v27, v27
v_mfma_f32_16x16x32_bf16 a[84:87], v[164:167], v[152:155], a[84:87]
v_cvt_pk_bf16_f32 v129, v26, v27
v_fma_f32 v29, v69, s28, v16
v_mfma_f32_16x16x32_bf16 a[124:127], v[164:167], v[156:159], a[124:127]
s_waitcnt lgkmcnt(4)
v_mfma_f32_16x16x32_bf16 a[8:11], v[168:171], v[144:147], a[8:11]
ds_read_b64_tr_b16 v[164:165], v4 offset:36992
ds_read_b64_tr_b16 v[166:167], v4 offset:43136
v_mfma_f32_16x16x32_bf16 a[48:51], v[168:171], v[148:151], a[48:51]
s_waitcnt vmcnt(27)
s_barrier
v_mfma_f32_16x16x32_bf16 a[88:91], v[168:171], v[152:155], a[88:91]
s_add_u32 m0, s37, 12288
v_exp_f32_e64 v28, v28
v_mfma_f32_16x16x32_bf16 a[128:131], v[168:171], v[156:159], a[128:131]
s_waitcnt lgkmcnt(4)
v_exp_f32 v29, v29
v_mfma_f32_16x16x32_bf16 a[12:15], v[172:175], v[144:147], a[12:15]
s_mov_b32 s38, 24576
ds_read_b64_tr_b16 v[168:169], v5 offset:36992
ds_read_b64_tr_b16 v[170:171], v5 offset:43136
v_mfma_f32_16x16x32_bf16 a[52:55], v[172:175], v[148:151], a[52:55]
buffer_load_dwordx4 v7, s[12:15], s38 offen sc1 nt lds
v_mfma_f32_16x16x32_bf16 a[92:95], v[172:175], v[152:155], a[92:95]
v_cvt_pk_bf16_f32 v130, v28, v29
v_or3_b32 v30, v128, v129, v130
v_mfma_f32_16x16x32_bf16 a[132:135], v[172:175], v[156:159], a[132:135]
s_waitcnt lgkmcnt(4)
v_fma_f32 v24, v70, s28, v16
v_fma_f32 v25, v71, s28, v16
v_mfma_f32_16x16x32_bf16 a[16:19], v[160:163], v[144:147], a[16:19]
ds_read_b64_tr_b16 v[172:173], v6 offset:36992
ds_read_b64_tr_b16 v[174:175], v6 offset:43136
v_mfma_f32_16x16x32_bf16 a[56:59], v[160:163], v[148:151], a[56:59]
v_exp_f32 v24, v24
v_mfma_f32_16x16x32_bf16 a[96:99], v[160:163], v[152:155], a[96:99]
v_exp_f32 v25, v25
v_mfma_f32_16x16x32_bf16 a[136:139], v[160:163], v[156:159], a[136:139]
s_waitcnt lgkmcnt(4)
v_cvt_pk_bf16_f32 v131, v24, v25
v_fma_f32 v26, v72, s28, v17
v_mfma_f32_16x16x32_bf16 a[20:23], v[164:167], v[144:147], a[20:23]
ds_read_b64_tr_b16 v[160:161], v3 offset:37120
ds_read_b64_tr_b16 v[162:163], v3 offset:43264
v_mfma_f32_16x16x32_bf16 a[60:63], v[164:167], v[148:151], a[60:63]
v_exp_f32_e64 v26, v26
v_mfma_f32_16x16x32_bf16 a[100:103], v[164:167], v[152:155], a[100:103]
v_fma_f32 v27, v73, s28, v17
v_mfma_f32_16x16x32_bf16 a[140:143], v[164:167], v[156:159], a[140:143]
s_waitcnt lgkmcnt(4)
v_exp_f32 v27, v27
v_mfma_f32_16x16x32_bf16 a[24:27], v[168:171], v[144:147], a[24:27]
ds_read_b64_tr_b16 v[164:165], v4 offset:37120
ds_read_b64_tr_b16 v[166:167], v4 offset:43264
v_mfma_f32_16x16x32_bf16 a[64:67], v[168:171], v[148:151], a[64:67]
buffer_load_dwordx4 v8, s[12:15], s38 offen offset:1024 sc1 nt lds
v_mfma_f32_16x16x32_bf16 a[104:107], v[168:171], v[152:155], a[104:107]
v_cvt_pk_bf16_f32 v132, v26, v27
v_or3_b32 v30, v30, v131, v132
v_mfma_f32_16x16x32_bf16 a[144:147], v[168:171], v[156:159], a[144:147]
s_waitcnt lgkmcnt(4)
v_fma_f32 v28, v74, s28, v17
v_fma_f32 v29, v75, s28, v17
v_mfma_f32_16x16x32_bf16 a[28:31], v[172:175], v[144:147], a[28:31]
ds_read_b64_tr_b16 v[168:169], v5 offset:37120
ds_read_b64_tr_b16 v[170:171], v5 offset:43264
v_mfma_f32_16x16x32_bf16 a[68:71], v[172:175], v[148:151], a[68:71]
v_mfma_f32_16x16x32_bf16 a[108:111], v[172:175], v[152:155], a[108:111]
v_exp_f32 v28, v28
v_mfma_f32_16x16x32_bf16 a[148:151], v[172:175], v[156:159], a[148:151]
s_waitcnt lgkmcnt(4)
v_exp_f32_e64 v29, v29
v_mfma_f32_16x16x32_bf16 a[32:35], v[160:163], v[144:147], a[32:35]
s_sub_u32 s51, s32, s34
ds_read_b64_tr_b16 v[172:173], v6 offset:37120
ds_read_b64_tr_b16 v[174:175], v6 offset:43264
v_mfma_f32_16x16x32_bf16 a[72:75], v[160:163], v[148:151], a[72:75]
v_add_u32 v1, s51, v1
v_add_u32 v2, s51, v2
v_mfma_f32_16x16x32_bf16 a[112:115], v[160:163], v[152:155], a[112:115]
v_cvt_pk_bf16_f32 v133, v28, v29
v_fma_f32 v24, v76, s28, v17
v_mfma_f32_16x16x32_bf16 a[152:155], v[160:163], v[156:159], a[152:155]
s_waitcnt lgkmcnt(4)
v_exp_f32 v24, v24
v_mfma_f32_16x16x32_bf16 a[36:39], v[164:167], v[144:147], a[36:39]
ds_read_b128 v[160:163], v1 offset:0
v_fma_f32 v25, v77, s28, v17
v_mfma_f32_16x16x32_bf16 a[76:79], v[164:167], v[148:151], a[76:79]
v_exp_f32 v25, v25
v_mfma_f32_16x16x32_bf16 a[116:119], v[164:167], v[152:155], a[116:119]
v_cvt_pk_bf16_f32 v134, v24, v25
v_or3_b32 v30, v30, v133, v134
v_mfma_f32_16x16x32_bf16 a[156:159], v[164:167], v[156:159], a[156:159]
s_waitcnt lgkmcnt(3)
v_fma_f32 v26, v78, s28, v17
v_fma_f32 v27, v79, s28, v17
v_mfma_f32_16x16x32_bf16 v[32:35], v[168:171], v[144:147], v[32:35]
ds_read_b128 v[164:167], v1 offset:6144
v_fma_f32 v28, v80, s28, v18
v_mfma_f32_16x16x32_bf16 v[40:43], v[168:171], v[148:151], v[40:43]
buffer_load_dwordx4 v9, s[12:15], s38 offen offset:2048 sc1 nt lds
v_mfma_f32_16x16x32_bf16 v[48:51], v[168:171], v[152:155], v[48:51]
v_mfma_f32_16x16x32_bf16 v[56:59], v[168:171], v[156:159], v[56:59]
s_waitcnt lgkmcnt(2)
v_exp_f32 v26, v26
v_mfma_f32_16x16x32_bf16 v[36:39], v[172:175], v[144:147], v[36:39]
ds_read_b128 v[168:171], v2 offset:0
v_fma_f32 v29, v81, s28, v18
v_mfma_f32_16x16x32_bf16 v[44:47], v[172:175], v[148:151], v[44:47]
v_exp_f32_e64 v27, v27
v_mfma_f32_16x16x32_bf16 v[52:55], v[172:175], v[152:155], v[52:55]
v_cvt_pk_bf16_f32 v135, v26, v27
v_fma_f32 v24, v82, s28, v18
v_mfma_f32_16x16x32_bf16 v[60:63], v[172:175], v[156:159], v[60:63]
s_waitcnt lgkmcnt(2)
v_exp_f32 v28, v28
v_mfma_f32_16x16x32_bf16 v[96:99], v[160:163], a[160:163], 0
ds_read_b128 v[172:175], v2 offset:6144
v_fma_f32 v25, v83, s28, v18
v_mfma_f32_16x16x32_bf16 v[104:107], v[160:163], a[184:187], 0
v_exp_f32_e64 v29, v29
v_mfma_f32_16x16x32_bf16 v[112:115], v[160:163], a[208:211], 0
v_cvt_pk_bf16_f32 v136, v28, v29
v_or3_b32 v30, v30, v135, v136
v_mfma_f32_16x16x32_bf16 v[120:123], v[160:163], a[232:235], 0
s_waitcnt lgkmcnt(2)
v_mfma_f32_16x16x32_bf16 v[100:103], v[164:167], a[160:163], 0
ds_read_b128 v[160:163], v1 offset:128
v_fma_f32 v26, v84, s28, v18
v_mfma_f32_16x16x32_bf16 v[108:111], v[164:167], a[184:187], 0
s_add_u32 s20, s8, s43
s_addc_u32 s21, s9, 0
s_mov_b32 s22, s45
v_mfma_f32_16x16x32_bf16 v[116:119], v[164:167], a[208:211], 0
s_add_u32 m0, s37, 24576
v_exp_f32_e64 v24, v24
v_mfma_f32_16x16x32_bf16 v[124:127], v[164:167], a[232:235], 0
s_waitcnt lgkmcnt(2)
v_exp_f32 v25, v25
v_mfma_f32_16x16x32_bf16 v[96:99], v[168:171], a[164:167], v[96:99]
s_mov_b32 s38, 36864
ds_read_b128 v[164:167], v1 offset:6272
v_cvt_pk_bf16_f32 v137, v24, v25
v_mfma_f32_16x16x32_bf16 v[104:107], v[168:171], a[188:191], v[104:107]
buffer_load_dwordx4 v7, s[12:15], s38 offen sc1 nt lds
v_mfma_f32_16x16x32_bf16 v[112:115], v[168:171], a[212:215], v[112:115]
v_exp_f32 v26, v26
v_mfma_f32_16x16x32_bf16 v[120:123], v[168:171], a[236:239], v[120:123]
s_waitcnt lgkmcnt(2)
v_fma_f32 v27, v85, s28, v18
v_fma_f32 v28, v86, s28, v18
v_mfma_f32_16x16x32_bf16 v[100:103], v[172:175], a[164:167], v[100:103]
ds_read_b128 v[168:171], v2 offset:128
v_fma_f32 v29, v87, s28, v18
v_mfma_f32_16x16x32_bf16 v[108:111], v[172:175], a[188:191], v[108:111]
v_exp_f32_e64 v27, v27
v_mfma_f32_16x16x32_bf16 v[116:119], v[172:175], a[212:215], v[116:119]
v_cvt_pk_bf16_f32 v138, v26, v27
v_or3_b32 v30, v30, v137, v138
v_mfma_f32_16x16x32_bf16 v[124:127], v[172:175], a[236:239], v[124:127]
s_waitcnt lgkmcnt(2)
v_mfma_f32_16x16x32_bf16 v[96:99], v[160:163], a[168:171], v[96:99]
ds_read_b128 v[172:175], v2 offset:6272
v_fma_f32 v24, v88, s28, v19
v_mfma_f32_16x16x32_bf16 v[104:107], v[160:163], a[192:195], v[104:107]
v_exp_f32 v28, v28
v_mfma_f32_16x16x32_bf16 v[112:115], v[160:163], a[216:219], v[112:115]
v_exp_f32 v29, v29
v_mfma_f32_16x16x32_bf16 v[120:123], v[160:163], a[240:243], v[120:123]
s_waitcnt lgkmcnt(2)
v_cvt_pk_bf16_f32 v139, v28, v29
v_fma_f32 v25, v89, s28, v19
v_mfma_f32_16x16x32_bf16 v[100:103], v[164:167], a[168:171], v[100:103]
ds_read_b128 v[160:163], v1 offset:256
v_fma_f32 v26, v90, s28, v19
v_mfma_f32_16x16x32_bf16 v[108:111], v[164:167], a[192:195], v[108:111]
v_exp_f32_e64 v24, v24
v_mfma_f32_16x16x32_bf16 v[116:119], v[164:167], a[216:219], v[116:119]
v_exp_f32 v25, v25
v_mfma_f32_16x16x32_bf16 v[124:127], v[164:167], a[240:243], v[124:127]
s_waitcnt lgkmcnt(2)
v_cvt_pk_bf16_f32 v140, v24, v25
v_or3_b32 v30, v30, v139, v140
v_mfma_f32_16x16x32_bf16 v[96:99], v[168:171], a[172:175], v[96:99]
ds_read_b128 v[164:167], v1 offset:6400
v_fma_f32 v27, v91, s28, v19
v_mfma_f32_16x16x32_bf16 v[104:107], v[168:171], a[196:199], v[104:107]
buffer_load_dwordx4 v8, s[12:15], s38 offen offset:1024 sc1 nt lds
v_mfma_f32_16x16x32_bf16 v[112:115], v[168:171], a[220:223], v[112:115]
v_exp_f32_e64 v26, v26
v_mfma_f32_16x16x32_bf16 v[120:123], v[168:171], a[244:247], v[120:123]
s_waitcnt lgkmcnt(2)
v_mfma_f32_16x16x32_bf16 v[100:103], v[172:175], a[172:175], v[100:103]
s_sub_u32 s51, s32, s34
ds_read_b128 v[168:171], v2 offset:256
v_add_u32_e64 v3, s51, v3
v_mfma_f32_16x16x32_bf16 v[108:111], v[172:175], a[196:199], v[108:111]
v_add_u32 v4, s51, v4
v_add_u32 v5, s51, v5
v_mfma_f32_16x16x32_bf16 v[116:119], v[172:175], a[220:223], v[116:119]
v_add_u32_e64 v6, s51, v6
v_fma_f32 v28, v92, s28, v19
v_mfma_f32_16x16x32_bf16 v[124:127], v[172:175], a[244:247], v[124:127]
s_waitcnt lgkmcnt(2)
v_exp_f32 v27, v27
v_mfma_f32_16x16x32_bf16 v[96:99], v[160:163], a[176:179], v[96:99]
ds_read_b128 v[172:175], v2 offset:6400
v_cvt_pk_bf16_f32 v141, v26, v27
v_mfma_f32_16x16x32_bf16 v[104:107], v[160:163], a[200:203], v[104:107]
v_exp_f32_e64 v28, v28
v_mfma_f32_16x16x32_bf16 v[112:115], v[160:163], a[224:227], v[112:115]
v_fma_f32 v29, v93, s28, v19
v_fma_f32 v24, v94, s28, v19
v_mfma_f32_16x16x32_bf16 v[120:123], v[160:163], a[248:251], v[120:123]
s_waitcnt lgkmcnt(2)
v_exp_f32 v29, v29
v_mfma_f32_16x16x32_bf16 v[100:103], v[164:167], a[176:179], v[100:103]
ds_read_b64_tr_b16 v[160:161], v3 offset:12288
ds_read_b64_tr_b16 v[162:163], v3 offset:18432
v_mfma_f32_16x16x32_bf16 v[108:111], v[164:167], a[200:203], v[108:111]
v_cvt_pk_bf16_f32 v142, v28, v29
v_or3_b32 v30, v30, v141, v142
v_mfma_f32_16x16x32_bf16 v[116:119], v[164:167], a[224:227], v[116:119]
buffer_load_dwordx4 v9, s[12:15], s38 offen offset:2048 sc1 nt lds
v_mfma_f32_16x16x32_bf16 v[124:127], v[164:167], a[248:251], v[124:127]
s_waitcnt lgkmcnt(3)
v_exp_f32 v24, v24
v_mfma_f32_16x16x32_bf16 v[96:99], v[168:171], a[180:183], v[96:99]
ds_read_b64_tr_b16 v[164:165], v4 offset:12288
ds_read_b64_tr_b16 v[166:167], v4 offset:18432
v_mfma_f32_16x16x32_bf16 v[104:107], v[168:171], a[204:207], v[104:107]
v_fma_f32 v25, v95, s28, v19
v_mfma_f32_16x16x32_bf16 v[112:115], v[168:171], a[228:231], v[112:115]
v_exp_f32_e64 v25, v25
v_mfma_f32_16x16x32_bf16 v[120:123], v[168:171], a[252:255], v[120:123]
s_waitcnt lgkmcnt(4)
v_cvt_pk_bf16_f32 v143, v24, v25
v_or_b32 v30, v30, v143
v_mfma_f32_16x16x32_bf16 v[100:103], v[172:175], a[180:183], v[100:103]
ds_read_b64_tr_b16 v[168:169], v5 offset:12288
ds_read_b64_tr_b16 v[170:171], v5 offset:18432
v_mfma_f32_16x16x32_bf16 v[108:111], v[172:175], a[204:207], v[108:111]
v_and_b32_e64 v30, s29, v30
v_cmp_ne_u32 vcc, 0, v30
v_mfma_f32_16x16x32_bf16 v[116:119], v[172:175], a[228:231], v[116:119]
v_mfma_f32_16x16x32_bf16 v[124:127], v[172:175], a[252:255], v[124:127]
s_cbranch_vccnz L_tr12
L_bk12:
v_mfma_f32_16x16x32_bf16 v[20:23], v[180:183], v[128:131], v[20:23]
v_mfma_f32_16x16x32_bf16 v[176:179], v[180:183], v[132:135], v[176:179]
v_fma_f32 v24, v96, s28, v16
v_fma_f32 v25, v97, s28, v16
v_mfma_f32_16x16x32_bf16 v[184:187], v[180:183], v[136:139], v[184:187]
v_exp_f32_e64 v24, v24
v_mfma_f32_16x16x32_bf16 v[188:191], v[180:183], v[140:143], v[188:191]
s_waitcnt lgkmcnt(4)
v_exp_f32 v25, v25
v_mfma_f32_16x16x32_bf16 a[0:3], v[160:163], v[128:131], a[0:3]
ds_read_b64_tr_b16 v[172:173], v6 offset:12288
ds_read_b64_tr_b16 v[174:175], v6 offset:18432
v_mfma_f32_16x16x32_bf16 a[40:43], v[160:163], v[132:135], a[40:43]
v_cvt_pk_bf16_f32 v144, v24, v25
v_fma_f32 v26, v98, s28, v16
v_mfma_f32_16x16x32_bf16 a[80:83], v[160:163], v[136:139], a[80:83]
v_exp_f32 v26, v26
v_mfma_f32_16x16x32_bf16 a[120:123], v[160:163], v[140:143], a[120:123]
s_waitcnt lgkmcnt(4)
v_fma_f32 v27, v99, s28, v16
v_fma_f32 v28, v100, s28, v16
v_mfma_f32_16x16x32_bf16 a[4:7], v[164:167], v[128:131], a[4:7]
ds_read_b64_tr_b16 v[160:161], v3 offset:12416
ds_read_b64_tr_b16 v[162:163], v3 offset:18560
v_mfma_f32_16x16x32_bf16 a[44:47], v[164:167], v[132:135], a[44:47]
v_mfma_f32_16x16x32_bf16 a[84:87], v[164:167], v[136:139], a[84:87]
v_exp_f32 v27, v27
v_mfma_f32_16x16x32_bf16 a[124:127], v[164:167], v[140:143], a[124:127]
s_waitcnt lgkmcnt(4)
v_cvt_pk_bf16_f32 v145, v26, v27
v_fma_f32 v29, v101, s28, v16
v_mfma_f32_16x16x32_bf16 a[8:11], v[168:171], v[128:131], a[8:11]
ds_read_b64_tr_b16 v[164:165], v4 offset:12416
ds_read_b64_tr_b16 v[166:167], v4 offset:18560
v_mfma_f32_16x16x32_bf16 a[48:51], v[168:171], v[132:135], a[48:51]
s_waitcnt vmcnt(25)
s_barrier
v_mfma_f32_16x16x32_bf16 a[88:91], v[168:171], v[136:139], a[88:91]
s_add_u32 m0, s37, 36864
v_exp_f32_e64 v28, v28
v_mfma_f32_16x16x32_bf16 a[128:131], v[168:171], v[140:143], a[128:131]
s_waitcnt lgkmcnt(4)
v_exp_f32 v29, v29
v_mfma_f32_16x16x32_bf16 a[12:15], v[172:175], v[128:131], a[12:15]
s_mov_b32 s38, 49152
ds_read_b64_tr_b16 v[168:169], v5 offset:12416
ds_read_b64_tr_b16 v[170:171], v5 offset:18560
v_mfma_f32_16x16x32_bf16 a[52:55], v[172:175], v[132:135], a[52:55]
buffer_load_dwordx4 v7, s[12:15], s38 offen sc1 nt lds
v_mfma_f32_16x16x32_bf16 a[92:95], v[172:175], v[136:139], a[92:95]
v_cvt_pk_bf16_f32 v146, v28, v29
v_or3_b32 v30, v144, v145, v146
v_mfma_f32_16x16x32_bf16 a[132:135], v[172:175], v[140:143], a[132:135]
s_waitcnt lgkmcnt(4)
v_fma_f32 v24, v102, s28, v16
v_mfma_f32_16x16x32_bf16 a[16:19], v[160:163], v[128:131], a[16:19]
ds_read_b64_tr_b16 v[172:173], v6 offset:12416
ds_read_b64_tr_b16 v[174:175], v6 offset:18560
v_mfma_f32_16x16x32_bf16 a[56:59], v[160:163], v[132:135], a[56:59]
v_exp_f32_e64 v24, v24
v_mfma_f32_16x16x32_bf16 a[96:99], v[160:163], v[136:139], a[96:99]
v_fma_f32 v25, v103, s28, v16
v_fma_f32 v26, v104, s28, v17
v_mfma_f32_16x16x32_bf16 a[136:139], v[160:163], v[140:143], a[136:139]
s_waitcnt lgkmcnt(4)
v_mfma_f32_16x16x32_bf16 a[20:23], v[164:167], v[128:131], a[20:23]
ds_read_b64_tr_b16 v[160:161], v3 offset:12544
ds_read_b64_tr_b16 v[162:163], v3 offset:18688
v_mfma_f32_16x16x32_bf16 a[60:63], v[164:167], v[132:135], a[60:63]
buffer_load_dwordx4 v8, s[12:15], s38 offen offset:1024 sc1 nt lds
v_mfma_f32_16x16x32_bf16 a[100:103], v[164:167], v[136:139], a[100:103]
v_exp_f32 v25, v25
v_mfma_f32_16x16x32_bf16 a[140:143], v[164:167], v[140:143], a[140:143]
s_waitcnt lgkmcnt(4)
v_cvt_pk_bf16_f32 v147, v24, v25
v_fma_f32 v27, v105, s28, v17
v_mfma_f32_16x16x32_bf16 a[24:27], v[168:171], v[128:131], a[24:27]
ds_read_b64_tr_b16 v[164:165], v4 offset:12544
ds_read_b64_tr_b16 v[166:167], v4 offset:18688
v_mfma_f32_16x16x32_bf16 a[64:67], v[168:171], v[132:135], a[64:67]
v_exp_f32_e64 v26, v26
v_mfma_f32_16x16x32_bf16 a[104:107], v[168:171], v[136:139], a[104:107]
v_exp_f32 v27, v27
v_mfma_f32_16x16x32_bf16 a[144:147], v[168:171], v[140:143], a[144:147]
s_waitcnt lgkmcnt(4)
v_cvt_pk_bf16_f32 v148, v26, v27
v_or3_b32 v30, v30, v147, v148
v_mfma_f32_16x16x32_bf16 a[28:31], v[172:175], v[128:131], a[28:31]
ds_read_b64_tr_b16 v[168:169], v5 offset:12544
ds_read_b64_tr_b16 v[170:171], v5 offset:18688
v_mfma_f32_16x16x32_bf16 a[68:71], v[172:175], v[132:135], a[68:71]
v_fma_f32 v28, v106, s28, v17
v_mfma_f32_16x16x32_bf16 a[108:111], v[172:175], v[136:139], a[108:111]
buffer_load_dwordx4 v9, s[12:15], s38 offen offset:2048 sc1 nt lds
v_mfma_f32_16x16x32_bf16 a[148:151], v[172:175], v[140:143], a[148:151]
s_waitcnt lgkmcnt(4)
v_exp_f32 v28, v28
v_mfma_f32_16x16x32_bf16 a[32:35], v[160:163], v[128:131], a[32:35]
ds_read_b64_tr_b16 v[172:173], v6 offset:12544
ds_read_b64_tr_b16 v[174:175], v6 offset:18688
v_mfma_f32_16x16x32_bf16 a[72:75], v[160:163], v[132:135], a[72:75]
v_fma_f32 v29, v107, s28, v17
v_fma_f32 v24, v108, s28, v17
v_mfma_f32_16x16x32_bf16 a[112:115], v[160:163], v[136:139], a[112:115]
v_mfma_f32_16x16x32_bf16 a[152:155], v[160:163], v[140:143], a[152:155]
s_waitcnt lgkmcnt(4)
v_exp_f32 v29, v29
v_mfma_f32_16x16x32_bf16 a[36:39], v[164:167], v[128:131], a[36:39]
ds_read_b128 v[160:163], v1 offset:24576
v_cvt_pk_bf16_f32 v149, v28, v29
v_mfma_f32_16x16x32_bf16 a[76:79], v[164:167], v[132:135], a[76:79]
v_exp_f32 v24, v24
v_mfma_f32_16x16x32_bf16 a[116:119], v[164:167], v[136:139], a[116:119]
s_add_u32 m0, s35, 0
v_fma_f32 v25, v109, s28, v17
v_fma_f32 v26, v110, s28, v17
v_mfma_f32_16x16x32_bf16 a[156:159], v[164:167], v[140:143], a[156:159]
s_waitcnt lgkmcnt(3)
v_exp_f32 v25, v25
v_mfma_f32_16x16x32_bf16 v[32:35], v[168:171], v[128:131], v[32:35]
s_mov_b32 s38, 61440
ds_read_b128 v[164:167], v1 offset:30720
v_cvt_pk_bf16_f32 v150, v24, v25
v_mfma_f32_16x16x32_bf16 v[40:43], v[168:171], v[132:135], v[40:43]
buffer_load_dwordx4 v7, s[12:15], s38 offen sc1 nt lds
v_mfma_f32_16x16x32_bf16 v[48:51], v[168:171], v[136:139], v[48:51]
v_or3_b32 v30, v30, v149, v150
v_mfma_f32_16x16x32_bf16 v[56:59], v[168:171], v[140:143], v[56:59]
s_waitcnt lgkmcnt(2)
v_exp_f32 v26, v26
v_mfma_f32_16x16x32_bf16 v[36:39], v[172:175], v[128:131], v[36:39]
ds_read_b128 v[168:171], v2 offset:24576
v_fma_f32 v27, v111, s28, v17
v_mfma_f32_16x16x32_bf16 v[44:47], v[172:175], v[132:135], v[44:47]
v_mfma_f32_16x16x32_bf16 v[52:55], v[172:175], v[136:139], v[52:55]
v_exp_f32 v27, v27
v_mfma_f32_16x16x32_bf16 v[60:63], v[172:175], v[140:143], v[60:63]
s_waitcnt lgkmcnt(2)
v_cvt_pk_bf16_f32 v151, v26, v27
v_fma_f32 v28, v112, s28, v18
v_mfma_f32_16x16x32_bf16 v[64:67], v[160:163], a[160:163], 0
ds_read_b128 v[172:175], v2 offset:30720
v_fma_f32 v29, v113, s28, v18
v_mfma_f32_16x16x32_bf16 v[72:75], v[160:163], a[184:187], 0
v_exp_f32_e64 v28, v28
v_mfma_f32_16x16x32_bf16 v[80:83], v[160:163], a[208:211], 0
buffer_load_dwordx4 v8, s[12:15], s38 offen offset:1024 sc1 nt lds
v_mfma_f32_16x16x32_bf16 v[88:91], v[160:163], a[232:235], 0
s_waitcnt lgkmcnt(2)
v_exp_f32 v29, v29
v_mfma_f32_16x16x32_bf16 v[68:71], v[164:167], a[160:163], 0
ds_read_b128 v[160:163], v1 offset:24704
v_cvt_pk_bf16_f32 v152, v28, v29
v_mfma_f32_16x16x32_bf16 v[76:79], v[164:167], a[184:187], 0
v_or3_b32 v30, v30, v151, v152
v_fma_f32 v24, v114, s28, v18
v_mfma_f32_16x16x32_bf16 v[84:87], v[164:167], a[208:211], 0
v_mfma_f32_16x16x32_bf16 v[92:95], v[164:167], a[232:235], 0
s_waitcnt lgkmcnt(2)
v_exp_f32 v24, v24
v_mfma_f32_16x16x32_bf16 v[64:67], v[168:171], a[164:167], v[64:67]
ds_read_b128 v[164:167], v1 offset:30848
v_fma_f32 v25, v115, s28, v18
v_mfma_f32_16x16x32_bf16 v[72:75], v[168:171], a[188:191], v[72:75]
v_exp_f32_e64 v25, v25
v_mfma_f32_16x16x32_bf16 v[80:83], v[168:171], a[212:215], v[80:83]
v_cvt_pk_bf16_f32 v153, v24, v25
v_fma_f32 v26, v116, s28, v18
v_mfma_f32_16x16x32_bf16 v[88:91], v[168:171], a[236:239], v[88:91]
s_waitcnt lgkmcnt(2)
v_exp_f32 v26, v26
v_mfma_f32_16x16x32_bf16 v[68:71], v[172:175], a[164:167], v[68:71]
ds_read_b128 v[168:171], v2 offset:24704
v_fma_f32 v27, v117, s28, v18
v_mfma_f32_16x16x32_bf16 v[76:79], v[172:175], a[188:191], v[76:79]
buffer_load_dwordx4 v9, s[12:15], s38 offen offset:2048 sc1 nt lds
v_mfma_f32_16x16x32_bf16 v[84:87], v[172:175], a[212:215], v[84:87]
v_mfma_f32_16x16x32_bf16 v[92:95], v[172:175], a[236:239], v[92:95]
s_waitcnt lgkmcnt(2)
v_exp_f32 v27, v27
v_mfma_f32_16x16x32_bf16 v[64:67], v[160:163], a[168:171], v[64:67]
ds_read_b128 v[172:175], v2 offset:30848
v_cvt_pk_bf16_f32 v154, v26, v27
v_mfma_f32_16x16x32_bf16 v[72:75], v[160:163], a[192:195], v[72:75]
v_or3_b32 v30, v30, v153, v154
v_fma_f32 v28, v118, s28, v18
v_mfma_f32_16x16x32_bf16 v[80:83], v[160:163], a[216:219], v[80:83]
v_exp_f32 v28, v28
v_mfma_f32_16x16x32_bf16 v[88:91], v[160:163], a[240:243], v[88:91]
s_waitcnt lgkmcnt(2)
v_fma_f32 v29, v119, s28, v18
v_fma_f32 v24, v120, s28, v19
v_mfma_f32_16x16x32_bf16 v[68:71], v[164:167], a[168:171], v[68:71]
ds_read_b128 v[160:163], v1 offset:24832
v_fma_f32 v25, v121, s28, v19
v_mfma_f32_16x16x32_bf16 v[76:79], v[164:167], a[192:195], v[76:79]
v_mfma_f32_16x16x32_bf16 v[84:87], v[164:167], a[216:219], v[84:87]
v_exp_f32 v29, v29
v_mfma_f32_16x16x32_bf16 v[92:95], v[164:167], a[240:243], v[92:95]
s_waitcnt lgkmcnt(2)
v_cvt_pk_bf16_f32 v155, v28, v29
v_fma_f32 v26, v122, s28, v19
v_mfma_f32_16x16x32_bf16 v[64:67], v[168:171], a[172:175], v[64:67]
ds_read_b128 v[164:167], v1 offset:30976
v_fma_f32 v27, v123, s28, v19
v_mfma_f32_16x16x32_bf16 v[72:75], v[168:171], a[196:199], v[72:75]
v_exp_f32_e64 v24, v24
v_mfma_f32_16x16x32_bf16 v[80:83], v[168:171], a[220:223], v[80:83]
v_exp_f32 v25, v25
v_mfma_f32_16x16x32_bf16 v[88:91], v[168:171], a[244:247], v[88:91]
s_waitcnt lgkmcnt(2)
v_cvt_pk_bf16_f32 v156, v24, v25
v_mfma_f32_16x16x32_bf16 v[68:71], v[172:175], a[172:175], v[68:71]
ds_read_b128 v[168:171], v2 offset:24832
v_or3_b32 v30, v30, v155, v156
v_mfma_f32_16x16x32_bf16 v[76:79], v[172:175], a[196:199], v[76:79]
v_exp_f32_e64 v26, v26
v_mfma_f32_16x16x32_bf16 v[84:87], v[172:175], a[220:223], v[84:87]
v_exp_f32 v27, v27
v_mfma_f32_16x16x32_bf16 v[92:95], v[172:175], a[244:247], v[92:95]
s_waitcnt lgkmcnt(2)
v_cvt_pk_bf16_f32 v157, v26, v27
v_mfma_f32_16x16x32_bf16 v[64:67], v[160:163], a[176:179], v[64:67]
ds_read_b128 v[172:175], v2 offset:30976
v_fma_f32 v28, v124, s28, v19
v_mfma_f32_16x16x32_bf16 v[72:75], v[160:163], a[200:203], v[72:75]
v_exp_f32_e64 v28, v28
v_mfma_f32_16x16x32_bf16 v[80:83], v[160:163], a[224:227], v[80:83]
v_fma_f32 v29, v125, s28, v19
v_mfma_f32_16x16x32_bf16 v[88:91], v[160:163], a[248:251], v[88:91]
s_waitcnt lgkmcnt(2)
v_exp_f32 v29, v29
v_mfma_f32_16x16x32_bf16 v[68:71], v[164:167], a[176:179], v[68:71]
ds_read_b64_tr_b16 v[160:161], v3 offset:36864
ds_read_b64_tr_b16 v[162:163], v3 offset:43008
v_mfma_f32_16x16x32_bf16 v[76:79], v[164:167], a[200:203], v[76:79]
v_cvt_pk_bf16_f32 v158, v28, v29
v_or3_b32 v30, v30, v157, v158
v_mfma_f32_16x16x32_bf16 v[84:87], v[164:167], a[224:227], v[84:87]
v_fma_f32 v24, v126, s28, v19
v_mfma_f32_16x16x32_bf16 v[92:95], v[164:167], a[248:251], v[92:95]
s_waitcnt lgkmcnt(3)
v_exp_f32 v24, v24
v_mfma_f32_16x16x32_bf16 v[64:67], v[168:171], a[180:183], v[64:67]
ds_read_b64_tr_b16 v[164:165], v4 offset:36864
ds_read_b64_tr_b16 v[166:167], v4 offset:43008
v_mfma_f32_16x16x32_bf16 v[72:75], v[168:171], a[204:207], v[72:75]
v_fma_f32 v25, v127, s28, v19
v_mfma_f32_16x16x32_bf16 v[80:83], v[168:171], a[228:231], v[80:83]
v_exp_f32 v25, v25
v_mfma_f32_16x16x32_bf16 v[88:91], v[168:171], a[252:255], v[88:91]
s_waitcnt lgkmcnt(4)
v_cvt_pk_bf16_f32 v159, v24, v25
v_or_b32_e64 v30, v30, v159
v_mfma_f32_16x16x32_bf16 v[68:71], v[172:175], a[180:183], v[68:71]
ds_read_b64_tr_b16 v[168:169], v5 offset:36864
ds_read_b64_tr_b16 v[170:171], v5 offset:43008
v_mfma_f32_16x16x32_bf16 v[76:79], v[172:175], a[204:207], v[76:79]
v_and_b32_e64 v30, s29, v30
v_cmp_ne_u32 vcc, 0, v30
v_mfma_f32_16x16x32_bf16 v[84:87], v[172:175], a[228:231], v[84:87]
v_mfma_f32_16x16x32_bf16 v[92:95], v[172:175], a[252:255], v[92:95]
s_cbranch_vccnz L_tr13
L_bk13:
v_mfma_f32_16x16x32_bf16 v[20:23], v[180:183], v[144:147], v[20:23]
v_mfma_f32_16x16x32_bf16 v[176:179], v[180:183], v[148:151], v[176:179]
v_fma_f32 v24, v64, s28, v16
v_fma_f32 v25, v65, s28, v16
v_mfma_f32_16x16x32_bf16 v[184:187], v[180:183], v[152:155], v[184:187]
v_exp_f32_e64 v24, v24
v_mfma_f32_16x16x32_bf16 v[188:191], v[180:183], v[156:159], v[188:191]
s_waitcnt lgkmcnt(4)
v_exp_f32 v25, v25
v_mfma_f32_16x16x32_bf16 a[0:3], v[160:163], v[144:147], a[0:3]
ds_read_b64_tr_b16 v[172:173], v6 offset:36864
ds_read_b64_tr_b16 v[174:175], v6 offset:43008
v_mfma_f32_16x16x32_bf16 a[40:43], v[160:163], v[148:151], a[40:43]
v_cvt_pk_bf16_f32 v128, v24, v25
v_fma_f32 v26, v66, s28, v16
v_mfma_f32_16x16x32_bf16 a[80:83], v[160:163], v[152:155], a[80:83]
v_exp_f32 v26, v26
v_mfma_f32_16x16x32_bf16 a[120:123], v[160:163], v[156:159], a[120:123]
s_waitcnt lgkmcnt(4)
v_fma_f32 v27, v67, s28, v16
v_fma_f32 v28, v68, s28, v16
v_mfma_f32_16x16x32_bf16 a[4:7], v[164:167], v[144:147], a[4:7]
ds_read_b64_tr_b16 v[160:161], v3 offset:36992
ds_read_b64_tr_b16 v[162:163], v3 offset:43136
v_mfma_f32_16x16x32_bf16 a[44:47], v[164:167], v[148:151], a[44:47]
v_exp_f32_e64 v27, v27
v_mfma_f32_16x16x32_bf16 a[84:87], v[164:167], v[152:155], a[84:87]
v_cvt_pk_bf16_f32 v129, v26, v27
v_mfma_f32_16x16x32_bf16 a[124:127], v[164:167], v[156:159], a[124:127]
s_waitcnt lgkmcnt(4)
v_exp_f32 v28, v28
v_mfma_f32_16x16x32_bf16 a[8:11], v[168:171], v[144:147], a[8:11]
ds_read_b64_tr_b16 v[164:165], v4 offset:36992
ds_read_b64_tr_b16 v[166:167], v4 offset:43136
v_mfma_f32_16x16x32_bf16 a[48:51], v[168:171], v[148:151], a[48:51]
s_waitcnt vmcnt(23)
s_barrier
v_mfma_f32_16x16x32_bf16 a[88:91], v[168:171], v[152:155], a[88:91]
s_add_u32 m0, s35, 12288
v_fma_f32 v29, v69, s28, v16
v_fma_f32 v24, v70, s28, v16
v_mfma_f32_16x16x32_bf16 a[128:131], v[168:171], v[156:159], a[128:131]
s_waitcnt lgkmcnt(4)
v_exp_f32 v29, v29
v_mfma_f32_16x16x32_bf16 a[12:15], v[172:175], v[144:147], a[12:15]
s_mov_b32 s38, 73728
ds_read_b64_tr_b16 v[168:169], v5 offset:36992
ds_read_b64_tr_b16 v[170:171], v5 offset:43136
v_mfma_f32_16x16x32_bf16 a[52:55], v[172:175], v[148:151], a[52:55]
L_pad7:
s_cbranch_execz L_warm_next
buffer_load_dwordx4 v7, s[12:15], s38 offen sc1 nt lds
v_mfma_f32_16x16x32_bf16 a[92:95], v[172:175], v[152:155], a[92:95]
v_cvt_pk_bf16_f32 v130, v28, v29
v_mfma_f32_16x16x32_bf16 a[132:135], v[172:175], v[156:159], a[132:135]
s_waitcnt lgkmcnt(4)
v_or3_b32 v30, v128, v129, v130
v_fma_f32 v25, v71, s28, v16
v_mfma_f32_16x16x32_bf16 a[16:19], v[160:163], v[144:147], a[16:19]
ds_read_b64_tr_b16 v[172:173], v6 offset:36992
ds_read_b64_tr_b16 v[174:175], v6 offset:43136
v_mfma_f32_16x16x32_bf16 a[56:59], v[160:163], v[148:151], a[56:59]
v_exp_f32_e64 v24, v24
v_mfma_f32_16x16x32_bf16 a[96:99], v[160:163], v[152:155], a[96:99]
v_exp_f32 v25, v25
v_mfma_f32_16x16x32_bf16 a[136:139], v[160:163], v[156:159], a[136:139]
s_waitcnt lgkmcnt(4)
v_cvt_pk_bf16_f32 v131, v24, v25
v_mfma_f32_16x16x32_bf16 a[20:23], v[164:167], v[144:147], a[20:23]
ds_read_b64_tr_b16 v[160:161], v3 offset:37120
ds_read_b64_tr_b16 v[162:163], v3 offset:43264
v_mfma_f32_16x16x32_bf16 a[60:63], v[164:167], v[148:151], a[60:63]
buffer_load_dwordx4 v8, s[12:15], s38 offen offset:1024 sc1 nt lds
v_mfma_f32_16x16x32_bf16 a[100:103], v[164:167], v[152:155], a[100:103]
v_fma_f32 v26, v72, s28, v17
v_fma_f32 v27, v73, s28, v17
v_mfma_f32_16x16x32_bf16 a[140:143], v[164:167], v[156:159], a[140:143]
s_waitcnt lgkmcnt(4)
v_exp_f32 v26, v26
v_mfma_f32_16x16x32_bf16 a[24:27], v[168:171], v[144:147], a[24:27]
ds_read_b64_tr_b16 v[164:165], v4 offset:37120
ds_read_b64_tr_b16 v[166:167], v4 offset:43264
v_mfma_f32_16x16x32_bf16 a[64:67], v[168:171], v[148:151], a[64:67]
v_exp_f32 v27, v27
v_mfma_f32_16x16x32_bf16 a[104:107], v[168:171], v[152:155], a[104:107]
v_cvt_pk_bf16_f32 v132, v26, v27
v_mfma_f32_16x16x32_bf16 a[144:147], v[168:171], v[156:159], a[144:147]
s_waitcnt lgkmcnt(4)
v_or3_b32 v30, v30, v131, v132
v_fma_f32 v28, v74, s28, v17
v_mfma_f32_16x16x32_bf16 a[28:31], v[172:175], v[144:147], a[28:31]
ds_read_b64_tr_b16 v[168:169], v5 offset:37120
ds_read_b64_tr_b16 v[170:171], v5 offset:43264
v_mfma_f32_16x16x32_bf16 a[68:71], v[172:175], v[148:151], a[68:71]
v_exp_f32_e64 v28, v28
v_mfma_f32_16x16x32_bf16 a[108:111], v[172:175], v[152:155], a[108:111]
buffer_load_dwordx4 v9, s[12:15], s38 offen offset:2048 sc1 nt lds
v_mfma_f32_16x16x32_bf16 a[148:151], v[172:175], v[156:159], a[148:151]
s_waitcnt lgkmcnt(4)
v_fma_f32 v29, v75, s28, v17
v_fma_f32 v24, v76, s28, v17
v_mfma_f32_16x16x32_bf16 a[32:35], v[160:163], v[144:147], a[32:35]
s_sub_u32 s51, s33, s32
ds_read_b64_tr_b16 v[172:173], v6 offset:37120
ds_read_b64_tr_b16 v[174:175], v6 offset:43264
v_mfma_f32_16x16x32_bf16 a[72:75], v[160:163], v[148:151], a[72:75]
v_add_u32 v1, s51, v1
v_add_u32 v2, s51, v2
v_mfma_f32_16x16x32_bf16 a[112:115], v[160:163], v[152:155], a[112:115]
v_mfma_f32_16x16x32_bf16 a[152:155], v[160:163], v[156:159], a[152:155]
s_waitcnt lgkmcnt(4)
v_exp_f32 v29, v29
v_mfma_f32_16x16x32_bf16 a[36:39], v[164:167], v[144:147], a[36:39]
ds_read_b128 v[160:163], v1 offset:0
v_cvt_pk_bf16_f32 v133, v28, v29
v_mfma_f32_16x16x32_bf16 a[76:79], v[164:167], v[148:151], a[76:79]
v_exp_f32_e64 v24, v24
v_mfma_f32_16x16x32_bf16 a[116:119], v[164:167], v[152:155], a[116:119]
s_add_u32 m0, s35, 24576
v_fma_f32 v25, v77, s28, v17
v_fma_f32 v26, v78, s28, v17
v_mfma_f32_16x16x32_bf16 a[156:159], v[164:167], v[156:159], a[156:159]
s_waitcnt lgkmcnt(3)
v_exp_f32 v25, v25
v_mfma_f32_16x16x32_bf16 v[32:35], v[168:171], v[144:147], v[32:35]
s_mov_b32 s38, 86016
ds_read_b128 v[164:167], v1 offset:6144
v_cvt_pk_bf16_f32 v134, v24, v25
v_mfma_f32_16x16x32_bf16 v[40:43], v[168:171], v[148:151], v[40:43]
buffer_load_dwordx4 v7, s[12:15], s38 offen sc1 nt lds
v_mfma_f32_16x16x32_bf16 v[48:51], v[168:171], v[152:155], v[48:51]
v_or3_b32 v30, v30, v133, v134
v_fma_f32 v27, v79, s28, v17
v_mfma_f32_16x16x32_bf16 v[56:59], v[168:171], v[156:159], v[56:59]
s_waitcnt lgkmcnt(2)
v_exp_f32 v26, v26
v_mfma_f32_16x16x32_bf16 v[36:39], v[172:175], v[144:147], v[36:39]
ds_read_b128 v[168:171], v2 offset:0
v_mfma_f32_16x16x32_bf16 v[44:47], v[172:175], v[148:151], v[44:47]
v_exp_f32_e64 v27, v27
v_mfma_f32_16x16x32_bf16 v[52:55], v[172:175], v[152:155], v[52:55]
v_cvt_pk_bf16_f32 v135, v26, v27
v_fma_f32 v28, v80, s28, v18
v_mfma_f32_16x16x32_bf16 v[60:63], v[172:175], v[156:159], v[60:63]
s_waitcnt lgkmcnt(2)
v_exp_f32 v28, v28
v_mfma_f32_16x16x32_bf16 v[96:99], v[160:163], a[160:163], 0
ds_read_b128 v[172:175], v2 offset:6144
v_mfma_f32_16x16x32_bf16 v[104:107], v[160:163], a[184:187], 0
v_fma_f32 v29, v81, s28, v18
v_fma_f32 v24, v82, s28, v18
v_mfma_f32_16x16x32_bf16 v[112:115], v[160:163], a[208:211], 0
buffer_load_dwordx4 v8, s[12:15], s38 offen offset:1024 sc1 nt lds
v_mfma_f32_16x16x32_bf16 v[120:123], v[160:163], a[232:235], 0
s_waitcnt lgkmcnt(2)
v_exp_f32 v29, v29
v_mfma_f32_16x16x32_bf16 v[100:103], v[164:167], a[160:163], 0
ds_read_b128 v[160:163], v1 offset:128
v_cvt_pk_bf16_f32 v136, v28, v29
v_mfma_f32_16x16x32_bf16 v[108:111], v[164:167], a[184:187], 0
v_or3_b32 v30, v30, v135, v136
v_fma_f32 v25, v83, s28, v18
v_mfma_f32_16x16x32_bf16 v[116:119], v[164:167], a[208:211], 0
v_mfma_f32_16x16x32_bf16 v[124:127], v[164:167], a[232:235], 0
s_waitcnt lgkmcnt(2)
v_exp_f32 v24, v24
v_mfma_f32_16x16x32_bf16 v[96:99], v[168:171], a[164:167], v[96:99]
ds_read_b128 v[164:167], v1 offset:6272
v_fma_f32 v26, v84, s28, v18
v_mfma_f32_16x16x32_bf16 v[104:107], v[168:171], a[188:191], v[104:107]
v_exp_f32_e64 v25, v25
v_mfma_f32_16x16x32_bf16 v[112:115], v[168:171], a[212:215], v[112:115]
v_cvt_pk_bf16_f32 v137, v24, v25
v_fma_f32 v27, v85, s28, v18
v_mfma_f32_16x16x32_bf16 v[120:123], v[168:171], a[236:239], v[120:123]
s_waitcnt lgkmcnt(2)
v_exp_f32 v26, v26
v_mfma_f32_16x16x32_bf16 v[100:103], v[172:175], a[164:167], v[100:103]
ds_read_b128 v[168:171], v2 offset:128
v_fma_f32 v28, v86, s28, v18
v_mfma_f32_16x16x32_bf16 v[108:111], v[172:175], a[188:191], v[108:111]
buffer_load_dwordx4 v9, s[12:15], s38 offen offset:2048 sc1 nt lds
v_mfma_f32_16x16x32_bf16 v[116:119], v[172:175], a[212:215], v[116:119]
v_exp_f32 v27, v27
v_mfma_f32_16x16x32_bf16 v[124:127], v[172:175], a[236:239], v[124:127]
s_waitcnt lgkmcnt(2)
v_cvt_pk_bf16_f32 v138, v26, v27
v_or3_b32 v30, v30, v137, v138
v_mfma_f32_16x16x32_bf16 v[96:99], v[160:163], a[168:171], v[96:99]
ds_read_b128 v[172:175], v2 offset:6272
v_mfma_f32_16x16x32_bf16 v[104:107], v[160:163], a[192:195], v[104:107]
v_exp_f32_e64 v28, v28
v_mfma_f32_16x16x32_bf16 v[112:115], v[160:163], a[216:219], v[112:115]
v_fma_f32 v29, v87, s28, v18
v_fma_f32 v24, v88, s28, v19
v_mfma_f32_16x16x32_bf16 v[120:123], v[160:163], a[240:243], v[120:123]
s_waitcnt lgkmcnt(2)
v_exp_f32 v29, v29
v_mfma_f32_16x16x32_bf16 v[100:103], v[164:167], a[168:171], v[100:103]
ds_read_b128 v[160:163], v1 offset:256
v_cvt_pk_bf16_f32 v139, v28, v29
v_mfma_f32_16x16x32_bf16 v[108:111], v[164:167], a[192:195], v[108:111]
v_mfma_f32_16x16x32_bf16 v[116:119], v[164:167], a[216:219], v[116:119]
v_exp_f32 v24, v24
v_mfma_f32_16x16x32_bf16 v[124:127], v[164:167], a[240:243], v[124:127]
s_waitcnt lgkmcnt(2)
v_fma_f32 v25, v89, s28, v19
v_fma_f32 v26, v90, s28, v19
v_mfma_f32_16x16x32_bf16 v[96:99], v[168:171], a[172:175], v[96:99]
ds_read_b128 v[164:167], v1 offset:6400
v_fma_f32 v27, v91, s28, v19
v_mfma_f32_16x16x32_bf16 v[104:107], v[168:171], a[196:199], v[104:107]
v_exp_f32_e64 v25, v25
v_mfma_f32_16x16x32_bf16 v[112:115], v[168:171], a[220:223], v[112:115]
v_cvt_pk_bf16_f32 v140, v24, v25
v_or3_b32 v30, v30, v139, v140
v_mfma_f32_16x16x32_bf16 v[120:123], v[168:171], a[244:247], v[120:123]
s_waitcnt lgkmcnt(2)
v_exp_f32 v26, v26
v_mfma_f32_16x16x32_bf16 v[100:103], v[172:175], a[172:175], v[100:103]
s_sub_u32 s51, s33, s32
ds_read_b128 v[168:171], v2 offset:256
v_add_u32 v3, s51, v3
v_mfma_f32_16x16x32_bf16 v[108:111], v[172:175], a[196:199], v[108:111]
v_add_u32 v4, s51, v4
v_add_u32 v5, s51, v5
v_mfma_f32_16x16x32_bf16 v[116:119], v[172:175], a[220:223], v[116:119]
v_add_u32 v6, s51, v6
v_fma_f32 v28, v92, s28, v19
v_mfma_f32_16x16x32_bf16 v[124:127], v[172:175], a[244:247], v[124:127]
s_waitcnt lgkmcnt(2)
v_mfma_f32_16x16x32_bf16 v[96:99], v[160:163], a[176:179], v[96:99]
ds_read_b128 v[172:175], v2 offset:6400
v_fma_f32 v29, v93, s28, v19
v_mfma_f32_16x16x32_bf16 v[104:107], v[160:163], a[200:203], v[104:107]
v_exp_f32_e64 v27, v27
v_mfma_f32_16x16x32_bf16 v[112:115], v[160:163], a[224:227], v[112:115]
v_cvt_pk_bf16_f32 v141, v26, v27
v_fma_f32 v24, v94, s28, v19
v_mfma_f32_16x16x32_bf16 v[120:123], v[160:163], a[248:251], v[120:123]
s_waitcnt lgkmcnt(2)
v_exp_f32 v28, v28
v_mfma_f32_16x16x32_bf16 v[100:103], v[164:167], a[176:179], v[100:103]
ds_read_b64_tr_b16 v[160:161], v3 offset:12288
ds_read_b64_tr_b16 v[162:163], v3 offset:18432
v_mfma_f32_16x16x32_bf16 v[108:111], v[164:167], a[200:203], v[108:111]
v_exp_f32_e64 v29, v29
v_mfma_f32_16x16x32_bf16 v[116:119], v[164:167], a[224:227], v[116:119]
v_cvt_pk_bf16_f32 v142, v28, v29
v_or3_b32 v30, v30, v141, v142
v_mfma_f32_16x16x32_bf16 v[124:127], v[164:167], a[248:251], v[124:127]
s_waitcnt lgkmcnt(3)
v_exp_f32 v24, v24
v_mfma_f32_16x16x32_bf16 v[96:99], v[168:171], a[180:183], v[96:99]
ds_read_b64_tr_b16 v[164:165], v4 offset:12288
ds_read_b64_tr_b16 v[166:167], v4 offset:18432
v_mfma_f32_16x16x32_bf16 v[104:107], v[168:171], a[204:207], v[104:107]
v_fma_f32 v25, v95, s28, v19
v_mfma_f32_16x16x32_bf16 v[112:115], v[168:171], a[228:231], v[112:115]
v_exp_f32_e64 v25, v25
v_mfma_f32_16x16x32_bf16 v[120:123], v[168:171], a[252:255], v[120:123]
s_waitcnt lgkmcnt(4)
v_cvt_pk_bf16_f32 v143, v24, v25
v_or_b32 v30, v30, v143
v_mfma_f32_16x16x32_bf16 v[100:103], v[172:175], a[180:183], v[100:103]
ds_read_b64_tr_b16 v[168:169], v5 offset:12288
ds_read_b64_tr_b16 v[170:171], v5 offset:18432
v_mfma_f32_16x16x32_bf16 v[108:111], v[172:175], a[204:207], v[108:111]
v_and_b32_e64 v30, s29, v30
v_cmp_ne_u32 vcc, 0, v30
v_mfma_f32_16x16x32_bf16 v[116:119], v[172:175], a[228:231], v[116:119]
v_mfma_f32_16x16x32_bf16 v[124:127], v[172:175], a[252:255], v[124:127]
s_cbranch_vccnz L_tr14
L_bk14:
v_mfma_f32_16x16x32_bf16 v[20:23], v[180:183], v[128:131], v[20:23]
v_mfma_f32_16x16x32_bf16 v[176:179], v[180:183], v[132:135], v[176:179]
v_fma_f32 v24, v96, s28, v16
v_fma_f32 v25, v97, s28, v16
v_mfma_f32_16x16x32_bf16 v[184:187], v[180:183], v[136:139], v[184:187]
v_exp_f32_e64 v24, v24
v_mfma_f32_16x16x32_bf16 v[188:191], v[180:183], v[140:143], v[188:191]
s_waitcnt lgkmcnt(4)
v_exp_f32 v25, v25
v_mfma_f32_16x16x32_bf16 a[0:3], v[160:163], v[128:131], a[0:3]
ds_read_b64_tr_b16 v[172:173], v6 offset:12288
ds_read_b64_tr_b16 v[174:175], v6 offset:18432
v_mfma_f32_16x16x32_bf16 a[40:43], v[160:163], v[132:135], a[40:43]
v_cvt_pk_bf16_f32 v144, v24, v25
v_fma_f32 v26, v98, s28, v16
v_mfma_f32_16x16x32_bf16 a[80:83], v[160:163], v[136:139], a[80:83]
v_exp_f32 v26, v26
v_mfma_f32_16x16x32_bf16 a[120:123], v[160:163], v[140:143], a[120:123]
s_waitcnt lgkmcnt(4)
v_fma_f32 v27, v99, s28, v16
v_fma_f32 v28, v100, s28, v16
v_mfma_f32_16x16x32_bf16 a[4:7], v[164:167], v[128:131], a[4:7]
ds_read_b64_tr_b16 v[160:161], v3 offset:12416
ds_read_b64_tr_b16 v[162:163], v3 offset:18560
v_mfma_f32_16x16x32_bf16 a[44:47], v[164:167], v[132:135], a[44:47]
v_exp_f32_e64 v27, v27
v_mfma_f32_16x16x32_bf16 a[84:87], v[164:167], v[136:139], a[84:87]
v_cvt_pk_bf16_f32 v145, v26, v27
v_fma_f32 v29, v101, s28, v16
v_mfma_f32_16x16x32_bf16 a[124:127], v[164:167], v[140:143], a[124:127]
s_waitcnt lgkmcnt(4)
v_exp_f32 v28, v28
v_mfma_f32_16x16x32_bf16 a[8:11], v[168:171], v[128:131], a[8:11]
ds_read_b64_tr_b16 v[164:165], v4 offset:12416
ds_read_b64_tr_b16 v[166:167], v4 offset:18560
v_mfma_f32_16x16x32_bf16 a[48:51], v[168:171], v[132:135], a[48:51]
s_waitcnt vmcnt(25)
s_barrier
v_mfma_f32_16x16x32_bf16 a[88:91], v[168:171], v[136:139], a[88:91]
s_add_u32 m0, s35, 36864
v_exp_f32_e64 v29, v29
v_mfma_f32_16x16x32_bf16 a[128:131], v[168:171], v[140:143], a[128:131]
s_waitcnt lgkmcnt(4)
v_cvt_pk_bf16_f32 v146, v28, v29
v_or3_b32 v30, v144, v145, v146
v_mfma_f32_16x16x32_bf16 a[12:15], v[172:175], v[128:131], a[12:15]
s_mov_b32 s38, 0
ds_read_b64_tr_b16 v[168:169], v5 offset:12416
ds_read_b64_tr_b16 v[170:171], v5 offset:18560
v_mfma_f32_16x16x32_bf16 a[52:55], v[172:175], v[132:135], a[52:55]
buffer_load_dwordx4 v7, s[16:19], s38 offen  lds
v_mfma_f32_16x16x32_bf16 a[92:95], v[172:175], v[136:139], a[92:95]
v_fma_f32 v24, v102, s28, v16
v_fma_f32 v25, v103, s28, v16
v_mfma_f32_16x16x32_bf16 a[132:135], v[172:175], v[140:143], a[132:135]
s_waitcnt lgkmcnt(4)
v_exp_f32 v24, v24
v_mfma_f32_16x16x32_bf16 a[16:19], v[160:163], v[128:131], a[16:19]
ds_read_b64_tr_b16 v[172:173], v6 offset:12416
ds_read_b64_tr_b16 v[174:175], v6 offset:18560
v_mfma_f32_16x16x32_bf16 a[56:59], v[160:163], v[132:135], a[56:59]
buffer_load_dwordx4 v8, s[16:19], s38 offen offset:1024  lds
v_mfma_f32_16x16x32_bf16 a[96:99], v[160:163], v[136:139], a[96:99]
v_exp_f32 v25, v25
v_mfma_f32_16x16x32_bf16 a[136:139], v[160:163], v[140:143], a[136:139]
s_waitcnt lgkmcnt(4)
v_cvt_pk_bf16_f32 v147, v24, v25
v_fma_f32 v26, v104, s28, v17
v_mfma_f32_16x16x32_bf16 a[20:23], v[164:167], v[128:131], a[20:23]
ds_read_b64_tr_b16 v[160:161], v3 offset:12544
ds_read_b64_tr_b16 v[162:163], v3 offset:18688
v_mfma_f32_16x16x32_bf16 a[60:63], v[164:167], v[132:135], a[60:63]
v_exp_f32 v26, v26
v_mfma_f32_16x16x32_bf16 a[100:103], v[164:167], v[136:139], a[100:103]
buffer_load_dwordx4 v9, s[16:19], s38 offen offset:2048  lds
v_mfma_f32_16x16x32_bf16 a[140:143], v[164:167], v[140:143], a[140:143]
s_waitcnt lgkmcnt(4)
v_fma_f32 v27, v105, s28, v17
v_fma_f32 v28, v106, s28, v17
v_mfma_f32_16x16x32_bf16 a[24:27], v[168:171], v[128:131], a[24:27]
ds_read_b64_tr_b16 v[164:165], v4 offset:12544
ds_read_b64_tr_b16 v[166:167], v4 offset:18688
v_mfma_f32_16x16x32_bf16 a[64:67], v[168:171], v[132:135], a[64:67]
v_exp_f32 v27, v27
v_mfma_f32_16x16x32_bf16 a[104:107], v[168:171], v[136:139], a[104:107]
s_add_u32 m0, s36, 0
v_cvt_pk_bf16_f32 v148, v26, v27
v_or3_b32 v30, v30, v147, v148
v_mfma_f32_16x16x32_bf16 a[144:147], v[168:171], v[140:143], a[144:147]
s_waitcnt lgkmcnt(4)
v_exp_f32 v28, v28
v_mfma_f32_16x16x32_bf16 a[28:31], v[172:175], v[128:131], a[28:31]
s_mov_b32 s38, 12288
ds_read_b64_tr_b16 v[168:169], v5 offset:12544
ds_read_b64_tr_b16 v[170:171], v5 offset:18688
v_mfma_f32_16x16x32_bf16 a[68:71], v[172:175], v[132:135], a[68:71]
buffer_load_dwordx4 v7, s[16:19], s38 offen  lds
v_mfma_f32_16x16x32_bf16 a[108:111], v[172:175], v[136:139], a[108:111]
v_fma_f32 v29, v107, s28, v17
v_fma_f32 v24, v108, s28, v17
v_mfma_f32_16x16x32_bf16 a[148:151], v[172:175], v[140:143], a[148:151]
s_waitcnt lgkmcnt(4)
v_exp_f32 v29, v29
v_mfma_f32_16x16x32_bf16 a[32:35], v[160:163], v[128:131], a[32:35]
ds_read_b64_tr_b16 v[172:173], v6 offset:12544
ds_read_b64_tr_b16 v[174:175], v6 offset:18688
v_mfma_f32_16x16x32_bf16 a[72:75], v[160:163], v[132:135], a[72:75]
v_cvt_pk_bf16_f32 v149, v28, v29
v_fma_f32 v25, v109, s28, v17
v_mfma_f32_16x16x32_bf16 a[112:115], v[160:163], v[136:139], a[112:115]
buffer_load_dwordx4 v8, s[16:19], s38 offen offset:1024  lds
v_mfma_f32_16x16x32_bf16 a[152:155], v[160:163], v[140:143], a[152:155]
s_waitcnt lgkmcnt(4)
v_exp_f32 v24, v24
v_mfma_f32_16x16x32_bf16 a[36:39], v[164:167], v[128:131], a[36:39]
ds_read_b64_tr_b16 v[160:161], v3 offset:24576
ds_read_b64_tr_b16 v[162:163], v3 offset:30720
v_mfma_f32_16x16x32_bf16 a[76:79], v[164:167], v[132:135], a[76:79]
v_exp_f32 v25, v25
v_mfma_f32_16x16x32_bf16 a[116:119], v[164:167], v[136:139], a[116:119]
v_cvt_pk_bf16_f32 v150, v24, v25
v_or3_b32 v30, v30, v149, v150
v_mfma_f32_16x16x32_bf16 a[156:159], v[164:167], v[140:143], a[156:159]
s_waitcnt lgkmcnt(4)
v_fma_f32 v26, v110, s28, v17
v_fma_f32 v27, v111, s28, v17
v_mfma_f32_16x16x32_bf16 v[32:35], v[168:171], v[128:131], v[32:35]
ds_read_b64_tr_b16 v[164:165], v4 offset:24576
ds_read_b64_tr_b16 v[166:167], v4 offset:30720
v_mfma_f32_16x16x32_bf16 v[40:43], v[168:171], v[132:135], v[40:43]
buffer_load_dwordx4 v9, s[16:19], s38 offen offset:2048  lds
v_mfma_f32_16x16x32_bf16 v[48:51], v[168:171], v[136:139], v[48:51]
v_exp_f32_e64 v26, v26
v_mfma_f32_16x16x32_bf16 v[56:59], v[168:171], v[140:143], v[56:59]
s_waitcnt lgkmcnt(4)
v_exp_f32 v27, v27
v_mfma_f32_16x16x32_bf16 v[36:39], v[172:175], v[128:131], v[36:39]
ds_read_b64_tr_b16 v[168:169], v5 offset:24576
ds_read_b64_tr_b16 v[170:171], v5 offset:30720
v_mfma_f32_16x16x32_bf16 v[44:47], v[172:175], v[132:135], v[44:47]
v_cvt_pk_bf16_f32 v151, v26, v27
v_fma_f32 v28, v112, s28, v18
v_mfma_f32_16x16x32_bf16 v[52:55], v[172:175], v[136:139], v[52:55]
v_exp_f32_e64 v28, v28
v_mfma_f32_16x16x32_bf16 v[60:63], v[172:175], v[140:143], v[60:63]
v_fma_f32 v29, v113, s28, v18
v_exp_f32 v29, v29
s_nop 0
v_cvt_pk_bf16_f32 v152, v28, v29
v_or3_b32 v30, v30, v151, v152
v_fma_f32 v24, v114, s28, v18
v_exp_f32_e64 v24, v24
v_fma_f32 v25, v115, s28, v18
v_exp_f32 v25, v25
s_nop 0
v_cvt_pk_bf16_f32 v153, v24, v25
v_fma_f32 v26, v116, s28, v18
v_exp_f32_e64 v26, v26
v_fma_f32 v27, v117, s28, v18
v_exp_f32 v27, v27
s_nop 0
v_cvt_pk_bf16_f32 v154, v26, v27
v_or3_b32 v30, v30, v153, v154
v_fma_f32 v28, v118, s28, v18
v_exp_f32_e64 v28, v28
v_fma_f32 v29, v119, s28, v18
v_exp_f32 v29, v29
s_nop 0
v_cvt_pk_bf16_f32 v155, v28, v29
v_fma_f32 v24, v120, s28, v19
v_exp_f32_e64 v24, v24
v_fma_f32 v25, v121, s28, v19
v_exp_f32 v25, v25
s_nop 0
v_cvt_pk_bf16_f32 v156, v24, v25
v_or3_b32 v30, v30, v155, v156
v_fma_f32 v26, v122, s28, v19
v_exp_f32_e64 v26, v26
v_fma_f32 v27, v123, s28, v19
v_exp_f32 v27, v27
s_nop 0
v_cvt_pk_bf16_f32 v157, v26, v27
v_fma_f32 v28, v124, s28, v19
v_exp_f32_e64 v28, v28
v_fma_f32 v29, v125, s28, v19
v_exp_f32 v29, v29
s_nop 0
v_cvt_pk_bf16_f32 v158, v28, v29
v_or3_b32 v30, v30, v157, v158
v_fma_f32 v24, v126, s28, v19
v_exp_f32_e64 v24, v24
v_fma_f32 v25, v127, s28, v19
v_exp_f32 v25, v25
s_nop 0
v_cvt_pk_bf16_f32 v159, v24, v25
v_or_b32_e64 v30, v30, v159
v_and_b32 v30, s29, v30
v_cmp_ne_u32 vcc, 0, v30
s_cbranch_vccnz L_tr15
L_bk15:
v_mfma_f32_16x16x32_bf16 v[20:23], v[180:183], v[144:147], v[20:23]
s_add_u32 s39, s46, s32
s_cmp_ge_u32 s39, 147456
s_cselect_b32 s48, 147456, 0
v_mfma_f32_16x16x32_bf16 v[176:179], v[180:183], v[148:151], v[176:179]
s_sub_u32 s39, s39, s48
s_sub_u32 s39, s39, s33
s_add_u32 s95, s47, s32
v_mfma_f32_16x16x32_bf16 v[184:187], v[180:183], v[152:155], v[184:187]
s_cmp_ge_u32 s95, 147456
s_cselect_b32 s93, 147456, 0
s_sub_u32 s95, s95, s93
v_mfma_f32_16x16x32_bf16 v[188:191], v[180:183], v[156:159], v[188:191]
s_waitcnt lgkmcnt(4)
s_sub_u32 s95, s95, s33
v_mfma_f32_16x16x32_bf16 a[0:3], v[160:163], v[144:147], a[0:3]
ds_read_b64_tr_b16 v[172:173], v6 offset:24576
ds_read_b64_tr_b16 v[174:175], v6 offset:30720
v_mfma_f32_16x16x32_bf16 a[40:43], v[160:163], v[148:151], a[40:43]
v_add_u32 v24, s39, v1
v_add_u32 v25, s39, v2
v_mfma_f32_16x16x32_bf16 a[80:83], v[160:163], v[152:155], a[80:83]
v_add_u32_e64 v26, s95, v1
v_add_u32 v27, s95, v2
v_mfma_f32_16x16x32_bf16 a[120:123], v[160:163], v[156:159], a[120:123]
s_waitcnt lgkmcnt(4)
v_permlane16_swap_b32 v20, v176
v_permlane16_swap_b32 v184, v188
v_mfma_f32_16x16x32_bf16 a[4:7], v[164:167], v[144:147], a[4:7]
ds_read_b64_tr_b16 v[160:161], v3 offset:24704
ds_read_b64_tr_b16 v[162:163], v3 offset:30848
v_mfma_f32_16x16x32_bf16 a[44:47], v[164:167], v[148:151], a[44:47]
v_permlane32_swap_b32 v20, v184
v_accvgpr_read_b32 v64, a0
v_mfma_f32_16x16x32_bf16 a[84:87], v[164:167], v[152:155], a[84:87]
v_rcp_f32 v20, v20
v_mfma_f32_16x16x32_bf16 a[124:127], v[164:167], v[156:159], a[124:127]
s_waitcnt lgkmcnt(4)
v_mov_b32 v184, v20
v_accvgpr_read_b32 v65, a1
v_mfma_f32_16x16x32_bf16 a[8:11], v[168:171], v[144:147], a[8:11]
ds_read_b64_tr_b16 v[164:165], v4 offset:24704
ds_read_b64_tr_b16 v[166:167], v4 offset:30848
v_mfma_f32_16x16x32_bf16 a[48:51], v[168:171], v[148:151], a[48:51]
v_permlane32_swap_b32 v20, v184
v_mov_b32 v176, v20
v_mfma_f32_16x16x32_bf16 a[88:91], v[168:171], v[152:155], a[88:91]
v_mov_b32_e64 v188, v184
v_accvgpr_read_b32 v66, a2
v_mfma_f32_16x16x32_bf16 a[128:131], v[168:171], v[156:159], a[128:131]
s_waitcnt lgkmcnt(4)
v_permlane16_swap_b32 v20, v176
v_accvgpr_read_b32 v67, a3
v_mfma_f32_16x16x32_bf16 a[12:15], v[172:175], v[144:147], a[12:15]
ds_read_b64_tr_b16 v[168:169], v5 offset:24704
ds_read_b64_tr_b16 v[170:171], v5 offset:30848
v_mfma_f32_16x16x32_bf16 a[52:55], v[172:175], v[148:151], a[52:55]
v_permlane16_swap_b32 v184, v188
v_accvgpr_read_b32 v68, a4
v_mfma_f32_16x16x32_bf16 a[92:95], v[172:175], v[152:155], a[92:95]
v_accvgpr_read_b32 v69, a5
v_accvgpr_read_b32 v70, a6
v_mfma_f32_16x16x32_bf16 a[132:135], v[172:175], v[156:159], a[132:135]
s_waitcnt lgkmcnt(4)
v_accvgpr_read_b32 v71, a7
v_pk_mul_f32 v[64:65], v[64:65], v[20:21] op_sel_hi:[1,0]
v_mfma_f32_16x16x32_bf16 a[16:19], v[160:163], v[144:147], a[16:19]
ds_read_b64_tr_b16 v[172:173], v6 offset:24704
ds_read_b64_tr_b16 v[174:175], v6 offset:30848
v_mfma_f32_16x16x32_bf16 a[56:59], v[160:163], v[148:151], a[56:59]
v_pk_mul_f32 v[66:67], v[66:67], v[20:21] op_sel_hi:[1,0]
v_accvgpr_read_b32 v72, a8
v_mfma_f32_16x16x32_bf16 a[96:99], v[160:163], v[152:155], a[96:99]
v_accvgpr_read_b32 v73, a9
v_accvgpr_read_b32 v74, a10
v_mfma_f32_16x16x32_bf16 a[136:139], v[160:163], v[156:159], a[136:139]
s_waitcnt lgkmcnt(4)
v_accvgpr_read_b32 v75, a11
v_pk_mul_f32 v[68:69], v[68:69], v[20:21] op_sel_hi:[1,0]
v_mfma_f32_16x16x32_bf16 a[20:23], v[164:167], v[144:147], a[20:23]
ds_read_b64_tr_b16 v[160:161], v3 offset:24832
ds_read_b64_tr_b16 v[162:163], v3 offset:30976
v_mfma_f32_16x16x32_bf16 a[60:63], v[164:167], v[148:151], a[60:63]
v_pk_mul_f32 v[70:71], v[70:71], v[20:21] op_sel_hi:[1,0]
v_cvt_pk_bf16_f32 v128, v64, v65
v_mfma_f32_16x16x32_bf16 a[100:103], v[164:167], v[152:155], a[100:103]
s_waitcnt vmcnt(6)
s_barrier
v_mfma_f32_16x16x32_bf16 a[140:143], v[164:167], v[156:159], a[140:143]
s_waitcnt lgkmcnt(4)
ds_read_b128 a[160:163], v24 offset:0
v_cvt_pk_bf16_f32 v129, v66, v67
v_mfma_f32_16x16x32_bf16 a[24:27], v[168:171], v[144:147], a[24:27]
s_add_u32 m0, s36, 12288
ds_read_b64_tr_b16 v[164:165], v4 offset:24832
ds_read_b64_tr_b16 v[166:167], v4 offset:30976
v_mfma_f32_16x16x32_bf16 a[64:67], v[168:171], v[148:151], a[64:67]
s_mov_b32 s38, 0
ds_read_b128 a[164:167], v25 offset:0
v_accvgpr_read_b32 v76, a12
v_mfma_f32_16x16x32_bf16 a[104:107], v[168:171], v[152:155], a[104:107]
buffer_load_dwordx4 v10, s[20:23], s38 offen  lds
v_mfma_f32_16x16x32_bf16 a[144:147], v[168:171], v[156:159], a[144:147]
s_waitcnt lgkmcnt(6)
ds_read_b128 a[168:171], v24 offset:128
v_accvgpr_read_b32 v77, a13
v_mfma_f32_16x16x32_bf16 a[28:31], v[172:175], v[144:147], a[28:31]
ds_read_b64_tr_b16 v[168:169], v5 offset:24832
ds_read_b64_tr_b16 v[170:171], v5 offset:30976
v_mfma_f32_16x16x32_bf16 a[68:71], v[172:175], v[148:151], a[68:71]
ds_read_b128 a[172:175], v25 offset:128
v_accvgpr_read_b32 v78, a14
v_mfma_f32_16x16x32_bf16 a[108:111], v[172:175], v[152:155], a[108:111]
ds_read_b128 a[176:179], v24 offset:256
v_accvgpr_read_b32 v79, a15
v_mfma_f32_16x16x32_bf16 a[148:151], v[172:175], v[156:159], a[148:151]
s_waitcnt lgkmcnt(9)
ds_read_b128 a[180:183], v25 offset:256
v_pk_mul_f32 v[72:73], v[72:73], v[20:21] op_sel_hi:[1,0]
v_mfma_f32_16x16x32_bf16 a[32:35], v[160:163], v[144:147], a[32:35]
ds_read_b64_tr_b16 v[172:173], v6 offset:24832
ds_read_b64_tr_b16 v[174:175], v6 offset:30976
v_mfma_f32_16x16x32_bf16 a[72:75], v[160:163], v[148:151], a[72:75]
buffer_load_dwordx4 v11, s[20:23], s38 offen offset:1024  lds
v_mfma_f32_16x16x32_bf16 a[112:115], v[160:163], v[152:155], a[112:115]
ds_read_b128 a[184:187], v24 offset:6144
v_pk_mul_f32 v[74:75], v[74:75], v[20:21] op_sel_hi:[1,0]
v_mfma_f32_16x16x32_bf16 a[152:155], v[160:163], v[156:159], a[152:155]
s_waitcnt lgkmcnt(10)
ds_read_b128 a[188:191], v25 offset:6144
v_cvt_pk_bf16_f32 v130, v68, v69
v_mfma_f32_16x16x32_bf16 a[36:39], v[164:167], v[144:147], a[36:39]
ds_read_b128 a[192:195], v24 offset:6272
v_cvt_pk_bf16_f32 v131, v70, v71
v_mfma_f32_16x16x32_bf16 a[76:79], v[164:167], v[148:151], a[76:79]
ds_read_b128 a[196:199], v25 offset:6272
v_accvgpr_read_b32 v80, a40
v_mfma_f32_16x16x32_bf16 a[116:119], v[164:167], v[152:155], a[116:119]
buffer_load_dwordx4 v12, s[20:23], s38 offen offset:2048  lds
v_mfma_f32_16x16x32_bf16 a[156:159], v[164:167], v[156:159], a[156:159]
s_waitcnt lgkmcnt(9)
ds_read_b128 a[200:203], v24 offset:6400
v_accvgpr_read_b32 v81, a41
v_mfma_f32_16x16x32_bf16 v[32:35], v[168:171], v[144:147], v[32:35]
ds_read_b128 a[204:207], v25 offset:6400
v_accvgpr_read_b32 v82, a42
v_mfma_f32_16x16x32_bf16 v[40:43], v[168:171], v[148:151], v[40:43]
ds_read_b128 a[208:211], v26 offset:0
v_accvgpr_read_b32 v83, a43
v_mfma_f32_16x16x32_bf16 v[48:51], v[168:171], v[152:155], v[48:51]
ds_read_b128 a[212:215], v27 offset:0
v_pk_mul_f32 v[76:77], v[76:77], v[20:21] op_sel_hi:[1,0]
v_mfma_f32_16x16x32_bf16 v[56:59], v[168:171], v[156:159], v[56:59]
L_pad8:
s_cbranch_execz L_warm_next
s_waitcnt lgkmcnt(8)
ds_read_b128 a[216:219], v26 offset:128
v_pk_mul_f32 v[78:79], v[78:79], v[20:21] op_sel_hi:[1,0]
v_mfma_f32_16x16x32_bf16 v[36:39], v[172:175], v[144:147], v[36:39]
ds_read_b128 a[220:223], v27 offset:128
v_cvt_pk_bf16_f32 v132, v72, v73
v_mfma_f32_16x16x32_bf16 v[44:47], v[172:175], v[148:151], v[44:47]
v_cvt_pk_bf16_f32 v133, v74, v75
v_accvgpr_read_b32 v84, a44
v_mfma_f32_16x16x32_bf16 v[52:55], v[172:175], v[152:155], v[52:55]
v_accvgpr_read_b32 v85, a45
v_accvgpr_read_b32 v86, a46
v_mfma_f32_16x16x32_bf16 v[60:63], v[172:175], v[156:159], v[60:63]
v_accvgpr_read_b32 v87, a47
v_pk_mul_f32 v[80:81], v[80:81], v[176:177] op_sel_hi:[1,0]
s_cmp_eq_u32 s30, 3
s_cbranch_scc1 L_final
s_nop 0
v_pk_mul_f32 v[82:83], v[82:83], v[176:177] op_sel_hi:[1,0]
v_cvt_pk_bf16_f32 v134, v76, v77
ds_read_b128 a[224:227], v26 offset:256
v_cvt_pk_bf16_f32 v135, v78, v79
v_accvgpr_read_b32 v88, a48
v_accvgpr_read_b32 v89, a49
v_accvgpr_read_b32 v90, a50
v_accvgpr_read_b32 v91, a51
ds_read_b128 a[228:231], v27 offset:256
ds_write_b64 v15, v[128:129] offset:0
v_pk_mul_f32 v[84:85], v[84:85], v[176:177] op_sel_hi:[1,0]
v_pk_mul_f32 v[86:87], v[86:87], v[176:177] op_sel_hi:[1,0]
v_cvt_pk_bf16_f32 v136, v80, v81
v_cvt_pk_bf16_f32 v137, v82, v83
v_accvgpr_read_b32 v92, a52
ds_read_b128 a[232:235], v26 offset:6144
v_accvgpr_read_b32 v93, a53
v_accvgpr_read_b32 v94, a54
v_accvgpr_read_b32 v95, a55
v_xor_b32_e64 v31, 32, v15
ds_write_b64 v31, v[130:131] offset:0
v_pk_mul_f32 v[88:89], v[88:89], v[176:177] op_sel_hi:[1,0]
v_pk_mul_f32 v[90:91], v[90:91], v[176:177] op_sel_hi:[1,0]
ds_read_b128 a[236:239], v27 offset:6144
v_cvt_pk_bf16_f32 v138, v84, v85
v_cvt_pk_bf16_f32 v139, v86, v87
v_pk_mul_f32 v[92:93], v[92:93], v[176:177] op_sel_hi:[1,0]
v_pk_mul_f32 v[94:95], v[94:95], v[176:177] op_sel_hi:[1,0]
v_cvt_pk_bf16_f32 v140, v88, v89
ds_read_b128 a[240:243], v26 offset:6272
v_cvt_pk_bf16_f32 v141, v90, v91
v_xor_b32_e64 v31, 64, v15
ds_write_b64 v31, v[132:133] offset:0
v_cvt_pk_bf16_f32 v142, v92, v93
v_cvt_pk_bf16_f32 v143, v94, v95
v_accvgpr_read_b32 v96, a80
v_accvgpr_read_b32 v97, a81
ds_read_b128 a[244:247], v27 offset:6272
v_accvgpr_read_b32 v98, a82
v_accvgpr_read_b32 v99, a83
v_accvgpr_read_b32 v100, a84
v_accvgpr_read_b32 v101, a85
v_xor_b32 v31, 96, v15
ds_write_b64 v31, v[134:135] offset:0
v_accvgpr_read_b32 v102, a86
ds_read_b128 a[248:251], v26 offset:6400
v_accvgpr_read_b32 v103, a87
v_pk_mul_f32 v[96:97], v[96:97], v[184:185] op_sel_hi:[1,0]
v_pk_mul_f32 v[98:99], v[98:99], v[184:185] op_sel_hi:[1,0]
v_accvgpr_read_b32 v104, a88
v_accvgpr_read_b32 v105, a89
ds_read_b128 a[252:255], v27 offset:6400
v_accvgpr_read_b32 v106, a90
v_accvgpr_read_b32 v107, a91
ds_write_b64 v15, v[136:137] offset:2048
v_pk_mul_f32 v[100:101], v[100:101], v[184:185] op_sel_hi:[1,0]
v_pk_mul_f32 v[102:103], v[102:103], v[184:185] op_sel_hi:[1,0]
v_cvt_pk_bf16_f32 v208, v96, v97
v_cvt_pk_bf16_f32 v209, v98, v99
v_accvgpr_read_b32 v108, a92
v_accvgpr_read_b32 v109, a93
v_accvgpr_read_b32 v110, a94
v_accvgpr_read_b32 v111, a95
v_xor_b32_e64 v31, 32, v15
ds_write_b64 v31, v[138:139] offset:2048
v_pk_mul_f32 v[104:105], v[104:105], v[184:185] op_sel_hi:[1,0]
v_pk_mul_f32 v[106:107], v[106:107], v[184:185] op_sel_hi:[1,0]
v_cvt_pk_bf16_f32 v210, v100, v101
v_cvt_pk_bf16_f32 v211, v102, v103
v_accvgpr_read_b32 v112, a120
v_accvgpr_read_b32 v113, a121
v_accvgpr_read_b32 v114, a122
v_accvgpr_read_b32 v115, a123
v_xor_b32_e64 v31, 64, v15
ds_write_b64 v31, v[140:141] offset:2048
v_pk_mul_f32 v[108:109], v[108:109], v[184:185] op_sel_hi:[1,0]
v_pk_mul_f32 v[110:111], v[110:111], v[184:185] op_sel_hi:[1,0]
v_cvt_pk_bf16_f32 v212, v104, v105
v_cvt_pk_bf16_f32 v213, v106, v107
v_accvgpr_read_b32 v116, a124
v_accvgpr_read_b32 v117, a125
v_accvgpr_read_b32 v118, a126
s_add_u32 s24, s10, s31
s_addc_u32 s25, s11, 0
s_mov_b32 s26, 98304
s_waitcnt lgkmcnt(0)
s_barrier
v_accvgpr_read_b32 v119, a127
v_xor_b32 v31, 96, v15
ds_write_b64 v31, v[142:143] offset:2048
v_pk_mul_f32 v[112:113], v[112:113], v[188:189] op_sel_hi:[1,0]
v_pk_mul_f32 v[114:115], v[114:115], v[188:189] op_sel_hi:[1,0]
v_cvt_pk_bf16_f32 v214, v108, v109
v_cvt_pk_bf16_f32 v215, v110, v111
v_accvgpr_read_b32 v120, a128
v_accvgpr_read_b32 v121, a129
v_accvgpr_read_b32 v122, a130
s_add_u32 m0, s36, 24576
s_mov_b32 s38, 24576
buffer_load_dwordx4 v7, s[16:19], s38 offen  lds
v_accvgpr_read_b32 v123, a131
v_pk_mul_f32 v[116:117], v[116:117], v[188:189] op_sel_hi:[1,0]
v_pk_mul_f32 v[118:119], v[118:119], v[188:189] op_sel_hi:[1,0]
v_cvt_pk_bf16_f32 v216, v112, v113
v_cvt_pk_bf16_f32 v217, v114, v115
v_accvgpr_read_b32 v124, a132
v_accvgpr_read_b32 v125, a133
v_accvgpr_read_b32 v126, a134
v_accvgpr_read_b32 v127, a135
v_pk_mul_f32 v[120:121], v[120:121], v[188:189] op_sel_hi:[1,0]
v_pk_mul_f32 v[122:123], v[122:123], v[188:189] op_sel_hi:[1,0]
v_cvt_pk_bf16_f32 v218, v116, v117
v_cvt_pk_bf16_f32 v219, v118, v119
v_pk_mul_f32 v[124:125], v[124:125], v[188:189] op_sel_hi:[1,0]
v_pk_mul_f32 v[126:127], v[126:127], v[188:189] op_sel_hi:[1,0]
v_cvt_pk_bf16_f32 v220, v120, v121
v_cvt_pk_bf16_f32 v221, v122, v123
v_cvt_pk_bf16_f32 v222, v124, v125
v_cvt_pk_bf16_f32 v223, v126, v127
v_accvgpr_read_b32 v64, a16
v_accvgpr_read_b32 v65, a17
v_accvgpr_read_b32 v66, a18
v_accvgpr_read_b32 v67, a19
v_accvgpr_read_b32 v68, a20
v_accvgpr_read_b32 v69, a21
v_accvgpr_read_b32 v70, a22
v_accvgpr_read_b32 v71, a23
v_pk_mul_f32 v[64:65], v[64:65], v[20:21] op_sel_hi:[1,0]
v_pk_mul_f32 v[66:67], v[66:67], v[20:21] op_sel_hi:[1,0]
v_accvgpr_read_b32 v72, a24
buffer_load_dwordx4 v8, s[16:19], s38 offen offset:1024  lds
v_accvgpr_read_b32 v73, a25
v_accvgpr_read_b32 v74, a26
v_accvgpr_read_b32 v75, a27
v_pk_mul_f32 v[68:69], v[68:69], v[20:21] op_sel_hi:[1,0]
v_pk_mul_f32 v[70:71], v[70:71], v[20:21] op_sel_hi:[1,0]
v_cvt_pk_bf16_f32 v144, v64, v65
v_cvt_pk_bf16_f32 v145, v66, v67
v_accvgpr_read_b32 v76, a28
v_accvgpr_read_b32 v77, a29
v_accvgpr_read_b32 v78, a30
v_accvgpr_read_b32 v79, a31
v_pk_mul_f32 v[72:73], v[72:73], v[20:21] op_sel_hi:[1,0]
v_pk_mul_f32 v[74:75], v[74:75], v[20:21] op_sel_hi:[1,0]
v_cvt_pk_bf16_f32 v146, v68, v69
v_cvt_pk_bf16_f32 v147, v70, v71
v_accvgpr_read_b32 v80, a56
v_accvgpr_read_b32 v81, a57
v_accvgpr_read_b32 v82, a58
v_accvgpr_read_b32 v83, a59
v_pk_mul_f32 v[76:77], v[76:77], v[20:21] op_sel_hi:[1,0]
v_pk_mul_f32 v[78:79], v[78:79], v[20:21] op_sel_hi:[1,0]
v_cvt_pk_bf16_f32 v148, v72, v73
v_cvt_pk_bf16_f32 v149, v74, v75
v_accvgpr_read_b32 v84, a60
v_accvgpr_read_b32 v85, a61
v_accvgpr_read_b32 v86, a62
v_accvgpr_read_b32 v87, a63
v_pk_mul_f32 v[80:81], v[80:81], v[176:177] op_sel_hi:[1,0]
v_pk_mul_f32 v[82:83], v[82:83], v[176:177] op_sel_hi:[1,0]
v_cvt_pk_bf16_f32 v150, v76, v77
buffer_load_dwordx4 v9, s[16:19], s38 offen offset:2048  lds
v_cvt_pk_bf16_f32 v151, v78, v79
v_accvgpr_read_b32 v88, a64
v_accvgpr_read_b32 v89, a65
v_accvgpr_read_b32 v90, a66
v_accvgpr_read_b32 v91, a67
v_pk_mul_f32 v[84:85], v[84:85], v[176:177] op_sel_hi:[1,0]
v_pk_mul_f32 v[86:87], v[86:87], v[176:177] op_sel_hi:[1,0]
v_cvt_pk_bf16_f32 v152, v80, v81
v_cvt_pk_bf16_f32 v153, v82, v83
v_accvgpr_read_b32 v92, a68
v_accvgpr_read_b32 v93, a69
v_accvgpr_read_b32 v94, a70
v_accvgpr_read_b32 v95, a71
v_pk_mul_f32 v[88:89], v[88:89], v[176:177] op_sel_hi:[1,0]
v_pk_mul_f32 v[90:91], v[90:91], v[176:177] op_sel_hi:[1,0]
v_cvt_pk_bf16_f32 v154, v84, v85
v_cvt_pk_bf16_f32 v155, v86, v87
v_pk_mul_f32 v[92:93], v[92:93], v[176:177] op_sel_hi:[1,0]
v_pk_mul_f32 v[94:95], v[94:95], v[176:177] op_sel_hi:[1,0]
v_cvt_pk_bf16_f32 v156, v88, v89
v_cvt_pk_bf16_f32 v157, v90, v91
v_cvt_pk_bf16_f32 v158, v92, v93
v_cvt_pk_bf16_f32 v159, v94, v95
v_accvgpr_read_b32 v96, a96
v_accvgpr_read_b32 v97, a97
v_accvgpr_read_b32 v98, a98
v_accvgpr_read_b32 v99, a99
v_accvgpr_read_b32 v100, a100
v_accvgpr_read_b32 v101, a101
v_accvgpr_read_b32 v102, a102
s_add_u32 m0, s36, 36864
s_mov_b32 s38, 12288
buffer_load_dwordx4 v10, s[20:23], s38 offen  lds
v_accvgpr_read_b32 v103, a103
v_pk_mul_f32 v[96:97], v[96:97], v[184:185] op_sel_hi:[1,0]
v_pk_mul_f32 v[98:99], v[98:99], v[184:185] op_sel_hi:[1,0]
v_accvgpr_read_b32 v104, a104
v_accvgpr_read_b32 v105, a105
v_accvgpr_read_b32 v106, a106
v_accvgpr_read_b32 v107, a107
v_pk_mul_f32 v[100:101], v[100:101], v[184:185] op_sel_hi:[1,0]
v_pk_mul_f32 v[102:103], v[102:103], v[184:185] op_sel_hi:[1,0]
v_cvt_pk_bf16_f32 v224, v96, v97
v_cvt_pk_bf16_f32 v225, v98, v99
v_accvgpr_read_b32 v108, a108
v_accvgpr_read_b32 v109, a109
v_accvgpr_read_b32 v110, a110
v_accvgpr_read_b32 v111, a111
v_pk_mul_f32 v[104:105], v[104:105], v[184:185] op_sel_hi:[1,0]
v_pk_mul_f32 v[106:107], v[106:107], v[184:185] op_sel_hi:[1,0]
v_cvt_pk_bf16_f32 v226, v100, v101
v_cvt_pk_bf16_f32 v227, v102, v103
v_accvgpr_read_b32 v112, a136
v_accvgpr_read_b32 v113, a137
v_accvgpr_read_b32 v114, a138
v_accvgpr_read_b32 v115, a139
v_pk_mul_f32 v[108:109], v[108:109], v[184:185] op_sel_hi:[1,0]
v_pk_mul_f32 v[110:111], v[110:111], v[184:185] op_sel_hi:[1,0]
v_cvt_pk_bf16_f32 v228, v104, v105
v_cvt_pk_bf16_f32 v229, v106, v107
v_accvgpr_read_b32 v116, a140
v_accvgpr_read_b32 v117, a141
v_accvgpr_read_b32 v118, a142
buffer_load_dwordx4 v11, s[20:23], s38 offen offset:1024  lds
v_accvgpr_read_b32 v119, a143
v_pk_mul_f32 v[112:113], v[112:113], v[188:189] op_sel_hi:[1,0]
v_pk_mul_f32 v[114:115], v[114:115], v[188:189] op_sel_hi:[1,0]
v_cvt_pk_bf16_f32 v230, v108, v109
v_cvt_pk_bf16_f32 v231, v110, v111
v_accvgpr_read_b32 v120, a144
v_accvgpr_read_b32 v121, a145
v_accvgpr_read_b32 v122, a146
v_accvgpr_read_b32 v123, a147
v_pk_mul_f32 v[116:117], v[116:117], v[188:189] op_sel_hi:[1,0]
v_pk_mul_f32 v[118:119], v[118:119], v[188:189] op_sel_hi:[1,0]
v_cvt_pk_bf16_f32 v232, v112, v113
v_cvt_pk_bf16_f32 v233, v114, v115
v_accvgpr_read_b32 v124, a148
v_accvgpr_read_b32 v125, a149
v_accvgpr_read_b32 v126, a150
v_accvgpr_read_b32 v127, a151
v_pk_mul_f32 v[120:121], v[120:121], v[188:189] op_sel_hi:[1,0]
v_pk_mul_f32 v[122:123], v[122:123], v[188:189] op_sel_hi:[1,0]
v_cvt_pk_bf16_f32 v234, v116, v117
v_cvt_pk_bf16_f32 v235, v118, v119
v_pk_mul_f32 v[124:125], v[124:125], v[188:189] op_sel_hi:[1,0]
v_pk_mul_f32 v[126:127], v[126:127], v[188:189] op_sel_hi:[1,0]
v_cvt_pk_bf16_f32 v236, v120, v121
v_cvt_pk_bf16_f32 v237, v122, v123
v_cvt_pk_bf16_f32 v238, v124, v125
v_cvt_pk_bf16_f32 v239, v126, v127
v_accvgpr_read_b32 v64, a32
v_accvgpr_read_b32 v65, a33
v_accvgpr_read_b32 v66, a34
buffer_load_dwordx4 v12, s[20:23], s38 offen offset:2048  lds
v_accvgpr_read_b32 v67, a35
v_accvgpr_read_b32 v68, a36
v_accvgpr_read_b32 v69, a37
v_accvgpr_read_b32 v70, a38
v_accvgpr_read_b32 v71, a39
v_pk_mul_f32 v[64:65], v[64:65], v[20:21] op_sel_hi:[1,0]
v_pk_mul_f32 v[66:67], v[66:67], v[20:21] op_sel_hi:[1,0]
v_pk_mul_f32 v[68:69], v[68:69], v[20:21] op_sel_hi:[1,0]
v_pk_mul_f32 v[70:71], v[70:71], v[20:21] op_sel_hi:[1,0]
v_cvt_pk_bf16_f32 v192, v64, v65
v_cvt_pk_bf16_f32 v193, v66, v67
v_pk_mul_f32 v[32:33], v[32:33], v[20:21] op_sel_hi:[1,0]
v_pk_mul_f32 v[34:35], v[34:35], v[20:21] op_sel_hi:[1,0]
v_cvt_pk_bf16_f32 v194, v68, v69
v_cvt_pk_bf16_f32 v195, v70, v71
v_accvgpr_read_b32 v80, a72
v_accvgpr_read_b32 v81, a73
v_accvgpr_read_b32 v82, a74
v_accvgpr_read_b32 v83, a75
v_pk_mul_f32 v[36:37], v[36:37], v[20:21] op_sel_hi:[1,0]
v_pk_mul_f32 v[38:39], v[38:39], v[20:21] op_sel_hi:[1,0]
v_cvt_pk_bf16_f32 v196, v32, v33
v_cvt_pk_bf16_f32 v197, v34, v35
v_accvgpr_read_b32 v84, a76
v_accvgpr_read_b32 v85, a77
v_accvgpr_read_b32 v86, a78
v_accvgpr_read_b32 v87, a79
v_pk_mul_f32 v[80:81], v[80:81], v[176:177] op_sel_hi:[1,0]
v_pk_mul_f32 v[82:83], v[82:83], v[176:177] op_sel_hi:[1,0]
v_cvt_pk_bf16_f32 v198, v36, v37
v_cvt_pk_bf16_f32 v199, v38, v39
v_pk_mul_f32 v[84:85], v[84:85], v[176:177] op_sel_hi:[1,0]
v_pk_mul_f32 v[86:87], v[86:87], v[176:177] op_sel_hi:[1,0]
v_cvt_pk_bf16_f32 v200, v80, v81
v_cvt_pk_bf16_f32 v201, v82, v83
v_pk_mul_f32 v[40:41], v[40:41], v[176:177] op_sel_hi:[1,0]
v_pk_mul_f32 v[42:43], v[42:43], v[176:177] op_sel_hi:[1,0]
v_cvt_pk_bf16_f32 v202, v84, v85
v_cvt_pk_bf16_f32 v203, v86, v87
v_pk_mul_f32 v[44:45], v[44:45], v[176:177] op_sel_hi:[1,0]
v_pk_mul_f32 v[46:47], v[46:47], v[176:177] op_sel_hi:[1,0]
v_cvt_pk_bf16_f32 v204, v40, v41
v_cvt_pk_bf16_f32 v205, v42, v43
v_cvt_pk_bf16_f32 v206, v44, v45
v_cvt_pk_bf16_f32 v207, v46, v47
v_accvgpr_read_b32 v96, a112
v_accvgpr_read_b32 v97, a113
v_accvgpr_read_b32 v98, a114
v_accvgpr_read_b32 v99, a115
v_accvgpr_read_b32 v100, a116
v_accvgpr_read_b32 v101, a117
v_accvgpr_read_b32 v102, a118
v_accvgpr_read_b32 v103, a119
v_pk_mul_f32 v[96:97], v[96:97], v[184:185] op_sel_hi:[1,0]
v_pk_mul_f32 v[98:99], v[98:99], v[184:185] op_sel_hi:[1,0]
v_pk_mul_f32 v[100:101], v[100:101], v[184:185] op_sel_hi:[1,0]
v_pk_mul_f32 v[102:103], v[102:103], v[184:185] op_sel_hi:[1,0]
v_cvt_pk_bf16_f32 v240, v96, v97
v_cvt_pk_bf16_f32 v241, v98, v99
v_pk_mul_f32 v[48:49], v[48:49], v[184:185] op_sel_hi:[1,0]
v_pk_mul_f32 v[50:51], v[50:51], v[184:185] op_sel_hi:[1,0]
v_cvt_pk_bf16_f32 v242, v100, v101
v_cvt_pk_bf16_f32 v243, v102, v103
v_accvgpr_read_b32 v112, a152
v_accvgpr_read_b32 v113, a153
v_accvgpr_read_b32 v114, a154
v_accvgpr_read_b32 v115, a155
v_pk_mul_f32 v[52:53], v[52:53], v[184:185] op_sel_hi:[1,0]
v_pk_mul_f32 v[54:55], v[54:55], v[184:185] op_sel_hi:[1,0]
v_cvt_pk_bf16_f32 v244, v48, v49
v_cvt_pk_bf16_f32 v245, v50, v51
v_accvgpr_read_b32 v116, a156
v_accvgpr_read_b32 v117, a157
v_accvgpr_read_b32 v118, a158
v_accvgpr_read_b32 v119, a159
v_pk_mul_f32 v[112:113], v[112:113], v[188:189] op_sel_hi:[1,0]
v_pk_mul_f32 v[114:115], v[114:115], v[188:189] op_sel_hi:[1,0]
v_cvt_pk_bf16_f32 v246, v52, v53
v_cvt_pk_bf16_f32 v247, v54, v55
v_pk_mul_f32 v[116:117], v[116:117], v[188:189] op_sel_hi:[1,0]
v_pk_mul_f32 v[118:119], v[118:119], v[188:189] op_sel_hi:[1,0]
v_cvt_pk_bf16_f32 v248, v112, v113
v_cvt_pk_bf16_f32 v249, v114, v115
v_pk_mul_f32 v[56:57], v[56:57], v[188:189] op_sel_hi:[1,0]
v_pk_mul_f32 v[58:59], v[58:59], v[188:189] op_sel_hi:[1,0]
v_cvt_pk_bf16_f32 v250, v116, v117
v_cvt_pk_bf16_f32 v251, v118, v119
v_pk_mul_f32 v[60:61], v[60:61], v[188:189] op_sel_hi:[1,0]
v_pk_mul_f32 v[62:63], v[62:63], v[188:189] op_sel_hi:[1,0]
v_cvt_pk_bf16_f32 v252, v56, v57
v_cvt_pk_bf16_f32 v253, v58, v59
v_cvt_pk_bf16_f32 v254, v60, v61
v_cvt_pk_bf16_f32 v255, v62, v63
s_mov_b32 s39, s32
s_mov_b32 s32, s33
s_mov_b32 s33, s34
s_mov_b32 s34, s39
s_mov_b32 s39, s35
s_mov_b32 s35, s36
s_mov_b32 s36, s37
s_mov_b32 s37, s39
s_add_u32 s31, s31, 25165824
s_add_u32 s30, s30, 1
s_branch L_item
L_final:
s_add_u32 s24, s10, s31
s_addc_u32 s25, s11, 0
s_mov_b32 s26, 98304
v_pk_mul_f32 v[82:83], v[82:83], v[176:177] op_sel_hi:[1,0]
v_cvt_pk_bf16_f32 v134, v76, v77
v_cvt_pk_bf16_f32 v135, v78, v79
v_accvgpr_read_b32 v88, a48
v_accvgpr_read_b32 v89, a49
v_accvgpr_read_b32 v90, a50
ds_write_b64 v15, v[128:129] offset:0
v_accvgpr_read_b32 v91, a51
v_pk_mul_f32 v[84:85], v[84:85], v[176:177] op_sel_hi:[1,0]
v_pk_mul_f32 v[86:87], v[86:87], v[176:177] op_sel_hi:[1,0]
v_cvt_pk_bf16_f32 v136, v80, v81
v_cvt_pk_bf16_f32 v137, v82, v83
v_accvgpr_read_b32 v92, a52
v_xor_b32_e64 v31, 32, v15
ds_write_b64 v31, v[130:131] offset:0
v_accvgpr_read_b32 v93, a53
v_accvgpr_read_b32 v94, a54
v_accvgpr_read_b32 v95, a55
v_pk_mul_f32 v[88:89], v[88:89], v[176:177] op_sel_hi:[1,0]
v_pk_mul_f32 v[90:91], v[90:91], v[176:177] op_sel_hi:[1,0]
v_cvt_pk_bf16_f32 v138, v84, v85
v_xor_b32_e64 v31, 64, v15
ds_write_b64 v31, v[132:133] offset:0
v_cvt_pk_bf16_f32 v139, v86, v87
v_pk_mul_f32 v[92:93], v[92:93], v[176:177] op_sel_hi:[1,0]
v_pk_mul_f32 v[94:95], v[94:95], v[176:177] op_sel_hi:[1,0]
v_cvt_pk_bf16_f32 v140, v88, v89
v_cvt_pk_bf16_f32 v141, v90, v91
v_cvt_pk_bf16_f32 v142, v92, v93
v_xor_b32 v31, 96, v15
ds_write_b64 v31, v[134:135] offset:0
v_cvt_pk_bf16_f32 v143, v94, v95
v_accvgpr_read_b32 v96, a80
v_accvgpr_read_b32 v97, a81
v_accvgpr_read_b32 v98, a82
v_accvgpr_read_b32 v99, a83
v_accvgpr_read_b32 v100, a84
ds_write_b64 v15, v[136:137] offset:2048
v_accvgpr_read_b32 v101, a85
v_accvgpr_read_b32 v102, a86
v_accvgpr_read_b32 v103, a87
v_pk_mul_f32 v[96:97], v[96:97], v[184:185] op_sel_hi:[1,0]
v_pk_mul_f32 v[98:99], v[98:99], v[184:185] op_sel_hi:[1,0]
v_accvgpr_read_b32 v104, a88
v_xor_b32_e64 v31, 32, v15
ds_write_b64 v31, v[138:139] offset:2048
v_accvgpr_read_b32 v105, a89
v_accvgpr_read_b32 v106, a90
v_accvgpr_read_b32 v107, a91
v_pk_mul_f32 v[100:101], v[100:101], v[184:185] op_sel_hi:[1,0]
v_pk_mul_f32 v[102:103], v[102:103], v[184:185] op_sel_hi:[1,0]
v_cvt_pk_bf16_f32 v208, v96, v97
v_xor_b32_e64 v31, 64, v15
ds_write_b64 v31, v[140:141] offset:2048
v_cvt_pk_bf16_f32 v209, v98, v99
v_accvgpr_read_b32 v108, a92
v_accvgpr_read_b32 v109, a93
v_accvgpr_read_b32 v110, a94
v_accvgpr_read_b32 v111, a95
v_pk_mul_f32 v[104:105], v[104:105], v[184:185] op_sel_hi:[1,0]
v_xor_b32 v31, 96, v15
ds_write_b64 v31, v[142:143] offset:2048
v_pk_mul_f32 v[106:107], v[106:107], v[184:185] op_sel_hi:[1,0]
v_cvt_pk_bf16_f32 v210, v100, v101
ds_read_b128 v[128:131], v13 offset:0
v_cvt_pk_bf16_f32 v211, v102, v103
v_accvgpr_read_b32 v112, a120
ds_read_b128 v[132:135], v13 offset:1024
v_accvgpr_read_b32 v113, a121
v_accvgpr_read_b32 v114, a122
ds_read_b128 v[136:139], v13 offset:2048
v_accvgpr_read_b32 v115, a123
v_pk_mul_f32 v[108:109], v[108:109], v[184:185] op_sel_hi:[1,0]
ds_read_b128 v[140:143], v13 offset:3072
v_pk_mul_f32 v[110:111], v[110:111], v[184:185] op_sel_hi:[1,0]
v_cvt_pk_bf16_f32 v212, v104, v105
v_cvt_pk_bf16_f32 v213, v106, v107
v_accvgpr_read_b32 v116, a124
v_accvgpr_read_b32 v117, a125
v_accvgpr_read_b32 v118, a126
ds_write_b64 v15, v[208:209] offset:0
v_accvgpr_read_b32 v119, a127
v_pk_mul_f32 v[112:113], v[112:113], v[188:189] op_sel_hi:[1,0]
v_pk_mul_f32 v[114:115], v[114:115], v[188:189] op_sel_hi:[1,0]
v_cvt_pk_bf16_f32 v214, v108, v109
s_mov_b32 s50, 0
s_waitcnt lgkmcnt(4)
buffer_store_dwordx4 v[128:131], v14, s[24:27], s50 offen sc1 nt
v_cvt_pk_bf16_f32 v215, v110, v111
v_accvgpr_read_b32 v120, a128
v_xor_b32_e64 v31, 32, v15
ds_write_b64 v31, v[210:211] offset:0
v_accvgpr_read_b32 v121, a129
v_accvgpr_read_b32 v122, a130
v_accvgpr_read_b32 v123, a131
s_mov_b32 s50, 3072
s_waitcnt lgkmcnt(4)
buffer_store_dwordx4 v[132:135], v14, s[24:27], s50 offen sc1 nt
v_pk_mul_f32 v[116:117], v[116:117], v[188:189] op_sel_hi:[1,0]
v_pk_mul_f32 v[118:119], v[118:119], v[188:189] op_sel_hi:[1,0]
v_cvt_pk_bf16_f32 v216, v112, v113
v_xor_b32 v31, 64, v15
ds_write_b64 v31, v[212:213] offset:0
v_cvt_pk_bf16_f32 v217, v114, v115
v_accvgpr_read_b32 v124, a132
s_mov_b32 s50, 6144
s_waitcnt lgkmcnt(4)
buffer_store_dwordx4 v[136:139], v14, s[24:27], s50 offen sc1 nt
v_accvgpr_read_b32 v125, a133
v_accvgpr_read_b32 v126, a134
v_accvgpr_read_b32 v127, a135
v_pk_mul_f32 v[120:121], v[120:121], v[188:189] op_sel_hi:[1,0]
v_xor_b32 v31, 96, v15
ds_write_b64 v31, v[214:215] offset:0
v_pk_mul_f32 v[122:123], v[122:123], v[188:189] op_sel_hi:[1,0]
s_mov_b32 s50, 9216
s_waitcnt lgkmcnt(4)
buffer_store_dwordx4 v[140:143], v14, s[24:27], s50 offen sc1 nt
v_cvt_pk_bf16_f32 v218, v116, v117
v_cvt_pk_bf16_f32 v219, v118, v119
v_pk_mul_f32 v[124:125], v[124:125], v[188:189] op_sel_hi:[1,0]
v_pk_mul_f32 v[126:127], v[126:127], v[188:189] op_sel_hi:[1,0]
v_cvt_pk_bf16_f32 v220, v120, v121
ds_write_b64 v15, v[216:217] offset:2048
v_cvt_pk_bf16_f32 v221, v122, v123
v_cvt_pk_bf16_f32 v222, v124, v125
v_cvt_pk_bf16_f32 v223, v126, v127
v_accvgpr_read_b32 v64, a16
v_accvgpr_read_b32 v65, a17
v_accvgpr_read_b32 v66, a18
v_xor_b32_e64 v31, 32, v15
ds_write_b64 v31, v[218:219] offset:2048
v_accvgpr_read_b32 v67, a19
v_accvgpr_read_b32 v68, a20
v_accvgpr_read_b32 v69, a21
v_accvgpr_read_b32 v70, a22
v_accvgpr_read_b32 v71, a23
v_pk_mul_f32 v[64:65], v[64:65], v[20:21] op_sel_hi:[1,0]
v_xor_b32_e64 v31, 64, v15
ds_write_b64 v31, v[220:221] offset:2048
L_pad9:
s_cbranch_execz L_warm_next
s_nop 0
v_pk_mul_f32 v[66:67], v[66:67], v[20:21] op_sel_hi:[1,0]
v_accvgpr_read_b32 v72, a24
v_accvgpr_read_b32 v73, a25
v_accvgpr_read_b32 v74, a26
v_accvgpr_read_b32 v75, a27
v_pk_mul_f32 v[68:69], v[68:69], v[20:21] op_sel_hi:[1,0]
v_xor_b32 v31, 96, v15
ds_write_b64 v31, v[222:223] offset:2048
v_pk_mul_f32 v[70:71], v[70:71], v[20:21] op_sel_hi:[1,0]
v_cvt_pk_bf16_f32 v144, v64, v65
ds_read_b128 v[208:211], v13 offset:0
v_cvt_pk_bf16_f32 v145, v66, v67
v_accvgpr_read_b32 v76, a28
ds_read_b128 v[212:215], v13 offset:1024
v_accvgpr_read_b32 v77, a29
v_accvgpr_read_b32 v78, a30
ds_read_b128 v[216:219], v13 offset:2048
v_accvgpr_read_b32 v79, a31
v_pk_mul_f32 v[72:73], v[72:73], v[20:21] op_sel_hi:[1,0]
ds_read_b128 v[220:223], v13 offset:3072
v_pk_mul_f32 v[74:75], v[74:75], v[20:21] op_sel_hi:[1,0]
v_cvt_pk_bf16_f32 v146, v68, v69
v_cvt_pk_bf16_f32 v147, v70, v71
v_accvgpr_read_b32 v80, a56
v_accvgpr_read_b32 v81, a57
v_accvgpr_read_b32 v82, a58
ds_write_b64 v15, v[144:145] offset:0
v_accvgpr_read_b32 v83, a59
v_pk_mul_f32 v[76:77], v[76:77], v[20:21] op_sel_hi:[1,0]
v_pk_mul_f32 v[78:79], v[78:79], v[20:21] op_sel_hi:[1,0]
v_cvt_pk_bf16_f32 v148, v72, v73
s_mov_b32 s50, 12288
s_waitcnt lgkmcnt(4)
buffer_store_dwordx4 v[208:211], v14, s[24:27], s50 offen sc1 nt
v_cvt_pk_bf16_f32 v149, v74, v75
v_accvgpr_read_b32 v84, a60
v_xor_b32 v31, 32, v15
ds_write_b64 v31, v[146:147] offset:0
v_accvgpr_read_b32 v85, a61
v_accvgpr_read_b32 v86, a62
v_accvgpr_read_b32 v87, a63
s_mov_b32 s50, 15360
s_waitcnt lgkmcnt(4)
buffer_store_dwordx4 v[212:215], v14, s[24:27], s50 offen sc1 nt
v_pk_mul_f32 v[80:81], v[80:81], v[176:177] op_sel_hi:[1,0]
v_pk_mul_f32 v[82:83], v[82:83], v[176:177] op_sel_hi:[1,0]
v_cvt_pk_bf16_f32 v150, v76, v77
v_xor_b32 v31, 64, v15
ds_write_b64 v31, v[148:149] offset:0
v_cvt_pk_bf16_f32 v151, v78, v79
v_accvgpr_read_b32 v88, a64
s_mov_b32 s50, 18432
s_waitcnt lgkmcnt(4)
buffer_store_dwordx4 v[216:219], v14, s[24:27], s50 offen sc1 nt
v_accvgpr_read_b32 v89, a65
v_accvgpr_read_b32 v90, a66
v_accvgpr_read_b32 v91, a67
v_pk_mul_f32 v[84:85], v[84:85], v[176:177] op_sel_hi:[1,0]
v_xor_b32 v31, 96, v15
ds_write_b64 v31, v[150:151] offset:0
v_pk_mul_f32 v[86:87], v[86:87], v[176:177] op_sel_hi:[1,0]
s_mov_b32 s50, 21504
s_waitcnt lgkmcnt(4)
buffer_store_dwordx4 v[220:223], v14, s[24:27], s50 offen sc1 nt
v_cvt_pk_bf16_f32 v152, v80, v81
v_cvt_pk_bf16_f32 v153, v82, v83
v_accvgpr_read_b32 v92, a68
v_accvgpr_read_b32 v93, a69
v_accvgpr_read_b32 v94, a70
ds_write_b64 v15, v[152:153] offset:2048
v_accvgpr_read_b32 v95, a71
v_pk_mul_f32 v[88:89], v[88:89], v[176:177] op_sel_hi:[1,0]
v_pk_mul_f32 v[90:91], v[90:91], v[176:177] op_sel_hi:[1,0]
v_cvt_pk_bf16_f32 v154, v84, v85
v_cvt_pk_bf16_f32 v155, v86, v87
v_pk_mul_f32 v[92:93], v[92:93], v[176:177] op_sel_hi:[1,0]
v_xor_b32_e64 v31, 32, v15
ds_write_b64 v31, v[154:155] offset:2048
v_pk_mul_f32 v[94:95], v[94:95], v[176:177] op_sel_hi:[1,0]
v_cvt_pk_bf16_f32 v156, v88, v89
v_cvt_pk_bf16_f32 v157, v90, v91
v_cvt_pk_bf16_f32 v158, v92, v93
v_cvt_pk_bf16_f32 v159, v94, v95
v_accvgpr_read_b32 v96, a96
v_xor_b32_e64 v31, 64, v15
ds_write_b64 v31, v[156:157] offset:2048
v_accvgpr_read_b32 v97, a97
v_accvgpr_read_b32 v98, a98
v_accvgpr_read_b32 v99, a99
v_accvgpr_read_b32 v100, a100
v_accvgpr_read_b32 v101, a101
v_accvgpr_read_b32 v102, a102
v_xor_b32 v31, 96, v15
ds_write_b64 v31, v[158:159] offset:2048
v_accvgpr_read_b32 v103, a103
v_pk_mul_f32 v[96:97], v[96:97], v[184:185] op_sel_hi:[1,0]
ds_read_b128 v[144:147], v13 offset:0
v_pk_mul_f32 v[98:99], v[98:99], v[184:185] op_sel_hi:[1,0]
v_accvgpr_read_b32 v104, a104
ds_read_b128 v[148:151], v13 offset:1024
v_accvgpr_read_b32 v105, a105
v_accvgpr_read_b32 v106, a106
ds_read_b128 v[152:155], v13 offset:2048
v_accvgpr_read_b32 v107, a107
v_pk_mul_f32 v[100:101], v[100:101], v[184:185] op_sel_hi:[1,0]
ds_read_b128 v[156:159], v13 offset:3072
v_pk_mul_f32 v[102:103], v[102:103], v[184:185] op_sel_hi:[1,0]
v_cvt_pk_bf16_f32 v224, v96, v97
v_cvt_pk_bf16_f32 v225, v98, v99
v_accvgpr_read_b32 v108, a108
v_accvgpr_read_b32 v109, a109
v_accvgpr_read_b32 v110, a110
ds_write_b64 v15, v[224:225] offset:0
v_accvgpr_read_b32 v111, a111
v_pk_mul_f32 v[104:105], v[104:105], v[184:185] op_sel_hi:[1,0]
v_pk_mul_f32 v[106:107], v[106:107], v[184:185] op_sel_hi:[1,0]
v_cvt_pk_bf16_f32 v226, v100, v101
s_mov_b32 s50, 128
s_waitcnt lgkmcnt(4)
buffer_store_dwordx4 v[144:147], v14, s[24:27], s50 offen sc1 nt
v_cvt_pk_bf16_f32 v227, v102, v103
v_accvgpr_read_b32 v112, a136
v_xor_b32 v31, 32, v15
ds_write_b64 v31, v[226:227] offset:0
v_accvgpr_read_b32 v113, a137
v_accvgpr_read_b32 v114, a138
v_accvgpr_read_b32 v115, a139
s_mov_b32 s50, 3200
s_waitcnt lgkmcnt(4)
buffer_store_dwordx4 v[148:151], v14, s[24:27], s50 offen sc1 nt
s_nop 0
v_pk_mul_f32 v[108:109], v[108:109], v[184:185] op_sel_hi:[1,0]
v_pk_mul_f32 v[110:111], v[110:111], v[184:185] op_sel_hi:[1,0]
v_cvt_pk_bf16_f32 v228, v104, v105
v_cvt_pk_bf16_f32 v229, v106, v107
v_accvgpr_read_b32 v116, a140
s_mov_b32 s50, 6272
s_waitcnt lgkmcnt(3)
buffer_store_dwordx4 v[152:155], v14, s[24:27], s50 offen sc1 nt
v_xor_b32 v31, 64, v15
ds_write_b64 v31, v[228:229] offset:0
v_accvgpr_read_b32 v117, a141
v_accvgpr_read_b32 v118, a142
v_accvgpr_read_b32 v119, a143
v_pk_mul_f32 v[112:113], v[112:113], v[188:189] op_sel_hi:[1,0]
v_pk_mul_f32 v[114:115], v[114:115], v[188:189] op_sel_hi:[1,0]
s_mov_b32 s50, 9344
s_waitcnt lgkmcnt(3)
buffer_store_dwordx4 v[156:159], v14, s[24:27], s50 offen sc1 nt
s_nop 0
v_cvt_pk_bf16_f32 v230, v108, v109
v_cvt_pk_bf16_f32 v231, v110, v111
v_accvgpr_read_b32 v120, a144
v_xor_b32 v31, 96, v15
ds_write_b64 v31, v[230:231] offset:0
v_accvgpr_read_b32 v121, a145
v_accvgpr_read_b32 v122, a146
v_accvgpr_read_b32 v123, a147
v_pk_mul_f32 v[116:117], v[116:117], v[188:189] op_sel_hi:[1,0]
v_pk_mul_f32 v[118:119], v[118:119], v[188:189] op_sel_hi:[1,0]
v_cvt_pk_bf16_f32 v232, v112, v113
v_cvt_pk_bf16_f32 v233, v114, v115
v_accvgpr_read_b32 v124, a148
ds_write_b64 v15, v[232:233] offset:2048
v_accvgpr_read_b32 v125, a149
v_accvgpr_read_b32 v126, a150
v_accvgpr_read_b32 v127, a151
v_pk_mul_f32 v[120:121], v[120:121], v[188:189] op_sel_hi:[1,0]
v_pk_mul_f32 v[122:123], v[122:123], v[188:189] op_sel_hi:[1,0]
v_cvt_pk_bf16_f32 v234, v116, v117
v_cvt_pk_bf16_f32 v235, v118, v119
v_pk_mul_f32 v[124:125], v[124:125], v[188:189] op_sel_hi:[1,0]
v_xor_b32_e64 v31, 32, v15
ds_write_b64 v31, v[234:235] offset:2048
v_pk_mul_f32 v[126:127], v[126:127], v[188:189] op_sel_hi:[1,0]
v_cvt_pk_bf16_f32 v236, v120, v121
v_cvt_pk_bf16_f32 v237, v122, v123
v_cvt_pk_bf16_f32 v238, v124, v125
v_cvt_pk_bf16_f32 v239, v126, v127
v_accvgpr_read_b32 v64, a32
v_xor_b32_e64 v31, 64, v15
ds_write_b64 v31, v[236:237] offset:2048
v_accvgpr_read_b32 v65, a33
v_accvgpr_read_b32 v66, a34
v_accvgpr_read_b32 v67, a35
v_accvgpr_read_b32 v68, a36
v_accvgpr_read_b32 v69, a37
v_accvgpr_read_b32 v70, a38
v_xor_b32 v31, 96, v15
ds_write_b64 v31, v[238:239] offset:2048
v_accvgpr_read_b32 v71, a39
v_pk_mul_f32 v[64:65], v[64:65], v[20:21] op_sel_hi:[1,0]
ds_read_b128 v[224:227], v13 offset:0
v_pk_mul_f32 v[66:67], v[66:67], v[20:21] op_sel_hi:[1,0]
v_pk_mul_f32 v[68:69], v[68:69], v[20:21] op_sel_hi:[1,0]
ds_read_b128 v[228:231], v13 offset:1024
v_pk_mul_f32 v[70:71], v[70:71], v[20:21] op_sel_hi:[1,0]
v_cvt_pk_bf16_f32 v192, v64, v65
ds_read_b128 v[232:235], v13 offset:2048
v_cvt_pk_bf16_f32 v193, v66, v67
v_pk_mul_f32 v[32:33], v[32:33], v[20:21] op_sel_hi:[1,0]
ds_read_b128 v[236:239], v13 offset:3072
v_pk_mul_f32 v[34:35], v[34:35], v[20:21] op_sel_hi:[1,0]
v_cvt_pk_bf16_f32 v194, v68, v69
v_cvt_pk_bf16_f32 v195, v70, v71
v_accvgpr_read_b32 v80, a72
v_accvgpr_read_b32 v81, a73
v_accvgpr_read_b32 v82, a74
ds_write_b64 v15, v[192:193] offset:0
v_accvgpr_read_b32 v83, a75
v_pk_mul_f32 v[36:37], v[36:37], v[20:21] op_sel_hi:[1,0]
v_pk_mul_f32 v[38:39], v[38:39], v[20:21] op_sel_hi:[1,0]
v_cvt_pk_bf16_f32 v196, v32, v33
s_mov_b32 s50, 12416
s_waitcnt lgkmcnt(4)
buffer_store_dwordx4 v[224:227], v14, s[24:27], s50 offen sc1 nt
v_cvt_pk_bf16_f32 v197, v34, v35
v_accvgpr_read_b32 v84, a76
v_xor_b32 v31, 32, v15
ds_write_b64 v31, v[194:195] offset:0
v_accvgpr_read_b32 v85, a77
v_accvgpr_read_b32 v86, a78
v_accvgpr_read_b32 v87, a79
s_mov_b32 s50, 15488
s_waitcnt lgkmcnt(4)
buffer_store_dwordx4 v[228:231], v14, s[24:27], s50 offen sc1 nt
v_pk_mul_f32 v[80:81], v[80:81], v[176:177] op_sel_hi:[1,0]
v_pk_mul_f32 v[82:83], v[82:83], v[176:177] op_sel_hi:[1,0]
v_cvt_pk_bf16_f32 v198, v36, v37
v_xor_b32 v31, 64, v15
ds_write_b64 v31, v[196:197] offset:0
v_cvt_pk_bf16_f32 v199, v38, v39
v_pk_mul_f32 v[84:85], v[84:85], v[176:177] op_sel_hi:[1,0]
s_mov_b32 s50, 18560
s_waitcnt lgkmcnt(4)
buffer_store_dwordx4 v[232:235], v14, s[24:27], s50 offen sc1 nt
v_pk_mul_f32 v[86:87], v[86:87], v[176:177] op_sel_hi:[1,0]
v_cvt_pk_bf16_f32 v200, v80, v81
v_cvt_pk_bf16_f32 v201, v82, v83
v_pk_mul_f32 v[40:41], v[40:41], v[176:177] op_sel_hi:[1,0]
v_xor_b32 v31, 96, v15
ds_write_b64 v31, v[198:199] offset:0
v_pk_mul_f32 v[42:43], v[42:43], v[176:177] op_sel_hi:[1,0]
s_mov_b32 s50, 21632
s_waitcnt lgkmcnt(4)
buffer_store_dwordx4 v[236:239], v14, s[24:27], s50 offen sc1 nt
v_cvt_pk_bf16_f32 v202, v84, v85
v_cvt_pk_bf16_f32 v203, v86, v87
v_pk_mul_f32 v[44:45], v[44:45], v[176:177] op_sel_hi:[1,0]
v_pk_mul_f32 v[46:47], v[46:47], v[176:177] op_sel_hi:[1,0]
v_cvt_pk_bf16_f32 v204, v40, v41
ds_write_b64 v15, v[200:201] offset:2048
v_cvt_pk_bf16_f32 v205, v42, v43
v_cvt_pk_bf16_f32 v206, v44, v45
v_cvt_pk_bf16_f32 v207, v46, v47
v_accvgpr_read_b32 v96, a112
v_accvgpr_read_b32 v97, a113
v_accvgpr_read_b32 v98, a114
v_xor_b32_e64 v31, 32, v15
ds_write_b64 v31, v[202:203] offset:2048
v_accvgpr_read_b32 v99, a115
v_accvgpr_read_b32 v100, a116
v_accvgpr_read_b32 v101, a117
v_accvgpr_read_b32 v102, a118
v_accvgpr_read_b32 v103, a119
v_pk_mul_f32 v[96:97], v[96:97], v[184:185] op_sel_hi:[1,0]
v_xor_b32_e64 v31, 64, v15
ds_write_b64 v31, v[204:205] offset:2048
v_pk_mul_f32 v[98:99], v[98:99], v[184:185] op_sel_hi:[1,0]
v_pk_mul_f32 v[100:101], v[100:101], v[184:185] op_sel_hi:[1,0]
v_pk_mul_f32 v[102:103], v[102:103], v[184:185] op_sel_hi:[1,0]
v_cvt_pk_bf16_f32 v240, v96, v97
v_cvt_pk_bf16_f32 v241, v98, v99
v_pk_mul_f32 v[48:49], v[48:49], v[184:185] op_sel_hi:[1,0]
v_xor_b32 v31, 96, v15
ds_write_b64 v31, v[206:207] offset:2048
v_pk_mul_f32 v[50:51], v[50:51], v[184:185] op_sel_hi:[1,0]
v_cvt_pk_bf16_f32 v242, v100, v101
ds_read_b128 v[192:195], v13 offset:0
v_cvt_pk_bf16_f32 v243, v102, v103
v_accvgpr_read_b32 v112, a152
ds_read_b128 v[196:199], v13 offset:1024
v_accvgpr_read_b32 v113, a153
v_accvgpr_read_b32 v114, a154
ds_read_b128 v[200:203], v13 offset:2048
v_accvgpr_read_b32 v115, a155
v_pk_mul_f32 v[52:53], v[52:53], v[184:185] op_sel_hi:[1,0]
ds_read_b128 v[204:207], v13 offset:3072
v_pk_mul_f32 v[54:55], v[54:55], v[184:185] op_sel_hi:[1,0]
v_cvt_pk_bf16_f32 v244, v48, v49
v_cvt_pk_bf16_f32 v245, v50, v51
v_accvgpr_read_b32 v116, a156
v_accvgpr_read_b32 v117, a157
v_accvgpr_read_b32 v118, a158
ds_write_b64 v15, v[240:241] offset:0
v_accvgpr_read_b32 v119, a159
v_pk_mul_f32 v[112:113], v[112:113], v[188:189] op_sel_hi:[1,0]
v_pk_mul_f32 v[114:115], v[114:115], v[188:189] op_sel_hi:[1,0]
v_cvt_pk_bf16_f32 v246, v52, v53
s_mov_b32 s50, 256
s_waitcnt lgkmcnt(4)
buffer_store_dwordx4 v[192:195], v14, s[24:27], s50 offen sc1 nt
v_cvt_pk_bf16_f32 v247, v54, v55
v_pk_mul_f32 v[116:117], v[116:117], v[188:189] op_sel_hi:[1,0]
v_xor_b32 v31, 32, v15
ds_write_b64 v31, v[242:243] offset:0
v_pk_mul_f32 v[118:119], v[118:119], v[188:189] op_sel_hi:[1,0]
v_cvt_pk_bf16_f32 v248, v112, v113
v_cvt_pk_bf16_f32 v249, v114, v115
s_mov_b32 s50, 3328
s_waitcnt lgkmcnt(4)
buffer_store_dwordx4 v[196:199], v14, s[24:27], s50 offen sc1 nt
v_pk_mul_f32 v[56:57], v[56:57], v[188:189] op_sel_hi:[1,0]
v_pk_mul_f32 v[58:59], v[58:59], v[188:189] op_sel_hi:[1,0]
v_cvt_pk_bf16_f32 v250, v116, v117
v_xor_b32_e64 v31, 64, v15
ds_write_b64 v31, v[244:245] offset:0
v_cvt_pk_bf16_f32 v251, v118, v119
v_pk_mul_f32 v[60:61], v[60:61], v[188:189] op_sel_hi:[1,0]
s_mov_b32 s50, 6400
s_waitcnt lgkmcnt(4)
buffer_store_dwordx4 v[200:203], v14, s[24:27], s50 offen sc1 nt
v_pk_mul_f32 v[62:63], v[62:63], v[188:189] op_sel_hi:[1,0]
v_cvt_pk_bf16_f32 v252, v56, v57
v_cvt_pk_bf16_f32 v253, v58, v59
v_cvt_pk_bf16_f32 v254, v60, v61
v_xor_b32 v31, 96, v15
ds_write_b64 v31, v[246:247] offset:0
v_cvt_pk_bf16_f32 v255, v62, v63
s_mov_b32 s50, 9472
s_waitcnt lgkmcnt(4)
buffer_store_dwordx4 v[204:207], v14, s[24:27], s50 offen sc1 nt
ds_write_b64 v15, v[248:249] offset:2048
v_xor_b32 v31, 32, v15
ds_write_b64 v31, v[250:251] offset:2048
v_xor_b32_e64 v31, 64, v15
ds_write_b64 v31, v[252:253] offset:2048
v_xor_b32 v31, 96, v15
ds_write_b64 v31, v[254:255] offset:2048
ds_read_b128 v[240:243], v13 offset:0
ds_read_b128 v[244:247], v13 offset:1024
ds_read_b128 v[248:251], v13 offset:2048
ds_read_b128 v[252:255], v13 offset:3072
s_mov_b32 s50, 12544
s_waitcnt lgkmcnt(3)
buffer_store_dwordx4 v[240:243], v14, s[24:27], s50 offen sc1 nt
s_mov_b32 s50, 15616
s_waitcnt lgkmcnt(2)
buffer_store_dwordx4 v[244:247], v14, s[24:27], s50 offen sc1 nt
s_mov_b32 s50, 18688
s_waitcnt lgkmcnt(1)
buffer_store_dwordx4 v[248:251], v14, s[24:27], s50 offen sc1 nt
s_mov_b32 s50, 21760
s_waitcnt lgkmcnt(0)
buffer_store_dwordx4 v[252:255], v14, s[24:27], s50 offen sc1 nt
L_end:
s_endpgm
L_tr1:
s_call_b64 s[40:41], L_rare1
s_branch L_bk1
L_tr2:
s_call_b64 s[40:41], L_rare0
s_branch L_bk2
L_tr3:
s_call_b64 s[40:41], L_rare1
s_branch L_bk3
L_tr4:
s_call_b64 s[40:41], L_rare0
s_branch L_bk4
L_tr5:
s_call_b64 s[40:41], L_rare1
s_branch L_bk5
L_tr6:
s_call_b64 s[40:41], L_rare0
s_branch L_bk6
L_tr7:
s_call_b64 s[40:41], L_rare1
s_branch L_bk7
L_tr8:
s_call_b64 s[40:41], L_rare0
s_branch L_bk8
L_tr9:
s_call_b64 s[40:41], L_rare1
s_branch L_bk9
L_tr10:
s_call_b64 s[40:41], L_rare0
s_branch L_bk10
L_tr11:
s_call_b64 s[40:41], L_rare1
s_branch L_bk11
L_tr12:
s_call_b64 s[40:41], L_rare0
s_branch L_bk12
L_tr13:
s_call_b64 s[40:41], L_rare1
s_branch L_bk13
L_tr14:
s_call_b64 s[40:41], L_rare0
s_branch L_bk14
L_tr15:
s_call_b64 s[40:41], L_rare1
s_branch L_bk15
L_rare0:
s_nop 15
s_nop 3
v_max3_f32 v30, v64, v65, v66
v_max3_f32 v30, v30, v67, v68
v_max3_f32 v30, v30, v69, v70
v_max_f32 v30, v30, v71
v_mov_b32 v31, v30
s_nop 1
v_permlane16_swap_b32 v31, v30
s_nop 1
v_max_f32 v30, v31, v30
v_mov_b32 v31, v30
s_nop 1
v_permlane32_swap_b32 v31, v30
s_nop 1
v_max_f32 v30, v31, v30
v_mov_b32 v31, s67
v_fma_f32 v30, s42, v30, v31
v_min_f32 v30, v30, v16
v_sub_f32 v31, v30, v16
v_exp_f32 v31, v31
v_mov_b32 v16, v30
v_mul_f32 v20, v20, v31
v_accvgpr_read_b32 v24, a0
v_mul_f32 v24, v24, v31
v_accvgpr_write_b32 a0, v24
v_accvgpr_read_b32 v25, a1
v_mul_f32 v25, v25, v31
v_accvgpr_write_b32 a1, v25
v_accvgpr_read_b32 v26, a2
v_mul_f32 v26, v26, v31
v_accvgpr_write_b32 a2, v26
v_accvgpr_read_b32 v27, a3
v_mul_f32 v27, v27, v31
v_accvgpr_write_b32 a3, v27
v_accvgpr_read_b32 v24, a4
v_mul_f32 v24, v24, v31
v_accvgpr_write_b32 a4, v24
v_accvgpr_read_b32 v25, a5
v_mul_f32 v25, v25, v31
v_accvgpr_write_b32 a5, v25
v_accvgpr_read_b32 v26, a6
v_mul_f32 v26, v26, v31
v_accvgpr_write_b32 a6, v26
v_accvgpr_read_b32 v27, a7
v_mul_f32 v27, v27, v31
v_accvgpr_write_b32 a7, v27
v_accvgpr_read_b32 v24, a8
v_mul_f32 v24, v24, v31
v_accvgpr_write_b32 a8, v24
v_accvgpr_read_b32 v25, a9
v_mul_f32 v25, v25, v31
v_accvgpr_write_b32 a9, v25
v_accvgpr_read_b32 v26, a10
v_mul_f32 v26, v26, v31
v_accvgpr_write_b32 a10, v26
v_accvgpr_read_b32 v27, a11
v_mul_f32 v27, v27, v31
v_accvgpr_write_b32 a11, v27
v_accvgpr_read_b32 v24, a12
v_mul_f32 v24, v24, v31
v_accvgpr_write_b32 a12, v24
v_accvgpr_read_b32 v25, a13
v_mul_f32 v25, v25, v31
v_accvgpr_write_b32 a13, v25
v_accvgpr_read_b32 v26, a14
v_mul_f32 v26, v26, v31
v_accvgpr_write_b32 a14, v26
v_accvgpr_read_b32 v27, a15
v_mul_f32 v27, v27, v31
v_accvgpr_write_b32 a15, v27
v_accvgpr_read_b32 v24, a16
v_mul_f32 v24, v24, v31
v_accvgpr_write_b32 a16, v24
v_accvgpr_read_b32 v25, a17
v_mul_f32 v25, v25, v31
v_accvgpr_write_b32 a17, v25
v_accvgpr_read_b32 v26, a18
v_mul_f32 v26, v26, v31
v_accvgpr_write_b32 a18, v26
v_accvgpr_read_b32 v27, a19
v_mul_f32 v27, v27, v31
v_accvgpr_write_b32 a19, v27
v_accvgpr_read_b32 v24, a20
v_mul_f32 v24, v24, v31
v_accvgpr_write_b32 a20, v24
v_accvgpr_read_b32 v25, a21
v_mul_f32 v25, v25, v31
v_accvgpr_write_b32 a21, v25
v_accvgpr_read_b32 v26, a22
v_mul_f32 v26, v26, v31
v_accvgpr_write_b32 a22, v26
v_accvgpr_read_b32 v27, a23
v_mul_f32 v27, v27, v31
v_accvgpr_write_b32 a23, v27
v_accvgpr_read_b32 v24, a24
v_mul_f32 v24, v24, v31
v_accvgpr_write_b32 a24, v24
v_accvgpr_read_b32 v25, a25
v_mul_f32 v25, v25, v31
v_accvgpr_write_b32 a25, v25
v_accvgpr_read_b32 v26, a26
v_mul_f32 v26, v26, v31
v_accvgpr_write_b32 a26, v26
v_accvgpr_read_b32 v27, a27
v_mul_f32 v27, v27, v31
v_accvgpr_write_b32 a27, v27
v_accvgpr_read_b32 v24, a28
v_mul_f32 v24, v24, v31
v_accvgpr_write_b32 a28, v24
v_accvgpr_read_b32 v25, a29
v_mul_f32 v25, v25, v31
v_accvgpr_write_b32 a29, v25
v_accvgpr_read_b32 v26, a30
v_mul_f32 v26, v26, v31
v_accvgpr_write_b32 a30, v26
v_accvgpr_read_b32 v27, a31
v_mul_f32 v27, v27, v31
v_accvgpr_write_b32 a31, v27
v_accvgpr_read_b32 v24, a32
v_mul_f32 v24, v24, v31
v_accvgpr_write_b32 a32, v24
v_accvgpr_read_b32 v25, a33
v_mul_f32 v25, v25, v31
v_accvgpr_write_b32 a33, v25
v_accvgpr_read_b32 v26, a34
v_mul_f32 v26, v26, v31
v_accvgpr_write_b32 a34, v26
v_accvgpr_read_b32 v27, a35
v_mul_f32 v27, v27, v31
v_accvgpr_write_b32 a35, v27
v_accvgpr_read_b32 v24, a36
v_mul_f32 v24, v24, v31
v_accvgpr_write_b32 a36, v24
v_accvgpr_read_b32 v25, a37
v_mul_f32 v25, v25, v31
v_accvgpr_write_b32 a37, v25
v_accvgpr_read_b32 v26, a38
v_mul_f32 v26, v26, v31
v_accvgpr_write_b32 a38, v26
v_accvgpr_read_b32 v27, a39
v_mul_f32 v27, v27, v31
v_accvgpr_write_b32 a39, v27
v_mul_f32 v32, v32, v31
v_mul_f32 v33, v33, v31
v_mul_f32 v34, v34, v31
v_mul_f32 v35, v35, v31
v_mul_f32 v36, v36, v31
v_mul_f32 v37, v37, v31
v_mul_f32 v38, v38, v31
v_mul_f32 v39, v39, v31
v_fma_f32 v24, v64, s28, v16
v_fma_f32 v25, v65, s28, v16
v_exp_f32 v24, v24
v_exp_f32 v25, v25
s_nop 0
v_cvt_pk_bf16_f32 v128, v24, v25
v_fma_f32 v24, v66, s28, v16
v_fma_f32 v25, v67, s28, v16
v_exp_f32 v24, v24
v_exp_f32 v25, v25
s_nop 0
v_cvt_pk_bf16_f32 v129, v24, v25
v_fma_f32 v24, v68, s28, v16
v_fma_f32 v25, v69, s28, v16
v_exp_f32 v24, v24
v_exp_f32 v25, v25
s_nop 0
v_cvt_pk_bf16_f32 v130, v24, v25
v_fma_f32 v24, v70, s28, v16
v_fma_f32 v25, v71, s28, v16
v_exp_f32 v24, v24
v_exp_f32 v25, v25
s_nop 0
v_cvt_pk_bf16_f32 v131, v24, v25
v_max3_f32 v30, v72, v73, v74
v_max3_f32 v30, v30, v75, v76
v_max3_f32 v30, v30, v77, v78
v_max_f32 v30, v30, v79
v_mov_b32 v31, v30
s_nop 1
v_permlane16_swap_b32 v31, v30
s_nop 1
v_max_f32 v30, v31, v30
v_mov_b32 v31, v30
s_nop 1
v_permlane32_swap_b32 v31, v30
s_nop 1
v_max_f32 v30, v31, v30
v_mov_b32 v31, s67
v_fma_f32 v30, s42, v30, v31
v_min_f32 v30, v30, v17
v_sub_f32 v31, v30, v17
v_exp_f32 v31, v31
v_mov_b32 v17, v30
v_mul_f32 v176, v176, v31
v_accvgpr_read_b32 v24, a40
v_mul_f32 v24, v24, v31
v_accvgpr_write_b32 a40, v24
v_accvgpr_read_b32 v25, a41
v_mul_f32 v25, v25, v31
v_accvgpr_write_b32 a41, v25
v_accvgpr_read_b32 v26, a42
v_mul_f32 v26, v26, v31
v_accvgpr_write_b32 a42, v26
v_accvgpr_read_b32 v27, a43
v_mul_f32 v27, v27, v31
v_accvgpr_write_b32 a43, v27
v_accvgpr_read_b32 v24, a44
v_mul_f32 v24, v24, v31
v_accvgpr_write_b32 a44, v24
v_accvgpr_read_b32 v25, a45
v_mul_f32 v25, v25, v31
v_accvgpr_write_b32 a45, v25
v_accvgpr_read_b32 v26, a46
v_mul_f32 v26, v26, v31
v_accvgpr_write_b32 a46, v26
v_accvgpr_read_b32 v27, a47
v_mul_f32 v27, v27, v31
v_accvgpr_write_b32 a47, v27
v_accvgpr_read_b32 v24, a48
v_mul_f32 v24, v24, v31
v_accvgpr_write_b32 a48, v24
v_accvgpr_read_b32 v25, a49
v_mul_f32 v25, v25, v31
v_accvgpr_write_b32 a49, v25
v_accvgpr_read_b32 v26, a50
v_mul_f32 v26, v26, v31
v_accvgpr_write_b32 a50, v26
v_accvgpr_read_b32 v27, a51
v_mul_f32 v27, v27, v31
v_accvgpr_write_b32 a51, v27
v_accvgpr_read_b32 v24, a52
v_mul_f32 v24, v24, v31
v_accvgpr_write_b32 a52, v24
v_accvgpr_read_b32 v25, a53
v_mul_f32 v25, v25, v31
v_accvgpr_write_b32 a53, v25
v_accvgpr_read_b32 v26, a54
v_mul_f32 v26, v26, v31
v_accvgpr_write_b32 a54, v26
v_accvgpr_read_b32 v27, a55
v_mul_f32 v27, v27, v31
v_accvgpr_write_b32 a55, v27
v_accvgpr_read_b32 v24, a56
v_mul_f32 v24, v24, v31
v_accvgpr_write_b32 a56, v24
v_accvgpr_read_b32 v25, a57
v_mul_f32 v25, v25, v31
v_accvgpr_write_b32 a57, v25
v_accvgpr_read_b32 v26, a58
v_mul_f32 v26, v26, v31
v_accvgpr_write_b32 a58, v26
v_accvgpr_read_b32 v27, a59
v_mul_f32 v27, v27, v31
v_accvgpr_write_b32 a59, v27
v_accvgpr_read_b32 v24, a60
v_mul_f32 v24, v24, v31
v_accvgpr_write_b32 a60, v24
v_accvgpr_read_b32 v25, a61
v_mul_f32 v25, v25, v31
v_accvgpr_write_b32 a61, v25
v_accvgpr_read_b32 v26, a62
v_mul_f32 v26, v26, v31
v_accvgpr_write_b32 a62, v26
v_accvgpr_read_b32 v27, a63
v_mul_f32 v27, v27, v31
v_accvgpr_write_b32 a63, v27
v_accvgpr_read_b32 v24, a64
v_mul_f32 v24, v24, v31
v_accvgpr_write_b32 a64, v24
v_accvgpr_read_b32 v25, a65
v_mul_f32 v25, v25, v31
v_accvgpr_write_b32 a65, v25
v_accvgpr_read_b32 v26, a66
v_mul_f32 v26, v26, v31
v_accvgpr_write_b32 a66, v26
v_accvgpr_read_b32 v27, a67
v_mul_f32 v27, v27, v31
v_accvgpr_write_b32 a67, v27
v_accvgpr_read_b32 v24, a68
v_mul_f32 v24, v24, v31
v_accvgpr_write_b32 a68, v24
v_accvgpr_read_b32 v25, a69
v_mul_f32 v25, v25, v31
v_accvgpr_write_b32 a69, v25
v_accvgpr_read_b32 v26, a70
v_mul_f32 v26, v26, v31
v_accvgpr_write_b32 a70, v26
v_accvgpr_read_b32 v27, a71
v_mul_f32 v27, v27, v31
v_accvgpr_write_b32 a71, v27
v_accvgpr_read_b32 v24, a72
v_mul_f32 v24, v24, v31
v_accvgpr_write_b32 a72, v24
v_accvgpr_read_b32 v25, a73
v_mul_f32 v25, v25, v31
v_accvgpr_write_b32 a73, v25
v_accvgpr_read_b32 v26, a74
v_mul_f32 v26, v26, v31
v_accvgpr_write_b32 a74, v26
v_accvgpr_read_b32 v27, a75
v_mul_f32 v27, v27, v31
v_accvgpr_write_b32 a75, v27
v_accvgpr_read_b32 v24, a76
v_mul_f32 v24, v24, v31
v_accvgpr_write_b32 a76, v24
v_accvgpr_read_b32 v25, a77
v_mul_f32 v25, v25, v31
v_accvgpr_write_b32 a77, v25
v_accvgpr_read_b32 v26, a78
v_mul_f32 v26, v26, v31
v_accvgpr_write_b32 a78, v26
v_accvgpr_read_b32 v27, a79
v_mul_f32 v27, v27, v31
v_accvgpr_write_b32 a79, v27
v_mul_f32 v40, v40, v31
v_mul_f32 v41, v41, v31
v_mul_f32 v42, v42, v31
v_mul_f32 v43, v43, v31
v_mul_f32 v44, v44, v31
v_mul_f32 v45, v45, v31
v_mul_f32 v46, v46, v31
v_mul_f32 v47, v47, v31
v_fma_f32 v24, v72, s28, v17
v_fma_f32 v25, v73, s28, v17
v_exp_f32 v24, v24
v_exp_f32 v25, v25
s_nop 0
v_cvt_pk_bf16_f32 v132, v24, v25
v_fma_f32 v24, v74, s28, v17
v_fma_f32 v25, v75, s28, v17
v_exp_f32 v24, v24
v_exp_f32 v25, v25
s_nop 0
v_cvt_pk_bf16_f32 v133, v24, v25
v_fma_f32 v24, v76, s28, v17
v_fma_f32 v25, v77, s28, v17
v_exp_f32 v24, v24
v_exp_f32 v25, v25
s_nop 0
v_cvt_pk_bf16_f32 v134, v24, v25
v_fma_f32 v24, v78, s28, v17
v_fma_f32 v25, v79, s28, v17
v_exp_f32 v24, v24
v_exp_f32 v25, v25
s_nop 0
v_cvt_pk_bf16_f32 v135, v24, v25
v_max3_f32 v30, v80, v81, v82
v_max3_f32 v30, v30, v83, v84
v_max3_f32 v30, v30, v85, v86
v_max_f32 v30, v30, v87
v_mov_b32 v31, v30
s_nop 1
v_permlane16_swap_b32 v31, v30
s_nop 1
v_max_f32 v30, v31, v30
v_mov_b32 v31, v30
s_nop 1
v_permlane32_swap_b32 v31, v30
s_nop 1
v_max_f32 v30, v31, v30
v_mov_b32 v31, s67
v_fma_f32 v30, s42, v30, v31
v_min_f32 v30, v30, v18
v_sub_f32 v31, v30, v18
v_exp_f32 v31, v31
v_mov_b32 v18, v30
v_mul_f32 v184, v184, v31
v_accvgpr_read_b32 v24, a80
v_mul_f32 v24, v24, v31
v_accvgpr_write_b32 a80, v24
v_accvgpr_read_b32 v25, a81
v_mul_f32 v25, v25, v31
v_accvgpr_write_b32 a81, v25
v_accvgpr_read_b32 v26, a82
v_mul_f32 v26, v26, v31
v_accvgpr_write_b32 a82, v26
v_accvgpr_read_b32 v27, a83
v_mul_f32 v27, v27, v31
v_accvgpr_write_b32 a83, v27
v_accvgpr_read_b32 v24, a84
v_mul_f32 v24, v24, v31
v_accvgpr_write_b32 a84, v24
v_accvgpr_read_b32 v25, a85
v_mul_f32 v25, v25, v31
v_accvgpr_write_b32 a85, v25
v_accvgpr_read_b32 v26, a86
v_mul_f32 v26, v26, v31
v_accvgpr_write_b32 a86, v26
v_accvgpr_read_b32 v27, a87
v_mul_f32 v27, v27, v31
v_accvgpr_write_b32 a87, v27
v_accvgpr_read_b32 v24, a88
v_mul_f32 v24, v24, v31
v_accvgpr_write_b32 a88, v24
v_accvgpr_read_b32 v25, a89
v_mul_f32 v25, v25, v31
v_accvgpr_write_b32 a89, v25
v_accvgpr_read_b32 v26, a90
v_mul_f32 v26, v26, v31
v_accvgpr_write_b32 a90, v26
v_accvgpr_read_b32 v27, a91
v_mul_f32 v27, v27, v31
v_accvgpr_write_b32 a91, v27
v_accvgpr_read_b32 v24, a92
v_mul_f32 v24, v24, v31
v_accvgpr_write_b32 a92, v24
v_accvgpr_read_b32 v25, a93
v_mul_f32 v25, v25, v31
v_accvgpr_write_b32 a93, v25
v_accvgpr_read_b32 v26, a94
v_mul_f32 v26, v26, v31
v_accvgpr_write_b32 a94, v26
v_accvgpr_read_b32 v27, a95
v_mul_f32 v27, v27, v31
v_accvgpr_write_b32 a95, v27
v_accvgpr_read_b32 v24, a96
v_mul_f32 v24, v24, v31
v_accvgpr_write_b32 a96, v24
v_accvgpr_read_b32 v25, a97
v_mul_f32 v25, v25, v31
v_accvgpr_write_b32 a97, v25
v_accvgpr_read_b32 v26, a98
v_mul_f32 v26, v26, v31
v_accvgpr_write_b32 a98, v26
v_accvgpr_read_b32 v27, a99
v_mul_f32 v27, v27, v31
v_accvgpr_write_b32 a99, v27
v_accvgpr_read_b32 v24, a100
v_mul_f32 v24, v24, v31
v_accvgpr_write_b32 a100, v24
v_accvgpr_read_b32 v25, a101
v_mul_f32 v25, v25, v31
v_accvgpr_write_b32 a101, v25
v_accvgpr_read_b32 v26, a102
v_mul_f32 v26, v26, v31
v_accvgpr_write_b32 a102, v26
v_accvgpr_read_b32 v27, a103
v_mul_f32 v27, v27, v31
v_accvgpr_write_b32 a103, v27
v_accvgpr_read_b32 v24, a104
v_mul_f32 v24, v24, v31
v_accvgpr_write_b32 a104, v24
v_accvgpr_read_b32 v25, a105
v_mul_f32 v25, v25, v31
v_accvgpr_write_b32 a105, v25
v_accvgpr_read_b32 v26, a106
v_mul_f32 v26, v26, v31
v_accvgpr_write_b32 a106, v26
v_accvgpr_read_b32 v27, a107
v_mul_f32 v27, v27, v31
v_accvgpr_write_b32 a107, v27
v_accvgpr_read_b32 v24, a108
v_mul_f32 v24, v24, v31
v_accvgpr_write_b32 a108, v24
v_accvgpr_read_b32 v25, a109
v_mul_f32 v25, v25, v31
v_accvgpr_write_b32 a109, v25
v_accvgpr_read_b32 v26, a110
v_mul_f32 v26, v26, v31
v_accvgpr_write_b32 a110, v26
v_accvgpr_read_b32 v27, a111
v_mul_f32 v27, v27, v31
v_accvgpr_write_b32 a111, v27
v_accvgpr_read_b32 v24, a112
v_mul_f32 v24, v24, v31
v_accvgpr_write_b32 a112, v24
v_accvgpr_read_b32 v25, a113
v_mul_f32 v25, v25, v31
v_accvgpr_write_b32 a113, v25
v_accvgpr_read_b32 v26, a114
v_mul_f32 v26, v26, v31
v_accvgpr_write_b32 a114, v26
v_accvgpr_read_b32 v27, a115
v_mul_f32 v27, v27, v31
v_accvgpr_write_b32 a115, v27
v_accvgpr_read_b32 v24, a116
v_mul_f32 v24, v24, v31
v_accvgpr_write_b32 a116, v24
v_accvgpr_read_b32 v25, a117
v_mul_f32 v25, v25, v31
v_accvgpr_write_b32 a117, v25
v_accvgpr_read_b32 v26, a118
v_mul_f32 v26, v26, v31
v_accvgpr_write_b32 a118, v26
v_accvgpr_read_b32 v27, a119
v_mul_f32 v27, v27, v31
v_accvgpr_write_b32 a119, v27
v_mul_f32 v48, v48, v31
v_mul_f32 v49, v49, v31
v_mul_f32 v50, v50, v31
v_mul_f32 v51, v51, v31
v_mul_f32 v52, v52, v31
v_mul_f32 v53, v53, v31
v_mul_f32 v54, v54, v31
v_mul_f32 v55, v55, v31
v_fma_f32 v24, v80, s28, v18
v_fma_f32 v25, v81, s28, v18
v_exp_f32 v24, v24
v_exp_f32 v25, v25
s_nop 0
v_cvt_pk_bf16_f32 v136, v24, v25
v_fma_f32 v24, v82, s28, v18
v_fma_f32 v25, v83, s28, v18
v_exp_f32 v24, v24
v_exp_f32 v25, v25
s_nop 0
v_cvt_pk_bf16_f32 v137, v24, v25
v_fma_f32 v24, v84, s28, v18
v_fma_f32 v25, v85, s28, v18
v_exp_f32 v24, v24
v_exp_f32 v25, v25
s_nop 0
v_cvt_pk_bf16_f32 v138, v24, v25
v_fma_f32 v24, v86, s28, v18
v_fma_f32 v25, v87, s28, v18
v_exp_f32 v24, v24
v_exp_f32 v25, v25
s_nop 0
v_cvt_pk_bf16_f32 v139, v24, v25
v_max3_f32 v30, v88, v89, v90
v_max3_f32 v30, v30, v91, v92
v_max3_f32 v30, v30, v93, v94
v_max_f32 v30, v30, v95
v_mov_b32 v31, v30
s_nop 1
v_permlane16_swap_b32 v31, v30
s_nop 1
v_max_f32 v30, v31, v30
v_mov_b32 v31, v30
s_nop 1
v_permlane32_swap_b32 v31, v30
s_nop 1
v_max_f32 v30, v31, v30
v_mov_b32 v31, s67
v_fma_f32 v30, s42, v30, v31
v_min_f32 v30, v30, v19
v_sub_f32 v31, v30, v19
v_exp_f32 v31, v31
v_mov_b32 v19, v30
v_mul_f32 v188, v188, v31
v_accvgpr_read_b32 v24, a120
v_mul_f32 v24, v24, v31
v_accvgpr_write_b32 a120, v24
v_accvgpr_read_b32 v25, a121
v_mul_f32 v25, v25, v31
v_accvgpr_write_b32 a121, v25
v_accvgpr_read_b32 v26, a122
v_mul_f32 v26, v26, v31
v_accvgpr_write_b32 a122, v26
v_accvgpr_read_b32 v27, a123
v_mul_f32 v27, v27, v31
v_accvgpr_write_b32 a123, v27
v_accvgpr_read_b32 v24, a124
v_mul_f32 v24, v24, v31
v_accvgpr_write_b32 a124, v24
v_accvgpr_read_b32 v25, a125
v_mul_f32 v25, v25, v31
v_accvgpr_write_b32 a125, v25
v_accvgpr_read_b32 v26, a126
v_mul_f32 v26, v26, v31
v_accvgpr_write_b32 a126, v26
v_accvgpr_read_b32 v27, a127
v_mul_f32 v27, v27, v31
v_accvgpr_write_b32 a127, v27
v_accvgpr_read_b32 v24, a128
v_mul_f32 v24, v24, v31
v_accvgpr_write_b32 a128, v24
v_accvgpr_read_b32 v25, a129
v_mul_f32 v25, v25, v31
v_accvgpr_write_b32 a129, v25
v_accvgpr_read_b32 v26, a130
v_mul_f32 v26, v26, v31
v_accvgpr_write_b32 a130, v26
v_accvgpr_read_b32 v27, a131
v_mul_f32 v27, v27, v31
v_accvgpr_write_b32 a131, v27
v_accvgpr_read_b32 v24, a132
v_mul_f32 v24, v24, v31
v_accvgpr_write_b32 a132, v24
v_accvgpr_read_b32 v25, a133
v_mul_f32 v25, v25, v31
v_accvgpr_write_b32 a133, v25
v_accvgpr_read_b32 v26, a134
v_mul_f32 v26, v26, v31
v_accvgpr_write_b32 a134, v26
v_accvgpr_read_b32 v27, a135
v_mul_f32 v27, v27, v31
v_accvgpr_write_b32 a135, v27
v_accvgpr_read_b32 v24, a136
v_mul_f32 v24, v24, v31
v_accvgpr_write_b32 a136, v24
v_accvgpr_read_b32 v25, a137
v_mul_f32 v25, v25, v31
v_accvgpr_write_b32 a137, v25
v_accvgpr_read_b32 v26, a138
v_mul_f32 v26, v26, v31
v_accvgpr_write_b32 a138, v26
v_accvgpr_read_b32 v27, a139
v_mul_f32 v27, v27, v31
v_accvgpr_write_b32 a139, v27
v_accvgpr_read_b32 v24, a140
v_mul_f32 v24, v24, v31
v_accvgpr_write_b32 a140, v24
v_accvgpr_read_b32 v25, a141
v_mul_f32 v25, v25, v31
v_accvgpr_write_b32 a141, v25
v_accvgpr_read_b32 v26, a142
v_mul_f32 v26, v26, v31
v_accvgpr_write_b32 a142, v26
v_accvgpr_read_b32 v27, a143
v_mul_f32 v27, v27, v31
v_accvgpr_write_b32 a143, v27
v_accvgpr_read_b32 v24, a144
v_mul_f32 v24, v24, v31
v_accvgpr_write_b32 a144, v24
v_accvgpr_read_b32 v25, a145
v_mul_f32 v25, v25, v31
v_accvgpr_write_b32 a145, v25
v_accvgpr_read_b32 v26, a146
v_mul_f32 v26, v26, v31
v_accvgpr_write_b32 a146, v26
v_accvgpr_read_b32 v27, a147
v_mul_f32 v27, v27, v31
v_accvgpr_write_b32 a147, v27
v_accvgpr_read_b32 v24, a148
v_mul_f32 v24, v24, v31
v_accvgpr_write_b32 a148, v24
v_accvgpr_read_b32 v25, a149
v_mul_f32 v25, v25, v31
v_accvgpr_write_b32 a149, v25
v_accvgpr_read_b32 v26, a150
v_mul_f32 v26, v26, v31
v_accvgpr_write_b32 a150, v26
v_accvgpr_read_b32 v27, a151
v_mul_f32 v27, v27, v31
v_accvgpr_write_b32 a151, v27
v_accvgpr_read_b32 v24, a152
v_mul_f32 v24, v24, v31
v_accvgpr_write_b32 a152, v24
v_accvgpr_read_b32 v25, a153
v_mul_f32 v25, v25, v31
v_accvgpr_write_b32 a153, v25
v_accvgpr_read_b32 v26, a154
v_mul_f32 v26, v26, v31
v_accvgpr_write_b32 a154, v26
v_accvgpr_read_b32 v27, a155
v_mul_f32 v27, v27, v31
v_accvgpr_write_b32 a155, v27
v_accvgpr_read_b32 v24, a156
v_mul_f32 v24, v24, v31
v_accvgpr_write_b32 a156, v24
v_accvgpr_read_b32 v25, a157
v_mul_f32 v25, v25, v31
v_accvgpr_write_b32 a157, v25
v_accvgpr_read_b32 v26, a158
v_mul_f32 v26, v26, v31
v_accvgpr_write_b32 a158, v26
v_accvgpr_read_b32 v27, a159
v_mul_f32 v27, v27, v31
v_accvgpr_write_b32 a159, v27
v_mul_f32 v56, v56, v31
v_mul_f32 v57, v57, v31
v_mul_f32 v58, v58, v31
v_mul_f32 v59, v59, v31
v_mul_f32 v60, v60, v31
v_mul_f32 v61, v61, v31
v_mul_f32 v62, v62, v31
v_mul_f32 v63, v63, v31
v_fma_f32 v24, v88, s28, v19
v_fma_f32 v25, v89, s28, v19
v_exp_f32 v24, v24
v_exp_f32 v25, v25
s_nop 0
v_cvt_pk_bf16_f32 v140, v24, v25
v_fma_f32 v24, v90, s28, v19
v_fma_f32 v25, v91, s28, v19
v_exp_f32 v24, v24
v_exp_f32 v25, v25
s_nop 0
v_cvt_pk_bf16_f32 v141, v24, v25
v_fma_f32 v24, v92, s28, v19
v_fma_f32 v25, v93, s28, v19
v_exp_f32 v24, v24
v_exp_f32 v25, v25
s_nop 0
v_cvt_pk_bf16_f32 v142, v24, v25
v_fma_f32 v24, v94, s28, v19
v_fma_f32 v25, v95, s28, v19
v_exp_f32 v24, v24
v_exp_f32 v25, v25
s_nop 0
v_cvt_pk_bf16_f32 v143, v24, v25
s_nop 3
s_setpc_b64 s[40:41]
L_rare1:
s_nop 15
s_nop 3
v_max3_f32 v30, v96, v97, v98
v_max3_f32 v30, v30, v99, v100
v_max3_f32 v30, v30, v101, v102
v_max_f32 v30, v30, v103
v_mov_b32 v31, v30
s_nop 1
v_permlane16_swap_b32 v31, v30
s_nop 1
v_max_f32 v30, v31, v30
v_mov_b32 v31, v30
s_nop 1
v_permlane32_swap_b32 v31, v30
s_nop 1
v_max_f32 v30, v31, v30
v_mov_b32 v31, s67
v_fma_f32 v30, s42, v30, v31
v_min_f32 v30, v30, v16
v_sub_f32 v31, v30, v16
v_exp_f32 v31, v31
v_mov_b32 v16, v30
v_mul_f32 v20, v20, v31
v_accvgpr_read_b32 v24, a0
v_mul_f32 v24, v24, v31
v_accvgpr_write_b32 a0, v24
v_accvgpr_read_b32 v25, a1
v_mul_f32 v25, v25, v31
v_accvgpr_write_b32 a1, v25
v_accvgpr_read_b32 v26, a2
v_mul_f32 v26, v26, v31
v_accvgpr_write_b32 a2, v26
v_accvgpr_read_b32 v27, a3
v_mul_f32 v27, v27, v31
v_accvgpr_write_b32 a3, v27
v_accvgpr_read_b32 v24, a4
v_mul_f32 v24, v24, v31
v_accvgpr_write_b32 a4, v24
v_accvgpr_read_b32 v25, a5
v_mul_f32 v25, v25, v31
v_accvgpr_write_b32 a5, v25
v_accvgpr_read_b32 v26, a6
v_mul_f32 v26, v26, v31
v_accvgpr_write_b32 a6, v26
v_accvgpr_read_b32 v27, a7
v_mul_f32 v27, v27, v31
v_accvgpr_write_b32 a7, v27
v_accvgpr_read_b32 v24, a8
v_mul_f32 v24, v24, v31
v_accvgpr_write_b32 a8, v24
v_accvgpr_read_b32 v25, a9
v_mul_f32 v25, v25, v31
v_accvgpr_write_b32 a9, v25
v_accvgpr_read_b32 v26, a10
v_mul_f32 v26, v26, v31
v_accvgpr_write_b32 a10, v26
v_accvgpr_read_b32 v27, a11
v_mul_f32 v27, v27, v31
v_accvgpr_write_b32 a11, v27
v_accvgpr_read_b32 v24, a12
v_mul_f32 v24, v24, v31
v_accvgpr_write_b32 a12, v24
v_accvgpr_read_b32 v25, a13
v_mul_f32 v25, v25, v31
v_accvgpr_write_b32 a13, v25
v_accvgpr_read_b32 v26, a14
v_mul_f32 v26, v26, v31
v_accvgpr_write_b32 a14, v26
v_accvgpr_read_b32 v27, a15
v_mul_f32 v27, v27, v31
v_accvgpr_write_b32 a15, v27
v_accvgpr_read_b32 v24, a16
v_mul_f32 v24, v24, v31
v_accvgpr_write_b32 a16, v24
v_accvgpr_read_b32 v25, a17
v_mul_f32 v25, v25, v31
v_accvgpr_write_b32 a17, v25
v_accvgpr_read_b32 v26, a18
v_mul_f32 v26, v26, v31
v_accvgpr_write_b32 a18, v26
v_accvgpr_read_b32 v27, a19
v_mul_f32 v27, v27, v31
v_accvgpr_write_b32 a19, v27
v_accvgpr_read_b32 v24, a20
v_mul_f32 v24, v24, v31
v_accvgpr_write_b32 a20, v24
v_accvgpr_read_b32 v25, a21
v_mul_f32 v25, v25, v31
v_accvgpr_write_b32 a21, v25
v_accvgpr_read_b32 v26, a22
v_mul_f32 v26, v26, v31
v_accvgpr_write_b32 a22, v26
v_accvgpr_read_b32 v27, a23
v_mul_f32 v27, v27, v31
v_accvgpr_write_b32 a23, v27
v_accvgpr_read_b32 v24, a24
v_mul_f32 v24, v24, v31
v_accvgpr_write_b32 a24, v24
v_accvgpr_read_b32 v25, a25
v_mul_f32 v25, v25, v31
v_accvgpr_write_b32 a25, v25
v_accvgpr_read_b32 v26, a26
v_mul_f32 v26, v26, v31
v_accvgpr_write_b32 a26, v26
v_accvgpr_read_b32 v27, a27
v_mul_f32 v27, v27, v31
v_accvgpr_write_b32 a27, v27
v_accvgpr_read_b32 v24, a28
v_mul_f32 v24, v24, v31
v_accvgpr_write_b32 a28, v24
v_accvgpr_read_b32 v25, a29
v_mul_f32 v25, v25, v31
v_accvgpr_write_b32 a29, v25
v_accvgpr_read_b32 v26, a30
v_mul_f32 v26, v26, v31
v_accvgpr_write_b32 a30, v26
v_accvgpr_read_b32 v27, a31
v_mul_f32 v27, v27, v31
v_accvgpr_write_b32 a31, v27
v_accvgpr_read_b32 v24, a32
v_mul_f32 v24, v24, v31
v_accvgpr_write_b32 a32, v24
v_accvgpr_read_b32 v25, a33
v_mul_f32 v25, v25, v31
v_accvgpr_write_b32 a33, v25
v_accvgpr_read_b32 v26, a34
v_mul_f32 v26, v26, v31
v_accvgpr_write_b32 a34, v26
v_accvgpr_read_b32 v27, a35
v_mul_f32 v27, v27, v31
v_accvgpr_write_b32 a35, v27
v_accvgpr_read_b32 v24, a36
v_mul_f32 v24, v24, v31
v_accvgpr_write_b32 a36, v24
v_accvgpr_read_b32 v25, a37
v_mul_f32 v25, v25, v31
v_accvgpr_write_b32 a37, v25
v_accvgpr_read_b32 v26, a38
v_mul_f32 v26, v26, v31
v_accvgpr_write_b32 a38, v26
v_accvgpr_read_b32 v27, a39
v_mul_f32 v27, v27, v31
v_accvgpr_write_b32 a39, v27
v_mul_f32 v32, v32, v31
v_mul_f32 v33, v33, v31
v_mul_f32 v34, v34, v31
v_mul_f32 v35, v35, v31
v_mul_f32 v36, v36, v31
v_mul_f32 v37, v37, v31
v_mul_f32 v38, v38, v31
v_mul_f32 v39, v39, v31
v_fma_f32 v24, v96, s28, v16
v_fma_f32 v25, v97, s28, v16
v_exp_f32 v24, v24
v_exp_f32 v25, v25
s_nop 0
v_cvt_pk_bf16_f32 v144, v24, v25
v_fma_f32 v24, v98, s28, v16
v_fma_f32 v25, v99, s28, v16
v_exp_f32 v24, v24
v_exp_f32 v25, v25
s_nop 0
v_cvt_pk_bf16_f32 v145, v24, v25
v_fma_f32 v24, v100, s28, v16
v_fma_f32 v25, v101, s28, v16
v_exp_f32 v24, v24
v_exp_f32 v25, v25
s_nop 0
v_cvt_pk_bf16_f32 v146, v24, v25
v_fma_f32 v24, v102, s28, v16
v_fma_f32 v25, v103, s28, v16
v_exp_f32 v24, v24
v_exp_f32 v25, v25
s_nop 0
v_cvt_pk_bf16_f32 v147, v24, v25
v_max3_f32 v30, v104, v105, v106
v_max3_f32 v30, v30, v107, v108
v_max3_f32 v30, v30, v109, v110
v_max_f32 v30, v30, v111
v_mov_b32 v31, v30
s_nop 1
v_permlane16_swap_b32 v31, v30
s_nop 1
v_max_f32 v30, v31, v30
v_mov_b32 v31, v30
s_nop 1
v_permlane32_swap_b32 v31, v30
s_nop 1
v_max_f32 v30, v31, v30
v_mov_b32 v31, s67
v_fma_f32 v30, s42, v30, v31
v_min_f32 v30, v30, v17
v_sub_f32 v31, v30, v17
v_exp_f32 v31, v31
v_mov_b32 v17, v30
v_mul_f32 v176, v176, v31
v_accvgpr_read_b32 v24, a40
v_mul_f32 v24, v24, v31
v_accvgpr_write_b32 a40, v24
v_accvgpr_read_b32 v25, a41
v_mul_f32 v25, v25, v31
v_accvgpr_write_b32 a41, v25
v_accvgpr_read_b32 v26, a42
v_mul_f32 v26, v26, v31
v_accvgpr_write_b32 a42, v26
v_accvgpr_read_b32 v27, a43
v_mul_f32 v27, v27, v31
v_accvgpr_write_b32 a43, v27
v_accvgpr_read_b32 v24, a44
v_mul_f32 v24, v24, v31
v_accvgpr_write_b32 a44, v24
v_accvgpr_read_b32 v25, a45
v_mul_f32 v25, v25, v31
v_accvgpr_write_b32 a45, v25
v_accvgpr_read_b32 v26, a46
v_mul_f32 v26, v26, v31
v_accvgpr_write_b32 a46, v26
v_accvgpr_read_b32 v27, a47
v_mul_f32 v27, v27, v31
v_accvgpr_write_b32 a47, v27
v_accvgpr_read_b32 v24, a48
v_mul_f32 v24, v24, v31
v_accvgpr_write_b32 a48, v24
v_accvgpr_read_b32 v25, a49
v_mul_f32 v25, v25, v31
v_accvgpr_write_b32 a49, v25
v_accvgpr_read_b32 v26, a50
v_mul_f32 v26, v26, v31
v_accvgpr_write_b32 a50, v26
v_accvgpr_read_b32 v27, a51
v_mul_f32 v27, v27, v31
v_accvgpr_write_b32 a51, v27
v_accvgpr_read_b32 v24, a52
v_mul_f32 v24, v24, v31
v_accvgpr_write_b32 a52, v24
v_accvgpr_read_b32 v25, a53
v_mul_f32 v25, v25, v31
v_accvgpr_write_b32 a53, v25
v_accvgpr_read_b32 v26, a54
v_mul_f32 v26, v26, v31
v_accvgpr_write_b32 a54, v26
v_accvgpr_read_b32 v27, a55
v_mul_f32 v27, v27, v31
v_accvgpr_write_b32 a55, v27
v_accvgpr_read_b32 v24, a56
v_mul_f32 v24, v24, v31
v_accvgpr_write_b32 a56, v24
v_accvgpr_read_b32 v25, a57
v_mul_f32 v25, v25, v31
v_accvgpr_write_b32 a57, v25
v_accvgpr_read_b32 v26, a58
v_mul_f32 v26, v26, v31
v_accvgpr_write_b32 a58, v26
v_accvgpr_read_b32 v27, a59
v_mul_f32 v27, v27, v31
v_accvgpr_write_b32 a59, v27
v_accvgpr_read_b32 v24, a60
v_mul_f32 v24, v24, v31
v_accvgpr_write_b32 a60, v24
v_accvgpr_read_b32 v25, a61
v_mul_f32 v25, v25, v31
v_accvgpr_write_b32 a61, v25
v_accvgpr_read_b32 v26, a62
v_mul_f32 v26, v26, v31
v_accvgpr_write_b32 a62, v26
v_accvgpr_read_b32 v27, a63
v_mul_f32 v27, v27, v31
v_accvgpr_write_b32 a63, v27
v_accvgpr_read_b32 v24, a64
v_mul_f32 v24, v24, v31
v_accvgpr_write_b32 a64, v24
v_accvgpr_read_b32 v25, a65
v_mul_f32 v25, v25, v31
v_accvgpr_write_b32 a65, v25
v_accvgpr_read_b32 v26, a66
v_mul_f32 v26, v26, v31
v_accvgpr_write_b32 a66, v26
v_accvgpr_read_b32 v27, a67
v_mul_f32 v27, v27, v31
v_accvgpr_write_b32 a67, v27
v_accvgpr_read_b32 v24, a68
v_mul_f32 v24, v24, v31
v_accvgpr_write_b32 a68, v24
v_accvgpr_read_b32 v25, a69
v_mul_f32 v25, v25, v31
v_accvgpr_write_b32 a69, v25
v_accvgpr_read_b32 v26, a70
v_mul_f32 v26, v26, v31
v_accvgpr_write_b32 a70, v26
v_accvgpr_read_b32 v27, a71
v_mul_f32 v27, v27, v31
v_accvgpr_write_b32 a71, v27
v_accvgpr_read_b32 v24, a72
v_mul_f32 v24, v24, v31
v_accvgpr_write_b32 a72, v24
v_accvgpr_read_b32 v25, a73
v_mul_f32 v25, v25, v31
v_accvgpr_write_b32 a73, v25
v_accvgpr_read_b32 v26, a74
v_mul_f32 v26, v26, v31
v_accvgpr_write_b32 a74, v26
v_accvgpr_read_b32 v27, a75
v_mul_f32 v27, v27, v31
v_accvgpr_write_b32 a75, v27
v_accvgpr_read_b32 v24, a76
v_mul_f32 v24, v24, v31
v_accvgpr_write_b32 a76, v24
v_accvgpr_read_b32 v25, a77
v_mul_f32 v25, v25, v31
v_accvgpr_write_b32 a77, v25
v_accvgpr_read_b32 v26, a78
v_mul_f32 v26, v26, v31
v_accvgpr_write_b32 a78, v26
v_accvgpr_read_b32 v27, a79
v_mul_f32 v27, v27, v31
v_accvgpr_write_b32 a79, v27
v_mul_f32 v40, v40, v31
v_mul_f32 v41, v41, v31
v_mul_f32 v42, v42, v31
v_mul_f32 v43, v43, v31
v_mul_f32 v44, v44, v31
v_mul_f32 v45, v45, v31
v_mul_f32 v46, v46, v31
v_mul_f32 v47, v47, v31
v_fma_f32 v24, v104, s28, v17
v_fma_f32 v25, v105, s28, v17
v_exp_f32 v24, v24
v_exp_f32 v25, v25
s_nop 0
v_cvt_pk_bf16_f32 v148, v24, v25
v_fma_f32 v24, v106, s28, v17
v_fma_f32 v25, v107, s28, v17
v_exp_f32 v24, v24
v_exp_f32 v25, v25
s_nop 0
v_cvt_pk_bf16_f32 v149, v24, v25
v_fma_f32 v24, v108, s28, v17
v_fma_f32 v25, v109, s28, v17
v_exp_f32 v24, v24
v_exp_f32 v25, v25
s_nop 0
v_cvt_pk_bf16_f32 v150, v24, v25
v_fma_f32 v24, v110, s28, v17
v_fma_f32 v25, v111, s28, v17
v_exp_f32 v24, v24
v_exp_f32 v25, v25
s_nop 0
v_cvt_pk_bf16_f32 v151, v24, v25
v_max3_f32 v30, v112, v113, v114
v_max3_f32 v30, v30, v115, v116
v_max3_f32 v30, v30, v117, v118
v_max_f32 v30, v30, v119
v_mov_b32 v31, v30
s_nop 1
v_permlane16_swap_b32 v31, v30
s_nop 1
v_max_f32 v30, v31, v30
v_mov_b32 v31, v30
s_nop 1
v_permlane32_swap_b32 v31, v30
s_nop 1
v_max_f32 v30, v31, v30
v_mov_b32 v31, s67
v_fma_f32 v30, s42, v30, v31
v_min_f32 v30, v30, v18
v_sub_f32 v31, v30, v18
v_exp_f32 v31, v31
v_mov_b32 v18, v30
v_mul_f32 v184, v184, v31
v_accvgpr_read_b32 v24, a80
v_mul_f32 v24, v24, v31
v_accvgpr_write_b32 a80, v24
v_accvgpr_read_b32 v25, a81
v_mul_f32 v25, v25, v31
v_accvgpr_write_b32 a81, v25
v_accvgpr_read_b32 v26, a82
v_mul_f32 v26, v26, v31
v_accvgpr_write_b32 a82, v26
v_accvgpr_read_b32 v27, a83
v_mul_f32 v27, v27, v31
v_accvgpr_write_b32 a83, v27
v_accvgpr_read_b32 v24, a84
v_mul_f32 v24, v24, v31
v_accvgpr_write_b32 a84, v24
v_accvgpr_read_b32 v25, a85
v_mul_f32 v25, v25, v31
v_accvgpr_write_b32 a85, v25
v_accvgpr_read_b32 v26, a86
v_mul_f32 v26, v26, v31
v_accvgpr_write_b32 a86, v26
v_accvgpr_read_b32 v27, a87
v_mul_f32 v27, v27, v31
v_accvgpr_write_b32 a87, v27
v_accvgpr_read_b32 v24, a88
v_mul_f32 v24, v24, v31
v_accvgpr_write_b32 a88, v24
v_accvgpr_read_b32 v25, a89
v_mul_f32 v25, v25, v31
v_accvgpr_write_b32 a89, v25
v_accvgpr_read_b32 v26, a90
v_mul_f32 v26, v26, v31
v_accvgpr_write_b32 a90, v26
v_accvgpr_read_b32 v27, a91
v_mul_f32 v27, v27, v31
v_accvgpr_write_b32 a91, v27
v_accvgpr_read_b32 v24, a92
v_mul_f32 v24, v24, v31
v_accvgpr_write_b32 a92, v24
v_accvgpr_read_b32 v25, a93
v_mul_f32 v25, v25, v31
v_accvgpr_write_b32 a93, v25
v_accvgpr_read_b32 v26, a94
v_mul_f32 v26, v26, v31
v_accvgpr_write_b32 a94, v26
v_accvgpr_read_b32 v27, a95
v_mul_f32 v27, v27, v31
v_accvgpr_write_b32 a95, v27
v_accvgpr_read_b32 v24, a96
v_mul_f32 v24, v24, v31
v_accvgpr_write_b32 a96, v24
v_accvgpr_read_b32 v25, a97
v_mul_f32 v25, v25, v31
v_accvgpr_write_b32 a97, v25
v_accvgpr_read_b32 v26, a98
v_mul_f32 v26, v26, v31
v_accvgpr_write_b32 a98, v26
v_accvgpr_read_b32 v27, a99
v_mul_f32 v27, v27, v31
v_accvgpr_write_b32 a99, v27
v_accvgpr_read_b32 v24, a100
v_mul_f32 v24, v24, v31
v_accvgpr_write_b32 a100, v24
v_accvgpr_read_b32 v25, a101
v_mul_f32 v25, v25, v31
v_accvgpr_write_b32 a101, v25
v_accvgpr_read_b32 v26, a102
v_mul_f32 v26, v26, v31
v_accvgpr_write_b32 a102, v26
v_accvgpr_read_b32 v27, a103
v_mul_f32 v27, v27, v31
v_accvgpr_write_b32 a103, v27
v_accvgpr_read_b32 v24, a104
v_mul_f32 v24, v24, v31
v_accvgpr_write_b32 a104, v24
v_accvgpr_read_b32 v25, a105
v_mul_f32 v25, v25, v31
v_accvgpr_write_b32 a105, v25
v_accvgpr_read_b32 v26, a106
v_mul_f32 v26, v26, v31
v_accvgpr_write_b32 a106, v26
v_accvgpr_read_b32 v27, a107
v_mul_f32 v27, v27, v31
v_accvgpr_write_b32 a107, v27
v_accvgpr_read_b32 v24, a108
v_mul_f32 v24, v24, v31
v_accvgpr_write_b32 a108, v24
v_accvgpr_read_b32 v25, a109
v_mul_f32 v25, v25, v31
v_accvgpr_write_b32 a109, v25
v_accvgpr_read_b32 v26, a110
v_mul_f32 v26, v26, v31
v_accvgpr_write_b32 a110, v26
v_accvgpr_read_b32 v27, a111
v_mul_f32 v27, v27, v31
v_accvgpr_write_b32 a111, v27
v_accvgpr_read_b32 v24, a112
v_mul_f32 v24, v24, v31
v_accvgpr_write_b32 a112, v24
v_accvgpr_read_b32 v25, a113
v_mul_f32 v25, v25, v31
v_accvgpr_write_b32 a113, v25
v_accvgpr_read_b32 v26, a114
v_mul_f32 v26, v26, v31
v_accvgpr_write_b32 a114, v26
v_accvgpr_read_b32 v27, a115
v_mul_f32 v27, v27, v31
v_accvgpr_write_b32 a115, v27
v_accvgpr_read_b32 v24, a116
v_mul_f32 v24, v24, v31
v_accvgpr_write_b32 a116, v24
v_accvgpr_read_b32 v25, a117
v_mul_f32 v25, v25, v31
v_accvgpr_write_b32 a117, v25
v_accvgpr_read_b32 v26, a118
v_mul_f32 v26, v26, v31
v_accvgpr_write_b32 a118, v26
v_accvgpr_read_b32 v27, a119
v_mul_f32 v27, v27, v31
v_accvgpr_write_b32 a119, v27
v_mul_f32 v48, v48, v31
v_mul_f32 v49, v49, v31
v_mul_f32 v50, v50, v31
v_mul_f32 v51, v51, v31
v_mul_f32 v52, v52, v31
v_mul_f32 v53, v53, v31
v_mul_f32 v54, v54, v31
v_mul_f32 v55, v55, v31
v_fma_f32 v24, v112, s28, v18
v_fma_f32 v25, v113, s28, v18
v_exp_f32 v24, v24
v_exp_f32 v25, v25
s_nop 0
v_cvt_pk_bf16_f32 v152, v24, v25
v_fma_f32 v24, v114, s28, v18
v_fma_f32 v25, v115, s28, v18
v_exp_f32 v24, v24
v_exp_f32 v25, v25
s_nop 0
v_cvt_pk_bf16_f32 v153, v24, v25
v_fma_f32 v24, v116, s28, v18
v_fma_f32 v25, v117, s28, v18
v_exp_f32 v24, v24
v_exp_f32 v25, v25
s_nop 0
v_cvt_pk_bf16_f32 v154, v24, v25
v_fma_f32 v24, v118, s28, v18
v_fma_f32 v25, v119, s28, v18
v_exp_f32 v24, v24
v_exp_f32 v25, v25
s_nop 0
v_cvt_pk_bf16_f32 v155, v24, v25
v_max3_f32 v30, v120, v121, v122
v_max3_f32 v30, v30, v123, v124
v_max3_f32 v30, v30, v125, v126
v_max_f32 v30, v30, v127
v_mov_b32 v31, v30
s_nop 1
v_permlane16_swap_b32 v31, v30
s_nop 1
v_max_f32 v30, v31, v30
v_mov_b32 v31, v30
s_nop 1
v_permlane32_swap_b32 v31, v30
s_nop 1
v_max_f32 v30, v31, v30
v_mov_b32 v31, s67
v_fma_f32 v30, s42, v30, v31
v_min_f32 v30, v30, v19
v_sub_f32 v31, v30, v19
v_exp_f32 v31, v31
v_mov_b32 v19, v30
v_mul_f32 v188, v188, v31
v_accvgpr_read_b32 v24, a120
v_mul_f32 v24, v24, v31
v_accvgpr_write_b32 a120, v24
v_accvgpr_read_b32 v25, a121
v_mul_f32 v25, v25, v31
v_accvgpr_write_b32 a121, v25
v_accvgpr_read_b32 v26, a122
v_mul_f32 v26, v26, v31
v_accvgpr_write_b32 a122, v26
v_accvgpr_read_b32 v27, a123
v_mul_f32 v27, v27, v31
v_accvgpr_write_b32 a123, v27
v_accvgpr_read_b32 v24, a124
v_mul_f32 v24, v24, v31
v_accvgpr_write_b32 a124, v24
v_accvgpr_read_b32 v25, a125
v_mul_f32 v25, v25, v31
v_accvgpr_write_b32 a125, v25
v_accvgpr_read_b32 v26, a126
v_mul_f32 v26, v26, v31
v_accvgpr_write_b32 a126, v26
v_accvgpr_read_b32 v27, a127
v_mul_f32 v27, v27, v31
v_accvgpr_write_b32 a127, v27
v_accvgpr_read_b32 v24, a128
v_mul_f32 v24, v24, v31
v_accvgpr_write_b32 a128, v24
v_accvgpr_read_b32 v25, a129
v_mul_f32 v25, v25, v31
v_accvgpr_write_b32 a129, v25
v_accvgpr_read_b32 v26, a130
v_mul_f32 v26, v26, v31
v_accvgpr_write_b32 a130, v26
v_accvgpr_read_b32 v27, a131
v_mul_f32 v27, v27, v31
v_accvgpr_write_b32 a131, v27
v_accvgpr_read_b32 v24, a132
v_mul_f32 v24, v24, v31
v_accvgpr_write_b32 a132, v24
v_accvgpr_read_b32 v25, a133
v_mul_f32 v25, v25, v31
v_accvgpr_write_b32 a133, v25
v_accvgpr_read_b32 v26, a134
v_mul_f32 v26, v26, v31
v_accvgpr_write_b32 a134, v26
v_accvgpr_read_b32 v27, a135
v_mul_f32 v27, v27, v31
v_accvgpr_write_b32 a135, v27
v_accvgpr_read_b32 v24, a136
v_mul_f32 v24, v24, v31
v_accvgpr_write_b32 a136, v24
v_accvgpr_read_b32 v25, a137
v_mul_f32 v25, v25, v31
v_accvgpr_write_b32 a137, v25
v_accvgpr_read_b32 v26, a138
v_mul_f32 v26, v26, v31
v_accvgpr_write_b32 a138, v26
v_accvgpr_read_b32 v27, a139
v_mul_f32 v27, v27, v31
v_accvgpr_write_b32 a139, v27
v_accvgpr_read_b32 v24, a140
v_mul_f32 v24, v24, v31
v_accvgpr_write_b32 a140, v24
v_accvgpr_read_b32 v25, a141
v_mul_f32 v25, v25, v31
v_accvgpr_write_b32 a141, v25
v_accvgpr_read_b32 v26, a142
v_mul_f32 v26, v26, v31
v_accvgpr_write_b32 a142, v26
v_accvgpr_read_b32 v27, a143
v_mul_f32 v27, v27, v31
v_accvgpr_write_b32 a143, v27
v_accvgpr_read_b32 v24, a144
v_mul_f32 v24, v24, v31
v_accvgpr_write_b32 a144, v24
v_accvgpr_read_b32 v25, a145
v_mul_f32 v25, v25, v31
v_accvgpr_write_b32 a145, v25
v_accvgpr_read_b32 v26, a146
v_mul_f32 v26, v26, v31
v_accvgpr_write_b32 a146, v26
v_accvgpr_read_b32 v27, a147
v_mul_f32 v27, v27, v31
v_accvgpr_write_b32 a147, v27
v_accvgpr_read_b32 v24, a148
v_mul_f32 v24, v24, v31
v_accvgpr_write_b32 a148, v24
v_accvgpr_read_b32 v25, a149
v_mul_f32 v25, v25, v31
v_accvgpr_write_b32 a149, v25
v_accvgpr_read_b32 v26, a150
v_mul_f32 v26, v26, v31
v_accvgpr_write_b32 a150, v26
v_accvgpr_read_b32 v27, a151
v_mul_f32 v27, v27, v31
v_accvgpr_write_b32 a151, v27
v_accvgpr_read_b32 v24, a152
v_mul_f32 v24, v24, v31
v_accvgpr_write_b32 a152, v24
v_accvgpr_read_b32 v25, a153
v_mul_f32 v25, v25, v31
v_accvgpr_write_b32 a153, v25
v_accvgpr_read_b32 v26, a154
v_mul_f32 v26, v26, v31
v_accvgpr_write_b32 a154, v26
v_accvgpr_read_b32 v27, a155
v_mul_f32 v27, v27, v31
v_accvgpr_write_b32 a155, v27
v_accvgpr_read_b32 v24, a156
v_mul_f32 v24, v24, v31
v_accvgpr_write_b32 a156, v24
v_accvgpr_read_b32 v25, a157
v_mul_f32 v25, v25, v31
v_accvgpr_write_b32 a157, v25
v_accvgpr_read_b32 v26, a158
v_mul_f32 v26, v26, v31
v_accvgpr_write_b32 a158, v26
v_accvgpr_read_b32 v27, a159
v_mul_f32 v27, v27, v31
v_accvgpr_write_b32 a159, v27
v_mul_f32 v56, v56, v31
v_mul_f32 v57, v57, v31
v_mul_f32 v58, v58, v31
v_mul_f32 v59, v59, v31
v_mul_f32 v60, v60, v31
v_mul_f32 v61, v61, v31
v_mul_f32 v62, v62, v31
v_mul_f32 v63, v63, v31
v_fma_f32 v24, v120, s28, v19
v_fma_f32 v25, v121, s28, v19
v_exp_f32 v24, v24
v_exp_f32 v25, v25
s_nop 0
v_cvt_pk_bf16_f32 v156, v24, v25
v_fma_f32 v24, v122, s28, v19
v_fma_f32 v25, v123, s28, v19
v_exp_f32 v24, v24
v_exp_f32 v25, v25
s_nop 0
v_cvt_pk_bf16_f32 v157, v24, v25
v_fma_f32 v24, v124, s28, v19
v_fma_f32 v25, v125, s28, v19
v_exp_f32 v24, v24
v_exp_f32 v25, v25
s_nop 0
v_cvt_pk_bf16_f32 v158, v24, v25
v_fma_f32 v24, v126, s28, v19
v_fma_f32 v25, v127, s28, v19
v_exp_f32 v24, v24
v_exp_f32 v25, v25
s_nop 0
v_cvt_pk_bf16_f32 v159, v24, v25
s_nop 3
s_setpc_b64 s[40:41]
.section .rodata,"a"
.p2align 6
.amdhsa_kernel standalone__gqa_softmax__near_ridge_kernel
  .amdhsa_next_free_vgpr 512
  .amdhsa_next_free_sgpr 102
  .amdhsa_accum_offset 256
  .amdhsa_group_segment_fixed_size 0
  .amdhsa_kernarg_size 48
  .amdhsa_user_sgpr_count 2
  .amdhsa_user_sgpr_kernarg_segment_ptr 1
  .amdhsa_system_sgpr_workgroup_id_x 1
.end_amdhsa_kernel
```
